```python
import torch

def _softmax(x, axis=-1):
    return torch.softmax(x, dim=axis)

def _gelu(x):
    return torch.nn.functional.gelu(x, approximate='tanh')

def _silu(x):
    return torch.nn.functional.silu(x)

def _sigmoid(x):
    return torch.sigmoid(x)

def _layernorm(x, axis=-1, eps=1e-05):
    m = x.mean(dim=axis, keepdim=True)
    v = x.var(dim=axis, keepdim=True, unbiased=False)
    return (x - m) / torch.sqrt(v + eps)

def _scatter_add(tgt, idx, src, axis=0):
    return tgt.clone().index_add_(axis, idx, src)

def _segment_sum(src, seg, n):
    out = torch.zeros((n,) + src.shape[1:], dtype=src.dtype)
    return out.index_add_(0, seg, src)

def _pad(x, pw):
    flat = tuple((v for pair in reversed(pw) for v in pair))
    return torch.nn.functional.pad(x, flat)
kernel_name = 'standalone__kv_cache_quant_pre_rope_vs_post_rope__prompt'

def setup_inputs():

    _w = lambda a: (lambda t: t.to(torch.bfloat16) if t.is_floating_point() else t)(torch.as_tensor(a))
    B, Sq, Skv = (1, 2048, 2048)
    H, Dh0 = (8, 256)
    G = -1 if -1 > 0 else Dh0
    G = max(2, G // 2 * 2)
    Dh = max(G, Dh0 // G * G)
    Skv = max(Skv, Sq)
    ng = Dh // G
    bits = 8 if 8 > 1 else 4
    bits = max(2, min(8, bits))
    qmax = (1 << bits) - 1
    half = Dh // 2
    inv = 1.0 / 10000.0 ** (torch.arange(half) / max(1, half))
    ang_k = torch.arange(Skv)[:, None] * inv[None, :]
    ang_q = torch.arange(Skv - Sq, Skv)[:, None] * inv[None, :]
    kc = torch.cat([torch.cos(ang_k), torch.cos(ang_k)], dim=-1)
    ks = torch.cat([torch.sin(ang_k), torch.sin(ang_k)], dim=-1)
    qc = torch.cat([torch.cos(ang_q), torch.cos(ang_q)], dim=-1)
    qs = torch.cat([torch.sin(ang_q), torch.sin(ang_q)], dim=-1)
    qk_i = torch.randint(0, qmax + 1, (B, H, Skv, Dh)).to(torch.int32)
    qv_i = torch.randint(0, qmax + 1, (B, H, Skv, Dh)).to(torch.int32)
    ksc = torch.abs((lambda *s: torch.randn(*s, dtype=torch.bfloat16) * 0.05)(B, H, Skv, ng)) * 0.1 + 0.01
    kzp = torch.full((B, H, Skv, ng), qmax / 2.0)
    vsc = torch.abs((lambda *s: torch.randn(*s, dtype=torch.bfloat16) * 0.05)(B, H, Skv, ng)) * 0.1 + 0.01
    vzp = torch.full((B, H, Skv, ng), qmax / 2.0)
    return {'q': _w((lambda *s: torch.randn(*s, dtype=torch.bfloat16) * 0.8)(B, H, Sq, Dh) * 0.5), 'qk': _w(qk_i), 'k_scales': _w(ksc), 'k_zeros': _w(kzp), 'qv': _w(qv_i), 'v_scales': _w(vsc), 'v_zeros': _w(vzp), 'q_cos': _w(qc), 'q_sin': _w(qs), 'k_cos': _w(kc), 'k_sin': _w(ks)}

def reference(q, qk, k_scales, k_zeros, qv, v_scales, v_zeros, q_cos, q_sin, k_cos, k_sin):
    B, H, Sq, Dh = q.shape
    ng = k_scales.shape[-1]
    G = Dh // ng
    half = Dh // 2
    ks = (lambda x, n, axis: torch.repeat_interleave(x, n, dim=axis))(k_scales, G, axis=-1)
    kz = (lambda x, n, axis: torch.repeat_interleave(x, n, dim=axis))(k_zeros, G, axis=-1)
    k = ((lambda x, dt: x.to(dt))(qk, q.dtype) - kz) * ks
    vs = (lambda x, n, axis: torch.repeat_interleave(x, n, dim=axis))(v_scales, G, axis=-1)
    vz = (lambda x, n, axis: torch.repeat_interleave(x, n, dim=axis))(v_zeros, G, axis=-1)
    v = ((lambda x, dt: x.to(dt))(qv, q.dtype) - vz) * vs
    k1 = k[..., :half].clone()
    k2 = k[..., half:].clone()
    krh = torch.concatenate([-k2, k1], axis=-1)
    kr = k * k_cos[None, None, :, :] + krh * k_sin[None, None, :, :]
    q1 = q[..., :half].clone()
    q2 = q[..., half:].clone()
    qrh = torch.concatenate([-q2, q1], axis=-1)
    qr = q * q_cos[None, None, :, :] + qrh * q_sin[None, None, :, :]
    logits = torch.einsum('bhqd,bhkd->bhqk', qr, kr) * float(Dh) ** (-0.5)
    attn = _softmax(logits, axis=-1)
    out = torch.einsum('bhqk,bhkd->bhqd', attn, v)
    return out
```

```asm
; @launch grid=(256,1,1) block=(512,1,1) lds=123392
.amdgcn_target "amdgcn-amd-amdhsa--gfx950"
.text
.globl standalone__kv_cache_quant_pre_rope_vs_post_rope__prompt_kernel
.p2align 8
.type standalone__kv_cache_quant_pre_rope_vs_post_rope__prompt_kernel,@function
standalone__kv_cache_quant_pre_rope_vs_post_rope__prompt_kernel:
s_cmp_ge_u32 s2, 256
s_cbranch_scc1 L_exit
s_load_dwordx16 s[16:31], s[0:1], 0
s_load_dwordx2 s[38:39], s[0:1], 88
s_load_dwordx4 s[40:43], s[0:1], 96
v_lshrrev_b32 v2, 6, v0
v_and_b32 v1, 63, v0
s_and_b32 s65, s2, 7
v_readfirstlane_b32 s64, v2
s_lshr_b32 s66, s2, 3
s_cmp_ge_u32 s64, 4
s_cbranch_scc1 L_producer
s_setprio 3
s_lshr_b32 s95, s66, 3
s_and_b32 s101, s66, 7
s_lshl_b32 s77, s95, 2
s_lshr_b32 s97, 0x2010, s77
s_and_b32 s97, s97, 7
s_lshl_b32 s76, s97, 3
s_add_u32 s76, s76, s101
s_lshl_b32 s76, s76, 5
s_lshl_b32 s77, s65, 21
s_cmp_eq_u32 s95, 2
s_waitcnt lgkmcnt(0)
s_cbranch_scc1 L_r0_v
s_add_u32 s52, s18, s77
s_addc_u32 s53, s19, 0
s_and_b32 s53, s53, 0xffff
s_mov_b32 s54, 0x200000
s_mov_b32 s55, 0x20000
s_lshl_b32 s77, s64, 3
s_add_u32 s32, s76, s77
s_lshl_b32 s78, s32, 10
s_add_u32 s79, s78, 4096
v_lshrrev_b32 v6, 5, v1
v_and_b32 v7, 31, v1
v_lshlrev_b32 v6, 10, v6
v_lshl_add_u32 v6, v7, 4, v6
buffer_load_dwordx4 a[0:3], v6, s[52:55], s78 offen offset:0 nt
buffer_load_dwordx4 a[4:7], v6, s[52:55], s78 offen offset:512 nt
buffer_load_dwordx4 a[8:11], v6, s[52:55], s78 offen offset:2048 nt
buffer_load_dwordx4 a[12:15], v6, s[52:55], s78 offen offset:2560 nt
buffer_load_dwordx4 a[16:19], v6, s[52:55], s79 offen offset:0 nt
buffer_load_dwordx4 a[20:23], v6, s[52:55], s79 offen offset:512 nt
buffer_load_dwordx4 a[24:27], v6, s[52:55], s79 offen offset:2048 nt
buffer_load_dwordx4 a[28:31], v6, s[52:55], s79 offen offset:2560 nt
s_mov_b32 s30, 1
s_branch L_r0_d
L_r0_v:
s_add_u32 s52, s24, s77
s_addc_u32 s53, s25, 0
s_and_b32 s53, s53, 0xffff
s_mov_b32 s54, 0x200000
s_mov_b32 s55, 0x20000
s_lshl_b32 s78, s64, 2
s_add_u32 s32, s76, s78
s_lshl_b32 s78, s32, 10
s_add_u32 s79, s78, 16384
v_lshlrev_b32 v6, 4, v1
buffer_load_dwordx4 a[0:3], v6, s[52:55], s78 offen offset:0 nt
buffer_load_dwordx4 a[4:7], v6, s[52:55], s78 offen offset:1024 nt
buffer_load_dwordx4 a[8:11], v6, s[52:55], s78 offen offset:2048 nt
buffer_load_dwordx4 a[12:15], v6, s[52:55], s78 offen offset:3072 nt
buffer_load_dwordx4 a[16:19], v6, s[52:55], s79 offen offset:0 nt
buffer_load_dwordx4 a[20:23], v6, s[52:55], s79 offen offset:1024 nt
buffer_load_dwordx4 a[24:27], v6, s[52:55], s79 offen offset:2048 nt
buffer_load_dwordx4 a[28:31], v6, s[52:55], s79 offen offset:3072 nt
s_mov_b32 s30, 0
L_r0_d:
s_barrier
s_lshl_b32 s70, s65, 20
s_add_u32 s48, s16, s70
s_addc_u32 s49, s17, 0
s_and_b32 s49, s49, 0xffff
s_mov_b32 s50, 0x100000
s_mov_b32 s51, 0x20000
s_lshl_b32 s71, s66, 6
s_lshl_b32 s70, s64, 4
s_add_u32 s31, s71, s70
s_lshl_b32 s73, s31, 9
s_add_u32 s72, s73, 4096
v_lshrrev_b32 v12, 4, v1
v_and_b32 v13, 15, v1
v_lshlrev_b32 v2, 9, v12
v_lshl_add_u32 v2, v13, 4, v2
buffer_load_dwordx4 a[32:35], v2, s[48:51], s73 offen offset:0 nt
buffer_load_dwordx4 a[36:39], v2, s[48:51], s73 offen offset:256 nt
buffer_load_dwordx4 a[40:43], v2, s[48:51], s73 offen offset:2048 nt
buffer_load_dwordx4 a[44:47], v2, s[48:51], s73 offen offset:2304 nt
buffer_load_dwordx4 a[48:51], v2, s[48:51], s72 offen offset:0 nt
buffer_load_dwordx4 a[52:55], v2, s[48:51], s72 offen offset:256 nt
buffer_load_dwordx4 a[56:59], v2, s[48:51], s72 offen offset:2048 nt
buffer_load_dwordx4 a[60:63], v2, s[48:51], s72 offen offset:2304 nt
s_lshl_b32 s96, s65, 3
s_add_u32 s96, s96, s97
s_lshl_b32 s96, s96, 18
s_lshl_b32 s77, s65, 11
s_add_u32 s77, s77, s32
s_lshl_b32 s77, s77, 1
s_cmp_eq_u32 s30, 1
s_cbranch_scc0 L_r0q_v
s_lshr_b32 s78, s101, 1
s_lshl_b32 s78, s78, 15
s_add_u32 s33, s96, s78
s_and_b32 s78, s101, 1
s_lshl_b32 s78, s78, 14
s_add_u32 s33, s33, s78
s_lshr_b32 s78, s64, 1
s_lshl_b32 s78, s78, 10
s_add_u32 s33, s33, s78
s_and_b32 s78, s64, 1
s_lshl_b32 s78, s78, 7
s_add_u32 s33, s33, s78
s_load_dwordx4 s[80:83], s[20:21], s77
s_load_dwordx4 s[84:87], s[22:23], s77
s_branch L_r0q_d
L_r0q_v:
s_add_u32 s33, s96, 131072
s_lshl_b32 s78, s64, 8
s_add_u32 s33, s33, s78
s_lshl_b32 s78, s101, 12
s_add_u32 s33, s33, s78
s_add_u32 s78, s77, 32
s_load_dwordx2 s[80:81], s[26:27], s77
s_load_dwordx2 s[82:83], s[26:27], s78
s_load_dwordx2 s[84:85], s[28:29], s77
s_load_dwordx2 s[86:87], s[28:29], s78
L_r0q_d:
v_lshrrev_b32 v12, 5, v1
v_and_b32 v13, 31, v1
v_mov_b32 v3, v12
v_lshlrev_b32 v5, 4, v12
v_sub_u32 v5, 16, v5
v_and_b32 v14, 7, v13
v_xor_b32 v14, v14, v12
v_lshlrev_b32 v14, 4, v14
v_lshl_add_u32 v6, v13, 7, v14
s_lshl_b32 s70, s64, 12
s_add_u32 s70, s70, 0
v_add_u32 v6, s70, v6
v_lshrrev_b32 v14, 3, v1
v_and_b32 v15, 7, v1
v_xor_b32 v7, v14, v15
v_lshlrev_b32 v7, 4, v7
v_lshl_add_u32 v7, v14, 7, v7
v_add_u32 v7, s70, v7
v_lshrrev_b32 v8, 2, v14
v_lshlrev_b32 v8, 11, v8
v_and_b32 v14, 3, v14
v_lshl_add_u32 v8, v14, 8, v8
v_lshl_add_u32 v8, v15, 4, v8
v_lshrrev_b32 v10, 4, v1
v_lshlrev_b32 v10, 15, v10
v_and_b32 v14, 15, v1
v_lshl_add_u32 v10, v14, 4, v10
s_mov_b32 s44, s42
s_and_b32 s45, s43, 0xffff
s_mov_b32 s46, 0x1100000
s_mov_b32 s47, 0x20000
v_lshlrev_b32 v4, 2, v13
v_add_u32 v96, 0, v4
v_add_u32 v97, 1, v4
v_add_u32 v98, 2, v4
v_add_u32 v99, 3, v4
v_cvt_f32_u32 v96, v96
v_cvt_f32_u32 v97, v97
v_cvt_f32_u32 v98, v98
v_cvt_f32_u32 v99, v99
v_mul_f32 v96, 0xbdd49a78, v96
v_mul_f32 v97, 0xbdd49a78, v97
v_mul_f32 v98, 0xbdd49a78, v98
v_mul_f32 v99, 0xbdd49a78, v99
v_exp_f32 v96, v96
v_exp_f32 v97, v97
v_exp_f32 v98, v98
v_exp_f32 v99, v99
s_nop 0
v_mul_f32 v96, 0.15915494, v96
v_mul_f32 v97, 0.15915494, v97
v_mul_f32 v98, 0.15915494, v98
v_mul_f32 v99, 0.15915494, v99
s_cmp_eq_u32 s30, 1
s_cbranch_scc0 L_r0p_v
v_add_u32 v100, s32, v3
v_cvt_f32_u32 v100, v100
v_mul_f32 v104, v100, v96
v_mul_f32 v105, v100, v97
v_mul_f32 v106, v100, v98
v_mul_f32 v107, v100, v99
v_fract_f32 v104, v104
v_fract_f32 v105, v105
v_fract_f32 v106, v106
v_fract_f32 v107, v107
v_sin_f32 v108, v104
v_sin_f32 v109, v105
v_sin_f32 v110, v106
v_sin_f32 v111, v107
v_cos_f32 v104, v104
v_cos_f32 v105, v105
v_cos_f32 v106, v106
v_cos_f32 v107, v107
s_nop 0
v_cvt_pk_bf16_f32 v104, v104, v108
v_cvt_pk_bf16_f32 v105, v105, v109
v_cvt_pk_bf16_f32 v106, v106, v110
v_cvt_pk_bf16_f32 v107, v107, v111
v_lshlrev_b32 v48, 16, v104
v_and_b32 v52, 0xffff0000, v104
v_lshlrev_b32 v49, 16, v105
v_and_b32 v53, 0xffff0000, v105
v_lshlrev_b32 v50, 16, v106
v_and_b32 v54, 0xffff0000, v106
v_lshlrev_b32 v51, 16, v107
v_and_b32 v55, 0xffff0000, v107
v_add_f32 v100, 2.0, v100
v_mul_f32 v104, v100, v96
v_mul_f32 v105, v100, v97
v_mul_f32 v106, v100, v98
v_mul_f32 v107, v100, v99
v_fract_f32 v104, v104
v_fract_f32 v105, v105
v_fract_f32 v106, v106
v_fract_f32 v107, v107
v_sin_f32 v108, v104
v_sin_f32 v109, v105
v_sin_f32 v110, v106
v_sin_f32 v111, v107
v_cos_f32 v104, v104
v_cos_f32 v105, v105
v_cos_f32 v106, v106
v_cos_f32 v107, v107
s_nop 0
v_cvt_pk_bf16_f32 v104, v104, v108
v_cvt_pk_bf16_f32 v105, v105, v109
v_cvt_pk_bf16_f32 v106, v106, v110
v_cvt_pk_bf16_f32 v107, v107, v111
v_lshlrev_b32 v56, 16, v104
v_and_b32 v60, 0xffff0000, v104
v_lshlrev_b32 v57, 16, v105
v_and_b32 v61, 0xffff0000, v105
v_lshlrev_b32 v58, 16, v106
v_and_b32 v62, 0xffff0000, v106
v_lshlrev_b32 v59, 16, v107
v_and_b32 v63, 0xffff0000, v107
v_add_f32 v100, 2.0, v100
v_mul_f32 v104, v100, v96
v_mul_f32 v105, v100, v97
v_mul_f32 v106, v100, v98
v_mul_f32 v107, v100, v99
v_fract_f32 v104, v104
v_fract_f32 v105, v105
v_fract_f32 v106, v106
v_fract_f32 v107, v107
v_sin_f32 v108, v104
v_sin_f32 v109, v105
v_sin_f32 v110, v106
v_sin_f32 v111, v107
v_cos_f32 v104, v104
v_cos_f32 v105, v105
v_cos_f32 v106, v106
v_cos_f32 v107, v107
s_nop 0
v_cvt_pk_bf16_f32 v104, v104, v108
v_cvt_pk_bf16_f32 v105, v105, v109
v_cvt_pk_bf16_f32 v106, v106, v110
v_cvt_pk_bf16_f32 v107, v107, v111
v_lshlrev_b32 v64, 16, v104
v_and_b32 v68, 0xffff0000, v104
v_lshlrev_b32 v65, 16, v105
v_and_b32 v69, 0xffff0000, v105
v_lshlrev_b32 v66, 16, v106
v_and_b32 v70, 0xffff0000, v106
v_lshlrev_b32 v67, 16, v107
v_and_b32 v71, 0xffff0000, v107
v_add_f32 v100, 2.0, v100
v_mul_f32 v104, v100, v96
v_mul_f32 v105, v100, v97
v_mul_f32 v106, v100, v98
v_mul_f32 v107, v100, v99
v_fract_f32 v104, v104
v_fract_f32 v105, v105
v_fract_f32 v106, v106
v_fract_f32 v107, v107
v_sin_f32 v108, v104
v_sin_f32 v109, v105
v_sin_f32 v110, v106
v_sin_f32 v111, v107
v_cos_f32 v104, v104
v_cos_f32 v105, v105
v_cos_f32 v106, v106
v_cos_f32 v107, v107
s_nop 0
v_cvt_pk_bf16_f32 v104, v104, v108
v_cvt_pk_bf16_f32 v105, v105, v109
v_cvt_pk_bf16_f32 v106, v106, v110
v_cvt_pk_bf16_f32 v107, v107, v111
v_lshlrev_b32 v72, 16, v104
v_and_b32 v76, 0xffff0000, v104
v_lshlrev_b32 v73, 16, v105
v_and_b32 v77, 0xffff0000, v105
v_lshlrev_b32 v74, 16, v106
v_and_b32 v78, 0xffff0000, v106
v_lshlrev_b32 v75, 16, v107
v_and_b32 v79, 0xffff0000, v107
s_waitcnt vmcnt(8) lgkmcnt(0)
v_accvgpr_read_b32 v16, a0
v_accvgpr_read_b32 v17, a1
v_accvgpr_read_b32 v18, a2
v_accvgpr_read_b32 v19, a3
v_accvgpr_read_b32 v20, a4
v_accvgpr_read_b32 v21, a5
v_accvgpr_read_b32 v22, a6
v_accvgpr_read_b32 v23, a7
v_accvgpr_read_b32 v24, a8
v_accvgpr_read_b32 v25, a9
v_accvgpr_read_b32 v26, a10
v_accvgpr_read_b32 v27, a11
v_accvgpr_read_b32 v28, a12
v_accvgpr_read_b32 v29, a13
v_accvgpr_read_b32 v30, a14
v_accvgpr_read_b32 v31, a15
v_accvgpr_read_b32 v32, a16
v_accvgpr_read_b32 v33, a17
v_accvgpr_read_b32 v34, a18
v_accvgpr_read_b32 v35, a19
v_accvgpr_read_b32 v36, a20
v_accvgpr_read_b32 v37, a21
v_accvgpr_read_b32 v38, a22
v_accvgpr_read_b32 v39, a23
v_accvgpr_read_b32 v40, a24
v_accvgpr_read_b32 v41, a25
v_accvgpr_read_b32 v42, a26
v_accvgpr_read_b32 v43, a27
v_accvgpr_read_b32 v44, a28
v_accvgpr_read_b32 v45, a29
v_accvgpr_read_b32 v46, a30
v_accvgpr_read_b32 v47, a31
s_mov_b32 s77, 0x3db8aa3b
v_mov_b32 v88, s80
v_mov_b32 v92, s84
v_mov_b32 v89, s81
v_mov_b32 v93, s85
v_mov_b32 v90, s82
v_mov_b32 v94, s86
v_mov_b32 v91, s83
v_mov_b32 v95, s87
v_lshlrev_b32 v88, v5, v88
v_lshlrev_b32 v92, v5, v92
v_lshlrev_b32 v89, v5, v89
v_lshlrev_b32 v93, v5, v93
v_lshlrev_b32 v90, v5, v90
v_lshlrev_b32 v94, v5, v94
v_lshlrev_b32 v91, v5, v91
v_lshlrev_b32 v95, v5, v95
v_and_b32 v88, 0xffff0000, v88
v_and_b32 v92, 0xffff0000, v92
v_and_b32 v89, 0xffff0000, v89
v_and_b32 v93, 0xffff0000, v93
v_and_b32 v90, 0xffff0000, v90
v_and_b32 v94, 0xffff0000, v94
v_and_b32 v91, 0xffff0000, v91
v_and_b32 v95, 0xffff0000, v95
v_mul_f32 v88, s77, v88
v_mul_f32 v89, s77, v89
v_mul_f32 v90, s77, v90
v_mul_f32 v91, s77, v91
v_mul_f32_e64 v92, -v92, v88
v_mul_f32_e64 v93, -v93, v89
v_mul_f32_e64 v94, -v94, v90
v_mul_f32_e64 v95, -v95, v91
v_cvt_f32_i32 v16, v16
v_cvt_f32_i32 v20, v20
v_cvt_f32_i32 v17, v17
v_cvt_f32_i32 v21, v21
v_cvt_f32_i32 v18, v18
v_cvt_f32_i32 v22, v22
v_cvt_f32_i32 v19, v19
v_cvt_f32_i32 v23, v23
v_fma_f32 v16, v16, v88, v92
v_fma_f32 v20, v20, v88, v92
v_fma_f32 v17, v17, v88, v92
v_fma_f32 v21, v21, v88, v92
v_fma_f32 v18, v18, v88, v92
v_fma_f32 v22, v22, v88, v92
v_fma_f32 v19, v19, v88, v92
v_fma_f32 v23, v23, v88, v92
v_mul_f32 v104, v20, v52
v_mul_f32 v108, v16, v52
v_mul_f32 v105, v21, v53
v_mul_f32 v109, v17, v53
v_mul_f32 v106, v22, v54
v_mul_f32 v110, v18, v54
v_mul_f32 v107, v23, v55
v_mul_f32 v111, v19, v55
v_fma_f32 v104, v16, v48, -v104
v_fma_f32 v108, v20, v48, v108
v_fma_f32 v105, v17, v49, -v105
v_fma_f32 v109, v21, v49, v109
v_fma_f32 v106, v18, v50, -v106
v_fma_f32 v110, v22, v50, v110
v_fma_f32 v107, v19, v51, -v107
v_fma_f32 v111, v23, v51, v111
v_xor_b32 v12, 0, v6
v_cvt_pk_bf16_f32 v112, v104, v105
v_cvt_pk_bf16_f32 v113, v106, v107
v_cvt_pk_bf16_f32 v114, v108, v109
v_cvt_pk_bf16_f32 v115, v110, v111
ds_write_b128 v12, v[112:115]
v_cvt_f32_i32 v24, v24
v_cvt_f32_i32 v28, v28
v_cvt_f32_i32 v25, v25
v_cvt_f32_i32 v29, v29
v_cvt_f32_i32 v26, v26
v_cvt_f32_i32 v30, v30
v_cvt_f32_i32 v27, v27
v_cvt_f32_i32 v31, v31
v_fma_f32 v24, v24, v89, v93
v_fma_f32 v28, v28, v89, v93
v_fma_f32 v25, v25, v89, v93
v_fma_f32 v29, v29, v89, v93
v_fma_f32 v26, v26, v89, v93
v_fma_f32 v30, v30, v89, v93
v_fma_f32 v27, v27, v89, v93
v_fma_f32 v31, v31, v89, v93
v_mul_f32 v104, v28, v60
v_mul_f32 v108, v24, v60
v_mul_f32 v105, v29, v61
v_mul_f32 v109, v25, v61
v_mul_f32 v106, v30, v62
v_mul_f32 v110, v26, v62
v_mul_f32 v107, v31, v63
v_mul_f32 v111, v27, v63
v_fma_f32 v104, v24, v56, -v104
v_fma_f32 v108, v28, v56, v108
v_fma_f32 v105, v25, v57, -v105
v_fma_f32 v109, v29, v57, v109
v_fma_f32 v106, v26, v58, -v106
v_fma_f32 v110, v30, v58, v110
v_fma_f32 v107, v27, v59, -v107
v_fma_f32 v111, v31, v59, v111
v_xor_b32 v13, 32, v6
v_cvt_pk_bf16_f32 v116, v104, v105
v_cvt_pk_bf16_f32 v117, v106, v107
v_cvt_pk_bf16_f32 v118, v108, v109
v_cvt_pk_bf16_f32 v119, v110, v111
ds_write_b128 v13, v[116:119]
v_cvt_f32_i32 v32, v32
v_cvt_f32_i32 v36, v36
v_cvt_f32_i32 v33, v33
v_cvt_f32_i32 v37, v37
v_cvt_f32_i32 v34, v34
v_cvt_f32_i32 v38, v38
v_cvt_f32_i32 v35, v35
v_cvt_f32_i32 v39, v39
v_fma_f32 v32, v32, v90, v94
v_fma_f32 v36, v36, v90, v94
v_fma_f32 v33, v33, v90, v94
v_fma_f32 v37, v37, v90, v94
v_fma_f32 v34, v34, v90, v94
v_fma_f32 v38, v38, v90, v94
v_fma_f32 v35, v35, v90, v94
v_fma_f32 v39, v39, v90, v94
v_mul_f32 v104, v36, v68
v_mul_f32 v108, v32, v68
v_mul_f32 v105, v37, v69
v_mul_f32 v109, v33, v69
v_mul_f32 v106, v38, v70
v_mul_f32 v110, v34, v70
v_mul_f32 v107, v39, v71
v_mul_f32 v111, v35, v71
v_fma_f32 v104, v32, v64, -v104
v_fma_f32 v108, v36, v64, v108
v_fma_f32 v105, v33, v65, -v105
v_fma_f32 v109, v37, v65, v109
v_fma_f32 v106, v34, v66, -v106
v_fma_f32 v110, v38, v66, v110
v_fma_f32 v107, v35, v67, -v107
v_fma_f32 v111, v39, v67, v111
v_xor_b32 v14, 64, v6
v_cvt_pk_bf16_f32 v120, v104, v105
v_cvt_pk_bf16_f32 v121, v106, v107
v_cvt_pk_bf16_f32 v122, v108, v109
v_cvt_pk_bf16_f32 v123, v110, v111
ds_write_b128 v14, v[120:123]
v_cvt_f32_i32 v40, v40
v_cvt_f32_i32 v44, v44
v_cvt_f32_i32 v41, v41
v_cvt_f32_i32 v45, v45
v_cvt_f32_i32 v42, v42
v_cvt_f32_i32 v46, v46
v_cvt_f32_i32 v43, v43
v_cvt_f32_i32 v47, v47
v_fma_f32 v40, v40, v91, v95
v_fma_f32 v44, v44, v91, v95
v_fma_f32 v41, v41, v91, v95
v_fma_f32 v45, v45, v91, v95
v_fma_f32 v42, v42, v91, v95
v_fma_f32 v46, v46, v91, v95
v_fma_f32 v43, v43, v91, v95
v_fma_f32 v47, v47, v91, v95
v_mul_f32 v104, v44, v76
v_mul_f32 v108, v40, v76
v_mul_f32 v105, v45, v77
v_mul_f32 v109, v41, v77
v_mul_f32 v106, v46, v78
v_mul_f32 v110, v42, v78
v_mul_f32 v107, v47, v79
v_mul_f32 v111, v43, v79
v_fma_f32 v104, v40, v72, -v104
v_fma_f32 v108, v44, v72, v108
v_fma_f32 v105, v41, v73, -v105
v_fma_f32 v109, v45, v73, v109
v_fma_f32 v106, v42, v74, -v106
v_fma_f32 v110, v46, v74, v110
v_fma_f32 v107, v43, v75, -v107
v_fma_f32 v111, v47, v75, v111
v_xor_b32 v15, 96, v6
v_cvt_pk_bf16_f32 v124, v104, v105
v_cvt_pk_bf16_f32 v125, v106, v107
v_cvt_pk_bf16_f32 v126, v108, v109
v_cvt_pk_bf16_f32 v127, v110, v111
ds_write_b128 v15, v[124:127]
s_waitcnt lgkmcnt(0)
ds_read_b128 v[112:115], v7 offset:0
ds_read_b128 v[116:119], v7 offset:1024
ds_read_b128 v[120:123], v7 offset:2048
ds_read_b128 v[124:127], v7 offset:3072
s_add_u32 s78, s33, 0
s_waitcnt lgkmcnt(3)
buffer_store_dwordx4 v[112:115], v8, s[44:47], s78 offen sc1
s_add_u32 s78, s33, 4096
s_waitcnt lgkmcnt(2)
buffer_store_dwordx4 v[116:119], v8, s[44:47], s78 offen sc1
s_add_u32 s78, s33, 8192
s_waitcnt lgkmcnt(1)
buffer_store_dwordx4 v[120:123], v8, s[44:47], s78 offen sc1
s_add_u32 s78, s33, 12288
s_waitcnt lgkmcnt(0)
buffer_store_dwordx4 v[124:127], v8, s[44:47], s78 offen sc1
s_branch L_r0p_d
L_r0p_v:
s_waitcnt vmcnt(8) lgkmcnt(0)
v_accvgpr_read_b32 v16, a0
v_accvgpr_read_b32 v17, a1
v_accvgpr_read_b32 v18, a2
v_accvgpr_read_b32 v19, a3
v_accvgpr_read_b32 v20, a4
v_accvgpr_read_b32 v21, a5
v_accvgpr_read_b32 v22, a6
v_accvgpr_read_b32 v23, a7
v_accvgpr_read_b32 v24, a8
v_accvgpr_read_b32 v25, a9
v_accvgpr_read_b32 v26, a10
v_accvgpr_read_b32 v27, a11
v_accvgpr_read_b32 v28, a12
v_accvgpr_read_b32 v29, a13
v_accvgpr_read_b32 v30, a14
v_accvgpr_read_b32 v31, a15
v_accvgpr_read_b32 v32, a16
v_accvgpr_read_b32 v33, a17
v_accvgpr_read_b32 v34, a18
v_accvgpr_read_b32 v35, a19
v_accvgpr_read_b32 v36, a20
v_accvgpr_read_b32 v37, a21
v_accvgpr_read_b32 v38, a22
v_accvgpr_read_b32 v39, a23
v_accvgpr_read_b32 v40, a24
v_accvgpr_read_b32 v41, a25
v_accvgpr_read_b32 v42, a26
v_accvgpr_read_b32 v43, a27
v_accvgpr_read_b32 v44, a28
v_accvgpr_read_b32 v45, a29
v_accvgpr_read_b32 v46, a30
v_accvgpr_read_b32 v47, a31
s_lshl_b32 s79, s84, 16
v_mov_b32 v88, s79
s_and_b32 s79, s84, 0xffff0000
v_mov_b32 v89, s79
s_lshl_b32 s79, s85, 16
v_mov_b32 v90, s79
s_and_b32 s79, s85, 0xffff0000
v_mov_b32 v91, s79
s_lshl_b32 s79, s86, 16
v_mov_b32 v92, s79
s_and_b32 s79, s86, 0xffff0000
v_mov_b32 v93, s79
s_lshl_b32 s79, s87, 16
v_mov_b32 v94, s79
s_and_b32 s79, s87, 0xffff0000
v_mov_b32 v95, s79
s_lshl_b32 s4, s80, 16
s_and_b32 s5, s80, 0xffff0000
s_lshl_b32 s6, s81, 16
s_and_b32 s7, s81, 0xffff0000
s_lshl_b32 s8, s82, 16
s_and_b32 s9, s82, 0xffff0000
s_lshl_b32 s10, s83, 16
s_and_b32 s11, s83, 0xffff0000
v_mul_f32_e64 v88, -s4, v88
v_mul_f32_e64 v89, -s5, v89
v_mul_f32_e64 v90, -s6, v90
v_mul_f32_e64 v91, -s7, v91
v_mul_f32_e64 v92, -s8, v92
v_mul_f32_e64 v93, -s9, v93
v_mul_f32_e64 v94, -s10, v94
v_mul_f32_e64 v95, -s11, v95
v_cvt_f32_i32 v16, v16
v_cvt_f32_i32 v17, v17
v_cvt_f32_i32 v18, v18
v_cvt_f32_i32 v19, v19
v_cvt_f32_i32 v20, v20
v_cvt_f32_i32 v21, v21
v_cvt_f32_i32 v22, v22
v_cvt_f32_i32 v23, v23
v_cvt_f32_i32 v24, v24
v_cvt_f32_i32 v25, v25
v_cvt_f32_i32 v26, v26
v_cvt_f32_i32 v27, v27
v_cvt_f32_i32 v28, v28
v_cvt_f32_i32 v29, v29
v_cvt_f32_i32 v30, v30
v_cvt_f32_i32 v31, v31
v_cvt_f32_i32 v32, v32
v_cvt_f32_i32 v33, v33
v_cvt_f32_i32 v34, v34
v_cvt_f32_i32 v35, v35
v_cvt_f32_i32 v36, v36
v_cvt_f32_i32 v37, v37
v_cvt_f32_i32 v38, v38
v_cvt_f32_i32 v39, v39
v_cvt_f32_i32 v40, v40
v_cvt_f32_i32 v41, v41
v_cvt_f32_i32 v42, v42
v_cvt_f32_i32 v43, v43
v_cvt_f32_i32 v44, v44
v_cvt_f32_i32 v45, v45
v_cvt_f32_i32 v46, v46
v_cvt_f32_i32 v47, v47
v_fma_f32 v16, v16, s4, v88
v_fma_f32 v17, v17, s4, v88
v_fma_f32 v18, v18, s4, v88
v_fma_f32 v19, v19, s4, v88
v_fma_f32 v20, v20, s5, v89
v_fma_f32 v21, v21, s5, v89
v_fma_f32 v22, v22, s5, v89
v_fma_f32 v23, v23, s5, v89
v_fma_f32 v24, v24, s6, v90
v_fma_f32 v25, v25, s6, v90
v_fma_f32 v26, v26, s6, v90
v_fma_f32 v27, v27, s6, v90
v_fma_f32 v28, v28, s7, v91
v_fma_f32 v29, v29, s7, v91
v_fma_f32 v30, v30, s7, v91
v_fma_f32 v31, v31, s7, v91
v_fma_f32 v32, v32, s8, v92
v_fma_f32 v33, v33, s8, v92
v_fma_f32 v34, v34, s8, v92
v_fma_f32 v35, v35, s8, v92
v_fma_f32 v36, v36, s9, v93
v_fma_f32 v37, v37, s9, v93
v_fma_f32 v38, v38, s9, v93
v_fma_f32 v39, v39, s9, v93
v_fma_f32 v40, v40, s10, v94
v_fma_f32 v41, v41, s10, v94
v_fma_f32 v42, v42, s10, v94
v_fma_f32 v43, v43, s10, v94
v_fma_f32 v44, v44, s11, v95
v_fma_f32 v45, v45, s11, v95
v_fma_f32 v46, v46, s11, v95
v_fma_f32 v47, v47, s11, v95
v_cvt_pk_bf16_f32 v112, v16, v20
v_cvt_pk_bf16_f32 v113, v24, v28
v_cvt_pk_bf16_f32 v114, v32, v36
v_cvt_pk_bf16_f32 v115, v40, v44
buffer_store_dwordx4 v[112:115], v10, s[44:47], s33 offen offset:0 sc1
v_cvt_pk_bf16_f32 v116, v17, v21
v_cvt_pk_bf16_f32 v117, v25, v29
v_cvt_pk_bf16_f32 v118, v33, v37
v_cvt_pk_bf16_f32 v119, v41, v45
buffer_store_dwordx4 v[116:119], v10, s[44:47], s33 offen offset:1024 sc1
v_cvt_pk_bf16_f32 v120, v18, v22
v_cvt_pk_bf16_f32 v121, v26, v30
v_cvt_pk_bf16_f32 v122, v34, v38
v_cvt_pk_bf16_f32 v123, v42, v46
buffer_store_dwordx4 v[120:123], v10, s[44:47], s33 offen offset:2048 sc1
v_cvt_pk_bf16_f32 v124, v19, v23
v_cvt_pk_bf16_f32 v125, v27, v31
v_cvt_pk_bf16_f32 v126, v35, v39
v_cvt_pk_bf16_f32 v127, v43, v47
buffer_store_dwordx4 v[124:127], v10, s[44:47], s33 offen offset:3072 sc1
L_r0p_d:
v_lshrrev_b32 v12, 4, v1
v_and_b32 v13, 15, v1
s_mul_i32 s70, s64, 8320
s_add_u32 s70, s70, 65536
v_lshrrev_b32 v3, 1, v13
v_mul_u32_u24 v3, 1040, v3
v_and_b32 v4, 1, v13
v_lshl_add_u32 v3, v4, 9, v3
v_lshl_add_u32 v3, v12, 4, v3
v_add_u32 v3, s70, v3
v_lshlrev_b32 v4, 3, v13
v_add_u32 v48, 0, v4
v_add_u32 v49, 1, v4
v_add_u32 v50, 2, v4
v_add_u32 v51, 3, v4
v_add_u32 v52, 4, v4
v_add_u32 v53, 5, v4
v_add_u32 v54, 6, v4
v_add_u32 v55, 7, v4
v_cvt_f32_u32 v48, v48
v_cvt_f32_u32 v49, v49
v_cvt_f32_u32 v50, v50
v_cvt_f32_u32 v51, v51
v_cvt_f32_u32 v52, v52
v_cvt_f32_u32 v53, v53
v_cvt_f32_u32 v54, v54
v_cvt_f32_u32 v55, v55
v_mul_f32 v48, 0xbdd49a78, v48
v_mul_f32 v49, 0xbdd49a78, v49
v_mul_f32 v50, 0xbdd49a78, v50
v_mul_f32 v51, 0xbdd49a78, v51
v_mul_f32 v52, 0xbdd49a78, v52
v_mul_f32 v53, 0xbdd49a78, v53
v_mul_f32 v54, 0xbdd49a78, v54
v_mul_f32 v55, 0xbdd49a78, v55
v_exp_f32 v48, v48
v_exp_f32 v49, v49
v_exp_f32 v50, v50
v_exp_f32 v51, v51
v_exp_f32 v52, v52
v_exp_f32 v53, v53
v_exp_f32 v54, v54
v_exp_f32 v55, v55
s_nop 0
v_mul_f32 v48, 0.15915494, v48
v_mul_f32 v49, 0.15915494, v49
v_mul_f32 v50, 0.15915494, v50
v_mul_f32 v51, 0.15915494, v51
v_mul_f32 v52, 0.15915494, v52
v_mul_f32 v53, 0.15915494, v53
v_mul_f32 v54, 0.15915494, v54
v_mul_f32 v55, 0.15915494, v55
v_add_u32 v5, s31, v12
v_cvt_f32_u32 v5, v5
v_mul_f32 v120, v5, v48
v_mul_f32 v121, v5, v49
v_mul_f32 v122, v5, v50
v_mul_f32 v123, v5, v51
v_fract_f32 v120, v120
v_fract_f32 v121, v121
v_fract_f32 v122, v122
v_fract_f32 v123, v123
v_sin_f32 v124, v120
v_sin_f32 v125, v121
v_sin_f32 v126, v122
v_sin_f32 v127, v123
v_cos_f32 v120, v120
v_cos_f32 v121, v121
v_cos_f32 v122, v122
v_cos_f32 v123, v123
s_nop 0
v_cvt_pk_bf16_f32 v120, v120, v124
v_cvt_pk_bf16_f32 v121, v121, v125
v_cvt_pk_bf16_f32 v122, v122, v126
v_cvt_pk_bf16_f32 v123, v123, v127
v_lshlrev_b32 v56, 16, v120
v_and_b32 v64, 0xffff0000, v120
v_lshlrev_b32 v57, 16, v121
v_and_b32 v65, 0xffff0000, v121
v_lshlrev_b32 v58, 16, v122
v_and_b32 v66, 0xffff0000, v122
v_lshlrev_b32 v59, 16, v123
v_and_b32 v67, 0xffff0000, v123
v_mul_f32 v120, v5, v52
v_mul_f32 v121, v5, v53
v_mul_f32 v122, v5, v54
v_mul_f32 v123, v5, v55
v_fract_f32 v120, v120
v_fract_f32 v121, v121
v_fract_f32 v122, v122
v_fract_f32 v123, v123
v_sin_f32 v124, v120
v_sin_f32 v125, v121
v_sin_f32 v126, v122
v_sin_f32 v127, v123
v_cos_f32 v120, v120
v_cos_f32 v121, v121
v_cos_f32 v122, v122
v_cos_f32 v123, v123
s_nop 0
v_cvt_pk_bf16_f32 v120, v120, v124
v_cvt_pk_bf16_f32 v121, v121, v125
v_cvt_pk_bf16_f32 v122, v122, v126
v_cvt_pk_bf16_f32 v123, v123, v127
v_lshlrev_b32 v60, 16, v120
v_and_b32 v68, 0xffff0000, v120
v_lshlrev_b32 v61, 16, v121
v_and_b32 v69, 0xffff0000, v121
v_lshlrev_b32 v62, 16, v122
v_and_b32 v70, 0xffff0000, v122
v_lshlrev_b32 v63, 16, v123
v_and_b32 v71, 0xffff0000, v123
v_add_f32 v5, 4.0, v5
v_mul_f32 v120, v5, v48
v_mul_f32 v121, v5, v49
v_mul_f32 v122, v5, v50
v_mul_f32 v123, v5, v51
v_fract_f32 v120, v120
v_fract_f32 v121, v121
v_fract_f32 v122, v122
v_fract_f32 v123, v123
v_sin_f32 v124, v120
v_sin_f32 v125, v121
v_sin_f32 v126, v122
v_sin_f32 v127, v123
v_cos_f32 v120, v120
v_cos_f32 v121, v121
v_cos_f32 v122, v122
v_cos_f32 v123, v123
s_nop 0
v_cvt_pk_bf16_f32 v120, v120, v124
v_cvt_pk_bf16_f32 v121, v121, v125
v_cvt_pk_bf16_f32 v122, v122, v126
v_cvt_pk_bf16_f32 v123, v123, v127
v_lshlrev_b32 v72, 16, v120
v_and_b32 v80, 0xffff0000, v120
v_lshlrev_b32 v73, 16, v121
v_and_b32 v81, 0xffff0000, v121
v_lshlrev_b32 v74, 16, v122
v_and_b32 v82, 0xffff0000, v122
v_lshlrev_b32 v75, 16, v123
v_and_b32 v83, 0xffff0000, v123
v_mul_f32 v120, v5, v52
v_mul_f32 v121, v5, v53
v_mul_f32 v122, v5, v54
v_mul_f32 v123, v5, v55
v_fract_f32 v120, v120
v_fract_f32 v121, v121
v_fract_f32 v122, v122
v_fract_f32 v123, v123
v_sin_f32 v124, v120
v_sin_f32 v125, v121
v_sin_f32 v126, v122
v_sin_f32 v127, v123
v_cos_f32 v120, v120
v_cos_f32 v121, v121
v_cos_f32 v122, v122
v_cos_f32 v123, v123
s_nop 0
v_cvt_pk_bf16_f32 v120, v120, v124
v_cvt_pk_bf16_f32 v121, v121, v125
v_cvt_pk_bf16_f32 v122, v122, v126
v_cvt_pk_bf16_f32 v123, v123, v127
v_lshlrev_b32 v76, 16, v120
v_and_b32 v84, 0xffff0000, v120
v_lshlrev_b32 v77, 16, v121
v_and_b32 v85, 0xffff0000, v121
v_lshlrev_b32 v78, 16, v122
v_and_b32 v86, 0xffff0000, v122
v_lshlrev_b32 v79, 16, v123
v_and_b32 v87, 0xffff0000, v123
v_add_f32 v5, 4.0, v5
v_mul_f32 v120, v5, v48
v_mul_f32 v121, v5, v49
v_mul_f32 v122, v5, v50
v_mul_f32 v123, v5, v51
v_fract_f32 v120, v120
v_fract_f32 v121, v121
v_fract_f32 v122, v122
v_fract_f32 v123, v123
v_sin_f32 v124, v120
v_sin_f32 v125, v121
v_sin_f32 v126, v122
v_sin_f32 v127, v123
v_cos_f32 v120, v120
v_cos_f32 v121, v121
v_cos_f32 v122, v122
v_cos_f32 v123, v123
s_nop 0
v_cvt_pk_bf16_f32 v120, v120, v124
v_cvt_pk_bf16_f32 v121, v121, v125
v_cvt_pk_bf16_f32 v122, v122, v126
v_cvt_pk_bf16_f32 v123, v123, v127
v_lshlrev_b32 v88, 16, v120
v_and_b32 v96, 0xffff0000, v120
v_lshlrev_b32 v89, 16, v121
v_and_b32 v97, 0xffff0000, v121
v_lshlrev_b32 v90, 16, v122
v_and_b32 v98, 0xffff0000, v122
v_lshlrev_b32 v91, 16, v123
v_and_b32 v99, 0xffff0000, v123
v_mul_f32 v120, v5, v52
v_mul_f32 v121, v5, v53
v_mul_f32 v122, v5, v54
v_mul_f32 v123, v5, v55
v_fract_f32 v120, v120
v_fract_f32 v121, v121
v_fract_f32 v122, v122
v_fract_f32 v123, v123
v_sin_f32 v124, v120
v_sin_f32 v125, v121
v_sin_f32 v126, v122
v_sin_f32 v127, v123
v_cos_f32 v120, v120
v_cos_f32 v121, v121
v_cos_f32 v122, v122
v_cos_f32 v123, v123
s_nop 0
v_cvt_pk_bf16_f32 v120, v120, v124
v_cvt_pk_bf16_f32 v121, v121, v125
v_cvt_pk_bf16_f32 v122, v122, v126
v_cvt_pk_bf16_f32 v123, v123, v127
v_lshlrev_b32 v92, 16, v120
v_and_b32 v100, 0xffff0000, v120
v_lshlrev_b32 v93, 16, v121
v_and_b32 v101, 0xffff0000, v121
v_lshlrev_b32 v94, 16, v122
v_and_b32 v102, 0xffff0000, v122
v_lshlrev_b32 v95, 16, v123
v_and_b32 v103, 0xffff0000, v123
v_add_f32 v5, 4.0, v5
v_mul_f32 v120, v5, v48
v_mul_f32 v121, v5, v49
v_mul_f32 v122, v5, v50
v_mul_f32 v123, v5, v51
v_fract_f32 v120, v120
v_fract_f32 v121, v121
v_fract_f32 v122, v122
v_fract_f32 v123, v123
v_sin_f32 v124, v120
v_sin_f32 v125, v121
v_sin_f32 v126, v122
v_sin_f32 v127, v123
v_cos_f32 v120, v120
v_cos_f32 v121, v121
v_cos_f32 v122, v122
v_cos_f32 v123, v123
s_nop 0
v_cvt_pk_bf16_f32 v120, v120, v124
v_cvt_pk_bf16_f32 v121, v121, v125
v_cvt_pk_bf16_f32 v122, v122, v126
v_cvt_pk_bf16_f32 v123, v123, v127
v_lshlrev_b32 v104, 16, v120
v_and_b32 v112, 0xffff0000, v120
v_lshlrev_b32 v105, 16, v121
v_and_b32 v113, 0xffff0000, v121
v_lshlrev_b32 v106, 16, v122
v_and_b32 v114, 0xffff0000, v122
v_lshlrev_b32 v107, 16, v123
v_and_b32 v115, 0xffff0000, v123
v_mul_f32 v120, v5, v52
v_mul_f32 v121, v5, v53
v_mul_f32 v122, v5, v54
v_mul_f32 v123, v5, v55
v_fract_f32 v120, v120
v_fract_f32 v121, v121
v_fract_f32 v122, v122
v_fract_f32 v123, v123
v_sin_f32 v124, v120
v_sin_f32 v125, v121
v_sin_f32 v126, v122
v_sin_f32 v127, v123
v_cos_f32 v120, v120
v_cos_f32 v121, v121
v_cos_f32 v122, v122
v_cos_f32 v123, v123
s_nop 0
v_cvt_pk_bf16_f32 v120, v120, v124
v_cvt_pk_bf16_f32 v121, v121, v125
v_cvt_pk_bf16_f32 v122, v122, v126
v_cvt_pk_bf16_f32 v123, v123, v127
v_lshlrev_b32 v108, 16, v120
v_and_b32 v116, 0xffff0000, v120
v_lshlrev_b32 v109, 16, v121
v_and_b32 v117, 0xffff0000, v121
v_lshlrev_b32 v110, 16, v122
v_and_b32 v118, 0xffff0000, v122
v_lshlrev_b32 v111, 16, v123
v_and_b32 v119, 0xffff0000, v123
s_waitcnt vmcnt(4)
v_accvgpr_read_b32 v16, a32
v_accvgpr_read_b32 v17, a33
v_accvgpr_read_b32 v18, a34
v_accvgpr_read_b32 v19, a35
v_accvgpr_read_b32 v20, a36
v_accvgpr_read_b32 v21, a37
v_accvgpr_read_b32 v22, a38
v_accvgpr_read_b32 v23, a39
v_accvgpr_read_b32 v24, a40
v_accvgpr_read_b32 v25, a41
v_accvgpr_read_b32 v26, a42
v_accvgpr_read_b32 v27, a43
v_accvgpr_read_b32 v28, a44
v_accvgpr_read_b32 v29, a45
v_accvgpr_read_b32 v30, a46
v_accvgpr_read_b32 v31, a47
v_accvgpr_read_b32 v32, a48
v_accvgpr_read_b32 v33, a49
v_accvgpr_read_b32 v34, a50
v_accvgpr_read_b32 v35, a51
v_accvgpr_read_b32 v36, a52
v_accvgpr_read_b32 v37, a53
v_accvgpr_read_b32 v38, a54
v_accvgpr_read_b32 v39, a55
v_accvgpr_read_b32 v40, a56
v_accvgpr_read_b32 v41, a57
v_accvgpr_read_b32 v42, a58
v_accvgpr_read_b32 v43, a59
v_accvgpr_read_b32 v44, a60
v_accvgpr_read_b32 v45, a61
v_accvgpr_read_b32 v46, a62
v_accvgpr_read_b32 v47, a63
v_lshlrev_b32 v120, 16, v16
v_lshlrev_b32 v124, 16, v20
v_and_b32 v121, 0xffff0000, v16
v_and_b32 v125, 0xffff0000, v20
v_lshlrev_b32 v122, 16, v17
v_lshlrev_b32 v126, 16, v21
v_and_b32 v123, 0xffff0000, v17
v_and_b32 v127, 0xffff0000, v21
v_mul_f32 v8, v124, v64
v_mul_f32 v12, v120, v64
v_mul_f32 v9, v125, v65
v_mul_f32 v13, v121, v65
v_mul_f32 v10, v126, v66
v_mul_f32 v14, v122, v66
v_mul_f32 v11, v127, v67
v_mul_f32 v15, v123, v67
v_fma_f32 v8, v120, v56, -v8
v_fma_f32 v12, v124, v56, v12
v_fma_f32 v9, v121, v57, -v9
v_fma_f32 v13, v125, v57, v13
v_fma_f32 v10, v122, v58, -v10
v_fma_f32 v14, v126, v58, v14
v_fma_f32 v11, v123, v59, -v11
v_fma_f32 v15, v127, v59, v15
v_cvt_pk_bf16_f32 v48, v8, v9
v_cvt_pk_bf16_f32 v49, v10, v11
v_cvt_pk_bf16_f32 v50, v12, v13
v_cvt_pk_bf16_f32 v51, v14, v15
ds_write_b128 v3, v[48:51] offset:0
v_lshlrev_b32 v120, 16, v18
v_lshlrev_b32 v124, 16, v22
v_and_b32 v121, 0xffff0000, v18
v_and_b32 v125, 0xffff0000, v22
v_lshlrev_b32 v122, 16, v19
v_lshlrev_b32 v126, 16, v23
v_and_b32 v123, 0xffff0000, v19
v_and_b32 v127, 0xffff0000, v23
v_mul_f32 v8, v124, v68
v_mul_f32 v12, v120, v68
v_mul_f32 v9, v125, v69
v_mul_f32 v13, v121, v69
v_mul_f32 v10, v126, v70
v_mul_f32 v14, v122, v70
v_mul_f32 v11, v127, v71
v_mul_f32 v15, v123, v71
v_fma_f32 v8, v120, v60, -v8
v_fma_f32 v12, v124, v60, v12
v_fma_f32 v9, v121, v61, -v9
v_fma_f32 v13, v125, v61, v13
v_fma_f32 v10, v122, v62, -v10
v_fma_f32 v14, v126, v62, v14
v_fma_f32 v11, v123, v63, -v11
v_fma_f32 v15, v127, v63, v15
v_cvt_pk_bf16_f32 v52, v8, v9
v_cvt_pk_bf16_f32 v53, v10, v11
v_cvt_pk_bf16_f32 v54, v12, v13
v_cvt_pk_bf16_f32 v55, v14, v15
ds_write_b128 v3, v[52:55] offset:256
v_lshlrev_b32 v120, 16, v24
v_lshlrev_b32 v124, 16, v28
v_and_b32 v121, 0xffff0000, v24
v_and_b32 v125, 0xffff0000, v28
v_lshlrev_b32 v122, 16, v25
v_lshlrev_b32 v126, 16, v29
v_and_b32 v123, 0xffff0000, v25
v_and_b32 v127, 0xffff0000, v29
v_mul_f32 v8, v124, v80
v_mul_f32 v12, v120, v80
v_mul_f32 v9, v125, v81
v_mul_f32 v13, v121, v81
v_mul_f32 v10, v126, v82
v_mul_f32 v14, v122, v82
v_mul_f32 v11, v127, v83
v_mul_f32 v15, v123, v83
v_fma_f32 v8, v120, v72, -v8
v_fma_f32 v12, v124, v72, v12
v_fma_f32 v9, v121, v73, -v9
v_fma_f32 v13, v125, v73, v13
v_fma_f32 v10, v122, v74, -v10
v_fma_f32 v14, v126, v74, v14
v_fma_f32 v11, v123, v75, -v11
v_fma_f32 v15, v127, v75, v15
v_cvt_pk_bf16_f32 v48, v8, v9
v_cvt_pk_bf16_f32 v49, v10, v11
v_cvt_pk_bf16_f32 v50, v12, v13
v_cvt_pk_bf16_f32 v51, v14, v15
ds_write_b128 v3, v[48:51] offset:64
v_lshlrev_b32 v120, 16, v26
v_lshlrev_b32 v124, 16, v30
v_and_b32 v121, 0xffff0000, v26
v_and_b32 v125, 0xffff0000, v30
v_lshlrev_b32 v122, 16, v27
v_lshlrev_b32 v126, 16, v31
v_and_b32 v123, 0xffff0000, v27
v_and_b32 v127, 0xffff0000, v31
v_mul_f32 v8, v124, v84
v_mul_f32 v12, v120, v84
v_mul_f32 v9, v125, v85
v_mul_f32 v13, v121, v85
v_mul_f32 v10, v126, v86
v_mul_f32 v14, v122, v86
v_mul_f32 v11, v127, v87
v_mul_f32 v15, v123, v87
v_fma_f32 v8, v120, v76, -v8
v_fma_f32 v12, v124, v76, v12
v_fma_f32 v9, v121, v77, -v9
v_fma_f32 v13, v125, v77, v13
v_fma_f32 v10, v122, v78, -v10
v_fma_f32 v14, v126, v78, v14
v_fma_f32 v11, v123, v79, -v11
v_fma_f32 v15, v127, v79, v15
v_cvt_pk_bf16_f32 v52, v8, v9
v_cvt_pk_bf16_f32 v53, v10, v11
v_cvt_pk_bf16_f32 v54, v12, v13
v_cvt_pk_bf16_f32 v55, v14, v15
ds_write_b128 v3, v[52:55] offset:320
v_lshlrev_b32 v120, 16, v32
v_lshlrev_b32 v124, 16, v36
v_and_b32 v121, 0xffff0000, v32
v_and_b32 v125, 0xffff0000, v36
v_lshlrev_b32 v122, 16, v33
v_lshlrev_b32 v126, 16, v37
v_and_b32 v123, 0xffff0000, v33
v_and_b32 v127, 0xffff0000, v37
v_mul_f32 v8, v124, v96
v_mul_f32 v12, v120, v96
v_mul_f32 v9, v125, v97
v_mul_f32 v13, v121, v97
v_mul_f32 v10, v126, v98
v_mul_f32 v14, v122, v98
v_mul_f32 v11, v127, v99
v_mul_f32 v15, v123, v99
v_fma_f32 v8, v120, v88, -v8
v_fma_f32 v12, v124, v88, v12
v_fma_f32 v9, v121, v89, -v9
v_fma_f32 v13, v125, v89, v13
v_fma_f32 v10, v122, v90, -v10
v_fma_f32 v14, v126, v90, v14
v_fma_f32 v11, v123, v91, -v11
v_fma_f32 v15, v127, v91, v15
v_cvt_pk_bf16_f32 v48, v8, v9
v_cvt_pk_bf16_f32 v49, v10, v11
v_cvt_pk_bf16_f32 v50, v12, v13
v_cvt_pk_bf16_f32 v51, v14, v15
ds_write_b128 v3, v[48:51] offset:128
v_lshlrev_b32 v120, 16, v34
v_lshlrev_b32 v124, 16, v38
v_and_b32 v121, 0xffff0000, v34
v_and_b32 v125, 0xffff0000, v38
v_lshlrev_b32 v122, 16, v35
v_lshlrev_b32 v126, 16, v39
v_and_b32 v123, 0xffff0000, v35
v_and_b32 v127, 0xffff0000, v39
v_mul_f32 v8, v124, v100
v_mul_f32 v12, v120, v100
v_mul_f32 v9, v125, v101
v_mul_f32 v13, v121, v101
v_mul_f32 v10, v126, v102
v_mul_f32 v14, v122, v102
v_mul_f32 v11, v127, v103
v_mul_f32 v15, v123, v103
v_fma_f32 v8, v120, v92, -v8
v_fma_f32 v12, v124, v92, v12
v_fma_f32 v9, v121, v93, -v9
v_fma_f32 v13, v125, v93, v13
v_fma_f32 v10, v122, v94, -v10
v_fma_f32 v14, v126, v94, v14
v_fma_f32 v11, v123, v95, -v11
v_fma_f32 v15, v127, v95, v15
v_cvt_pk_bf16_f32 v52, v8, v9
v_cvt_pk_bf16_f32 v53, v10, v11
v_cvt_pk_bf16_f32 v54, v12, v13
v_cvt_pk_bf16_f32 v55, v14, v15
ds_write_b128 v3, v[52:55] offset:384
v_lshlrev_b32 v120, 16, v40
v_lshlrev_b32 v124, 16, v44
v_and_b32 v121, 0xffff0000, v40
v_and_b32 v125, 0xffff0000, v44
v_lshlrev_b32 v122, 16, v41
v_lshlrev_b32 v126, 16, v45
v_and_b32 v123, 0xffff0000, v41
v_and_b32 v127, 0xffff0000, v45
v_mul_f32 v8, v124, v112
v_mul_f32 v12, v120, v112
v_mul_f32 v9, v125, v113
v_mul_f32 v13, v121, v113
v_mul_f32 v10, v126, v114
v_mul_f32 v14, v122, v114
v_mul_f32 v11, v127, v115
v_mul_f32 v15, v123, v115
v_fma_f32 v8, v120, v104, -v8
v_fma_f32 v12, v124, v104, v12
v_fma_f32 v9, v121, v105, -v9
v_fma_f32 v13, v125, v105, v13
v_fma_f32 v10, v122, v106, -v10
v_fma_f32 v14, v126, v106, v14
v_fma_f32 v11, v123, v107, -v11
v_fma_f32 v15, v127, v107, v15
v_cvt_pk_bf16_f32 v48, v8, v9
v_cvt_pk_bf16_f32 v49, v10, v11
v_cvt_pk_bf16_f32 v50, v12, v13
v_cvt_pk_bf16_f32 v51, v14, v15
ds_write_b128 v3, v[48:51] offset:192
v_lshlrev_b32 v120, 16, v42
v_lshlrev_b32 v124, 16, v46
v_and_b32 v121, 0xffff0000, v42
v_and_b32 v125, 0xffff0000, v46
v_lshlrev_b32 v122, 16, v43
v_lshlrev_b32 v126, 16, v47
v_and_b32 v123, 0xffff0000, v43
v_and_b32 v127, 0xffff0000, v47
v_mul_f32 v8, v124, v116
v_mul_f32 v12, v120, v116
v_mul_f32 v9, v125, v117
v_mul_f32 v13, v121, v117
v_mul_f32 v10, v126, v118
v_mul_f32 v14, v122, v118
v_mul_f32 v11, v127, v119
v_mul_f32 v15, v123, v119
v_fma_f32 v8, v120, v108, -v8
v_fma_f32 v12, v124, v108, v12
v_fma_f32 v9, v121, v109, -v9
v_fma_f32 v13, v125, v109, v13
v_fma_f32 v10, v122, v110, -v10
v_fma_f32 v14, v126, v110, v14
v_fma_f32 v11, v123, v111, -v11
v_fma_f32 v15, v127, v111, v15
v_cvt_pk_bf16_f32 v52, v8, v9
v_cvt_pk_bf16_f32 v53, v10, v11
v_cvt_pk_bf16_f32 v54, v12, v13
v_cvt_pk_bf16_f32 v55, v14, v15
ds_write_b128 v3, v[52:55] offset:448
s_waitcnt lgkmcnt(0)
s_waitcnt vmcnt(0)
v_mov_b32 v12, 102656
v_mov_b32 v13, 1
s_mov_b64 exec, 1
ds_add_rtn_u32 v14, v12, v13
s_waitcnt lgkmcnt(0)
v_readfirstlane_b32 s70, v14
s_mov_b64 exec, -1
s_cmp_lg_u32 s70, 3
s_cbranch_scc1 L_r0_noflag
v_mov_b32 v12, 101888
s_mov_b32 s90, 0x80000
L_nw_c:
ds_read_b32 v13, v12
s_waitcnt lgkmcnt(0)
v_readfirstlane_b32 s94, v13
s_cmp_lg_u32 s94, 0
s_cbranch_scc1 L_nw_done_c
s_sleep 1
s_sub_u32 s90, s90, 1
s_cmp_lg_u32 s90, 0
s_cbranch_scc1 L_nw_c
L_nw_done_c:
s_mov_b32 s70, s66
s_lshl_b32 s79, s65, 7
s_add_u32 s70, s70, s79
s_lshl_b32 s70, s70, 7
s_add_u32 s70, s70, 16777216
v_mov_b32 v13, s94
v_mov_b32 v12, 0
s_mov_b64 exec, 1
buffer_store_dword v13, v12, s[44:47], s70 offen sc1
s_mov_b64 exec, -1
L_r0_noflag:
s_lshl_b32 s70, s64, 8
s_add_u32 s70, s70, 98816
v_lshlrev_b32 v5, 2, v1
v_add_u32 v5, s70, v5
v_and_b32 v0, 3, v1
v_lshlrev_b32 v0, 8, v0
v_add_u32 v0, 98816, v0
v_mov_b32 v7, 1
ds_write_b32 v5, v7 offset:1024
s_mov_b32 s91, 2
s_mov_b32 s90, 0x80000
L_cpoll:
ds_read_b32 v7, v0 offset:2048
s_waitcnt lgkmcnt(0)
v_cmp_gt_u32 vcc, s91, v7
s_cbranch_vccz L_cpoll_done
s_sleep 1
s_sub_u32 s90, s90, 1
s_cmp_lg_u32 s90, 0
s_cbranch_scc1 L_cpoll
L_cpoll_done:
v_lshlrev_b32 v1, 4, v1
v_add_u32 v2, 65536, v1
s_mov_b32 s91, 1
s_mov_b32 s93, 0
s_mov_b32 s90, 0x80000
L_qw:
ds_read_b32 v7, v0 offset:1024
s_waitcnt lgkmcnt(0)
v_cmp_gt_u32 vcc, s91, v7
s_cbranch_vccz L_qw_done
s_sub_u32 s90, s90, 1
s_cmp_lg_u32 s90, 0
s_cbranch_scc1 L_qw
L_qw_done:
s_mov_b32 s32, 0x7050302
s_mov_b32 s33, 0xf0e0d0c
s_mov_b32 s34, 0x8060402
s_mov_b32 s35, 0x100e0d0c
s_mov_b32 s80, 0x9080604
s_mov_b32 s81, 0xffff0b0a
s_mov_b32 s82, 0xc070503
s_mov_b32 s83, 0x100f0e0d
s_lshl_b32 s84, s66, 2
s_add_u32 s84, s84, s64
s_lshl_b32 s84, s84, 10
s_lshl_b32 s70, s65, 21
s_add_u32 s84, s84, s70
s_add_u32 s84, s84, 262144
s_lshl_b32 s70, s65, 21
s_lshl_b32 s71, s64, 15
s_add_u32 s68, s70, s71
s_add_u32 s69, s68, 131072
buffer_load_dwordx4 a[64:67], v1, s[44:47], s68 offen offset:0 sc1
buffer_load_dwordx4 a[68:71], v1, s[44:47], s68 offen offset:1024 sc1
buffer_load_dwordx4 a[72:75], v1, s[44:47], s68 offen offset:2048 sc1
buffer_load_dwordx4 a[76:79], v1, s[44:47], s68 offen offset:3072 sc1
s_add_u32 s68, s68, 4096
buffer_load_dwordx4 a[80:83], v1, s[44:47], s68 offen offset:0 sc1
buffer_load_dwordx4 a[84:87], v1, s[44:47], s68 offen offset:1024 sc1
buffer_load_dwordx4 a[88:91], v1, s[44:47], s68 offen offset:2048 sc1
buffer_load_dwordx4 a[92:95], v1, s[44:47], s68 offen offset:3072 sc1
s_add_u32 s68, s68, 4096
buffer_load_dwordx4 a[96:99], v1, s[44:47], s68 offen offset:0 sc1
buffer_load_dwordx4 a[100:103], v1, s[44:47], s68 offen offset:1024 sc1
buffer_load_dwordx4 a[104:107], v1, s[44:47], s68 offen offset:2048 sc1
buffer_load_dwordx4 a[108:111], v1, s[44:47], s68 offen offset:3072 sc1
s_add_u32 s68, s68, 4096
buffer_load_dwordx4 a[112:115], v1, s[44:47], s68 offen offset:0 sc1
buffer_load_dwordx4 a[116:119], v1, s[44:47], s68 offen offset:1024 sc1
buffer_load_dwordx4 a[120:123], v1, s[44:47], s68 offen offset:2048 sc1
ds_read_b128 v[32:35], v2 offset:0
ds_read_b128 v[36:39], v2 offset:8320
ds_read_b128 v[40:43], v2 offset:16640
ds_read_b128 v[44:47], v2 offset:24960
v_mov_b32 v3, v1
s_lshl_b32 s70, s64, 13
v_add_u32 v4, s70, v1
v_mov_b32 v8, 0
v_mov_b32 v9, 0
v_mov_b32 v10, 0
v_mov_b32 v11, 0
s_waitcnt vmcnt(15)
v_accvgpr_write_b32 a0, 0
v_accvgpr_write_b32 a1, 0
v_accvgpr_write_b32 a2, 0
v_accvgpr_write_b32 a3, 0
v_accvgpr_write_b32 a4, 0
v_accvgpr_write_b32 a5, 0
v_accvgpr_write_b32 a6, 0
v_accvgpr_write_b32 a7, 0
v_accvgpr_write_b32 a8, 0
v_accvgpr_write_b32 a9, 0
v_accvgpr_write_b32 a10, 0
v_accvgpr_write_b32 a11, 0
v_accvgpr_write_b32 a12, 0
v_accvgpr_write_b32 a13, 0
v_accvgpr_write_b32 a14, 0
v_accvgpr_write_b32 a15, 0
v_accvgpr_write_b32 a16, 0
v_accvgpr_write_b32 a17, 0
v_accvgpr_write_b32 a18, 0
v_accvgpr_write_b32 a19, 0
v_accvgpr_write_b32 a20, 0
v_accvgpr_write_b32 a21, 0
v_accvgpr_write_b32 a22, 0
v_accvgpr_write_b32 a23, 0
v_accvgpr_write_b32 a24, 0
v_accvgpr_write_b32 a25, 0
v_accvgpr_write_b32 a26, 0
v_accvgpr_write_b32 a27, 0
v_accvgpr_write_b32 a28, 0
v_accvgpr_write_b32 a29, 0
v_accvgpr_write_b32 a30, 0
v_accvgpr_write_b32 a31, 0
v_accvgpr_write_b32 a32, 0
v_accvgpr_write_b32 a33, 0
v_accvgpr_write_b32 a34, 0
v_accvgpr_write_b32 a35, 0
v_accvgpr_write_b32 a36, 0
v_accvgpr_write_b32 a37, 0
v_accvgpr_write_b32 a38, 0
v_accvgpr_write_b32 a39, 0
v_accvgpr_write_b32 a40, 0
v_accvgpr_write_b32 a41, 0
v_accvgpr_write_b32 a42, 0
v_accvgpr_write_b32 a43, 0
v_accvgpr_write_b32 a44, 0
v_accvgpr_write_b32 a45, 0
v_accvgpr_write_b32 a46, 0
v_accvgpr_write_b32 a47, 0
v_accvgpr_write_b32 a48, 0
v_accvgpr_write_b32 a49, 0
v_accvgpr_write_b32 a50, 0
v_accvgpr_write_b32 a51, 0
v_accvgpr_write_b32 a52, 0
v_accvgpr_write_b32 a53, 0
v_accvgpr_write_b32 a54, 0
v_accvgpr_write_b32 a55, 0
v_accvgpr_write_b32 a56, 0
v_accvgpr_write_b32 a57, 0
v_accvgpr_write_b32 a58, 0
v_accvgpr_write_b32 a59, 0
v_accvgpr_write_b32 a60, 0
v_accvgpr_write_b32 a61, 0
v_accvgpr_write_b32 a62, 0
v_accvgpr_write_b32 a63, 0
s_waitcnt vmcnt(14) lgkmcnt(3)
v_mfma_f32_16x16x32_bf16 v[64:67], a[64:67], v[32:35], 0
s_waitcnt lgkmcnt(2)
buffer_load_dwordx4 a[124:127], v1, s[44:47], s68 offen offset:3072 sc1
v_mfma_f32_16x16x32_bf16 v[68:71], a[64:67], v[36:39], 0
s_waitcnt lgkmcnt(1)
ds_read_b128 v[48:51], v2 offset:1040
v_mfma_f32_16x16x32_bf16 v[72:75], a[64:67], v[40:43], 0
s_waitcnt lgkmcnt(1)
ds_read_b128 v[52:55], v2 offset:9360
v_mfma_f32_16x16x32_bf16 v[76:79], a[64:67], v[44:47], 0
s_waitcnt vmcnt(14)
ds_read_b128 v[56:59], v2 offset:17680
v_mfma_f32_16x16x32_bf16 v[80:83], a[68:71], v[32:35], 0
s_add_u32 s68, s68, 4096
buffer_load_dwordx4 a[64:67], v1, s[44:47], s68 offen offset:0 sc1
v_mfma_f32_16x16x32_bf16 v[84:87], a[68:71], v[36:39], 0
ds_read_b128 v[60:63], v2 offset:26000
v_mfma_f32_16x16x32_bf16 v[88:91], a[68:71], v[40:43], 0
v_mfma_f32_16x16x32_bf16 v[92:95], a[68:71], v[44:47], 0
s_waitcnt vmcnt(14) lgkmcnt(3)
v_mfma_f32_16x16x32_bf16 v[64:67], a[72:75], v[48:51], v[64:67]
s_waitcnt lgkmcnt(2)
buffer_load_dwordx4 a[68:71], v1, s[44:47], s68 offen offset:1024 sc1
v_mfma_f32_16x16x32_bf16 v[68:71], a[72:75], v[52:55], v[68:71]
s_waitcnt lgkmcnt(1)
ds_read_b128 v[32:35], v2 offset:2080
v_mfma_f32_16x16x32_bf16 v[72:75], a[72:75], v[56:59], v[72:75]
s_waitcnt lgkmcnt(1)
ds_read_b128 v[36:39], v2 offset:10400
v_mfma_f32_16x16x32_bf16 v[76:79], a[72:75], v[60:63], v[76:79]
s_waitcnt vmcnt(14)
ds_read_b128 v[40:43], v2 offset:18720
v_mfma_f32_16x16x32_bf16 v[80:83], a[76:79], v[48:51], v[80:83]
buffer_load_dwordx4 a[72:75], v1, s[44:47], s68 offen offset:2048 sc1
v_mfma_f32_16x16x32_bf16 v[84:87], a[76:79], v[52:55], v[84:87]
ds_read_b128 v[44:47], v2 offset:27040
v_mfma_f32_16x16x32_bf16 v[88:91], a[76:79], v[56:59], v[88:91]
v_mfma_f32_16x16x32_bf16 v[92:95], a[76:79], v[60:63], v[92:95]
s_waitcnt vmcnt(14) lgkmcnt(3)
v_mfma_f32_16x16x32_bf16 v[64:67], a[80:83], v[32:35], v[64:67]
s_waitcnt lgkmcnt(2)
buffer_load_dwordx4 a[76:79], v1, s[44:47], s68 offen offset:3072 sc1
v_mfma_f32_16x16x32_bf16 v[68:71], a[80:83], v[36:39], v[68:71]
s_waitcnt lgkmcnt(1)
ds_read_b128 v[48:51], v2 offset:3120
v_mfma_f32_16x16x32_bf16 v[72:75], a[80:83], v[40:43], v[72:75]
s_waitcnt lgkmcnt(1)
ds_read_b128 v[52:55], v2 offset:11440
v_mfma_f32_16x16x32_bf16 v[76:79], a[80:83], v[44:47], v[76:79]
s_waitcnt vmcnt(14)
ds_read_b128 v[56:59], v2 offset:19760
v_mfma_f32_16x16x32_bf16 v[80:83], a[84:87], v[32:35], v[80:83]
s_add_u32 s68, s68, 4096
buffer_load_dwordx4 a[80:83], v1, s[44:47], s68 offen offset:0 sc1
v_mfma_f32_16x16x32_bf16 v[84:87], a[84:87], v[36:39], v[84:87]
ds_read_b128 v[60:63], v2 offset:28080
v_mfma_f32_16x16x32_bf16 v[88:91], a[84:87], v[40:43], v[88:91]
v_mfma_f32_16x16x32_bf16 v[92:95], a[84:87], v[44:47], v[92:95]
s_waitcnt vmcnt(14) lgkmcnt(3)
v_mfma_f32_16x16x32_bf16 v[64:67], a[88:91], v[48:51], v[64:67]
s_waitcnt lgkmcnt(2)
buffer_load_dwordx4 a[84:87], v1, s[44:47], s68 offen offset:1024 sc1
v_mfma_f32_16x16x32_bf16 v[68:71], a[88:91], v[52:55], v[68:71]
s_waitcnt lgkmcnt(1)
ds_read_b128 v[32:35], v2 offset:4160
v_mfma_f32_16x16x32_bf16 v[72:75], a[88:91], v[56:59], v[72:75]
s_waitcnt lgkmcnt(1)
ds_read_b128 v[36:39], v2 offset:12480
v_mfma_f32_16x16x32_bf16 v[76:79], a[88:91], v[60:63], v[76:79]
s_waitcnt vmcnt(14)
ds_read_b128 v[40:43], v2 offset:20800
v_mfma_f32_16x16x32_bf16 v[80:83], a[92:95], v[48:51], v[80:83]
buffer_load_dwordx4 a[88:91], v1, s[44:47], s68 offen offset:2048 sc1
v_mfma_f32_16x16x32_bf16 v[84:87], a[92:95], v[52:55], v[84:87]
ds_read_b128 v[44:47], v2 offset:29120
v_mfma_f32_16x16x32_bf16 v[88:91], a[92:95], v[56:59], v[88:91]
v_mfma_f32_16x16x32_bf16 v[92:95], a[92:95], v[60:63], v[92:95]
s_waitcnt vmcnt(14) lgkmcnt(3)
v_mfma_f32_16x16x32_bf16 v[64:67], a[96:99], v[32:35], v[64:67]
s_waitcnt lgkmcnt(2)
buffer_load_dwordx4 a[92:95], v1, s[44:47], s68 offen offset:3072 sc1
v_mfma_f32_16x16x32_bf16 v[68:71], a[96:99], v[36:39], v[68:71]
s_waitcnt lgkmcnt(1)
ds_read_b128 v[48:51], v2 offset:5200
v_mfma_f32_16x16x32_bf16 v[72:75], a[96:99], v[40:43], v[72:75]
s_waitcnt lgkmcnt(1)
ds_read_b128 v[52:55], v2 offset:13520
v_mfma_f32_16x16x32_bf16 v[76:79], a[96:99], v[44:47], v[76:79]
s_waitcnt vmcnt(14)
ds_read_b128 v[56:59], v2 offset:21840
v_mfma_f32_16x16x32_bf16 v[80:83], a[100:103], v[32:35], v[80:83]
s_add_u32 s68, s68, 4096
buffer_load_dwordx4 a[96:99], v1, s[44:47], s68 offen offset:0 sc1
v_mfma_f32_16x16x32_bf16 v[84:87], a[100:103], v[36:39], v[84:87]
ds_read_b128 v[60:63], v2 offset:30160
v_mfma_f32_16x16x32_bf16 v[88:91], a[100:103], v[40:43], v[88:91]
v_mfma_f32_16x16x32_bf16 v[92:95], a[100:103], v[44:47], v[92:95]
s_waitcnt vmcnt(14) lgkmcnt(3)
v_mfma_f32_16x16x32_bf16 v[64:67], a[104:107], v[48:51], v[64:67]
s_waitcnt lgkmcnt(2)
buffer_load_dwordx4 a[100:103], v1, s[44:47], s68 offen offset:1024 sc1
v_mfma_f32_16x16x32_bf16 v[68:71], a[104:107], v[52:55], v[68:71]
s_waitcnt lgkmcnt(1)
ds_read_b128 v[32:35], v2 offset:6240
v_mfma_f32_16x16x32_bf16 v[72:75], a[104:107], v[56:59], v[72:75]
s_waitcnt lgkmcnt(1)
ds_read_b128 v[36:39], v2 offset:14560
v_mfma_f32_16x16x32_bf16 v[76:79], a[104:107], v[60:63], v[76:79]
s_waitcnt vmcnt(14)
ds_read_b128 v[40:43], v2 offset:22880
v_mfma_f32_16x16x32_bf16 v[80:83], a[108:111], v[48:51], v[80:83]
buffer_load_dwordx4 a[104:107], v1, s[44:47], s68 offen offset:2048 sc1
v_mfma_f32_16x16x32_bf16 v[84:87], a[108:111], v[52:55], v[84:87]
ds_read_b128 v[44:47], v2 offset:31200
v_mfma_f32_16x16x32_bf16 v[88:91], a[108:111], v[56:59], v[88:91]
v_mfma_f32_16x16x32_bf16 v[92:95], a[108:111], v[60:63], v[92:95]
s_waitcnt vmcnt(14) lgkmcnt(3)
v_mfma_f32_16x16x32_bf16 v[64:67], a[112:115], v[32:35], v[64:67]
s_waitcnt lgkmcnt(2)
buffer_load_dwordx4 a[108:111], v1, s[44:47], s68 offen offset:3072 sc1
v_mfma_f32_16x16x32_bf16 v[68:71], a[112:115], v[36:39], v[68:71]
s_waitcnt lgkmcnt(1)
ds_read_b128 v[48:51], v2 offset:7280
v_mfma_f32_16x16x32_bf16 v[72:75], a[112:115], v[40:43], v[72:75]
s_waitcnt lgkmcnt(1)
ds_read_b128 v[52:55], v2 offset:15600
v_mfma_f32_16x16x32_bf16 v[76:79], a[112:115], v[44:47], v[76:79]
s_waitcnt vmcnt(14)
ds_read_b128 v[56:59], v2 offset:23920
v_mfma_f32_16x16x32_bf16 v[80:83], a[116:119], v[32:35], v[80:83]
s_add_u32 s68, s68, 4096
buffer_load_dwordx4 a[112:115], v1, s[44:47], s68 offen offset:0 sc1
v_mfma_f32_16x16x32_bf16 v[84:87], a[116:119], v[36:39], v[84:87]
ds_read_b128 v[60:63], v2 offset:32240
v_mfma_f32_16x16x32_bf16 v[88:91], a[116:119], v[40:43], v[88:91]
v_mfma_f32_16x16x32_bf16 v[92:95], a[116:119], v[44:47], v[92:95]
s_waitcnt vmcnt(14) lgkmcnt(3)
v_mfma_f32_16x16x32_bf16 v[64:67], a[120:123], v[48:51], v[64:67]
s_waitcnt lgkmcnt(2)
buffer_load_dwordx4 a[116:119], v1, s[44:47], s68 offen offset:1024 sc1
v_mfma_f32_16x16x32_bf16 v[68:71], a[120:123], v[52:55], v[68:71]
s_waitcnt lgkmcnt(1)
ds_read_b128 v[32:35], v2 offset:0
v_mfma_f32_16x16x32_bf16 v[72:75], a[120:123], v[56:59], v[72:75]
s_waitcnt lgkmcnt(1)
ds_read_b128 v[36:39], v2 offset:8320
v_mfma_f32_16x16x32_bf16 v[76:79], a[120:123], v[60:63], v[76:79]
s_waitcnt vmcnt(14)
ds_read_b128 v[40:43], v2 offset:16640
v_mfma_f32_16x16x32_bf16 v[80:83], a[124:127], v[48:51], v[80:83]
buffer_load_dwordx4 a[120:123], v1, s[44:47], s68 offen offset:2048 sc1
v_mfma_f32_16x16x32_bf16 v[84:87], a[124:127], v[52:55], v[84:87]
ds_read_b128 v[44:47], v2 offset:24960
v_mfma_f32_16x16x32_bf16 v[88:91], a[124:127], v[56:59], v[88:91]
v_mfma_f32_16x16x32_bf16 v[92:95], a[124:127], v[60:63], v[92:95]
s_waitcnt vmcnt(14) lgkmcnt(3)
v_mfma_f32_16x16x32_bf16 v[96:99], a[64:67], v[32:35], 0
s_waitcnt lgkmcnt(2)
buffer_load_dwordx4 a[124:127], v1, s[44:47], s68 offen offset:3072 sc1
v_mfma_f32_16x16x32_bf16 v[100:103], a[64:67], v[36:39], 0
s_waitcnt lgkmcnt(1)
ds_read_b128 v[48:51], v2 offset:1040
v_mfma_f32_16x16x32_bf16 v[104:107], a[64:67], v[40:43], 0
s_waitcnt lgkmcnt(1)
ds_read_b128 v[52:55], v2 offset:9360
v_mfma_f32_16x16x32_bf16 v[108:111], a[64:67], v[44:47], 0
s_waitcnt vmcnt(14)
ds_read_b128 v[56:59], v2 offset:17680
v_exp_f32 v12, v64
v_mfma_f32_16x16x32_bf16 v[112:115], a[68:71], v[32:35], 0
s_add_u32 s68, s68, 233472
buffer_load_dwordx4 a[64:67], v1, s[44:47], s68 offen offset:0 sc1
v_exp_f32 v13, v65
v_mfma_f32_16x16x32_bf16 v[116:119], a[68:71], v[36:39], 0
ds_read_b128 v[60:63], v2 offset:26000
v_exp_f32 v14, v66
v_mfma_f32_16x16x32_bf16 v[120:123], a[68:71], v[40:43], 0
v_exp_f32 v15, v67
v_add_f32 v8, v8, v12
v_mfma_f32_16x16x32_bf16 v[124:127], a[68:71], v[44:47], 0
s_waitcnt vmcnt(14) lgkmcnt(3)
v_cvt_pk_bf16_f32 v20, v12, v13
v_add_f32 v8, v8, v13
v_exp_f32 v16, v80
v_mfma_f32_16x16x32_bf16 v[96:99], a[72:75], v[48:51], v[96:99]
s_waitcnt lgkmcnt(2)
buffer_load_dwordx4 a[68:71], v1, s[44:47], s68 offen offset:1024 sc1
v_mfma_f32_16x16x32_bf16 v[100:103], a[72:75], v[52:55], v[100:103]
s_waitcnt lgkmcnt(1)
ds_read_b128 v[32:35], v2 offset:2080
v_mfma_f32_16x16x32_bf16 v[104:107], a[72:75], v[56:59], v[104:107]
s_waitcnt lgkmcnt(1)
ds_read_b128 v[36:39], v2 offset:10400
v_exp_f32 v17, v81
v_mfma_f32_16x16x32_bf16 v[108:111], a[72:75], v[60:63], v[108:111]
s_waitcnt vmcnt(14)
ds_read_b128 v[40:43], v2 offset:18720
v_mfma_f32_16x16x32_bf16 v[112:115], a[76:79], v[48:51], v[112:115]
buffer_load_dwordx4 a[72:75], v1, s[44:47], s68 offen offset:2048 sc1
v_mfma_f32_16x16x32_bf16 v[116:119], a[76:79], v[52:55], v[116:119]
ds_read_b128 v[44:47], v2 offset:27040
v_mfma_f32_16x16x32_bf16 v[120:123], a[76:79], v[56:59], v[120:123]
v_add_f32 v8, v8, v14
v_cvt_pk_bf16_f32 v21, v14, v15
v_mfma_f32_16x16x32_bf16 v[124:127], a[76:79], v[60:63], v[124:127]
s_waitcnt vmcnt(14) lgkmcnt(3)
v_add_f32 v8, v8, v15
v_exp_f32 v18, v82
v_mfma_f32_16x16x32_bf16 v[96:99], a[80:83], v[32:35], v[96:99]
s_waitcnt lgkmcnt(2)
buffer_load_dwordx4 a[76:79], v1, s[44:47], s68 offen offset:3072 sc1
v_mfma_f32_16x16x32_bf16 v[100:103], a[80:83], v[36:39], v[100:103]
s_waitcnt lgkmcnt(1)
ds_read_b128 v[48:51], v2 offset:3120
v_mfma_f32_16x16x32_bf16 v[104:107], a[80:83], v[40:43], v[104:107]
s_waitcnt lgkmcnt(1)
ds_read_b128 v[52:55], v2 offset:11440
v_exp_f32 v19, v83
v_mfma_f32_16x16x32_bf16 v[108:111], a[80:83], v[44:47], v[108:111]
s_waitcnt vmcnt(14)
ds_read_b128 v[56:59], v2 offset:19760
v_mfma_f32_16x16x32_bf16 v[112:115], a[84:87], v[32:35], v[112:115]
s_add_u32 s68, s68, 4096
buffer_load_dwordx4 a[80:83], v1, s[44:47], s68 offen offset:0 sc1
v_mfma_f32_16x16x32_bf16 v[116:119], a[84:87], v[36:39], v[116:119]
ds_read_b128 v[60:63], v2 offset:28080
v_add_f32 v8, v8, v16
v_mfma_f32_16x16x32_bf16 v[120:123], a[84:87], v[40:43], v[120:123]
v_cvt_pk_bf16_f32 v22, v16, v17
v_add_f32 v8, v8, v17
v_mfma_f32_16x16x32_bf16 v[124:127], a[84:87], v[44:47], v[124:127]
s_waitcnt vmcnt(14) lgkmcnt(3)
v_exp_f32 v12, v68
v_mfma_f32_16x16x32_bf16 v[96:99], a[88:91], v[48:51], v[96:99]
s_waitcnt lgkmcnt(2)
buffer_load_dwordx4 a[84:87], v1, s[44:47], s68 offen offset:1024 sc1
v_mfma_f32_16x16x32_bf16 v[100:103], a[88:91], v[52:55], v[100:103]
s_waitcnt lgkmcnt(1)
ds_read_b128 v[32:35], v2 offset:4160
v_mfma_f32_16x16x32_bf16 v[104:107], a[88:91], v[56:59], v[104:107]
s_waitcnt lgkmcnt(1)
ds_read_b128 v[36:39], v2 offset:12480
v_exp_f32 v13, v69
v_mfma_f32_16x16x32_bf16 v[108:111], a[88:91], v[60:63], v[108:111]
s_waitcnt vmcnt(14)
ds_read_b128 v[40:43], v2 offset:20800
v_mfma_f32_16x16x32_bf16 v[112:115], a[92:95], v[48:51], v[112:115]
buffer_load_dwordx4 a[88:91], v1, s[44:47], s68 offen offset:2048 sc1
v_mfma_f32_16x16x32_bf16 v[116:119], a[92:95], v[52:55], v[116:119]
ds_read_b128 v[44:47], v2 offset:29120
v_add_f32 v8, v8, v18
v_mfma_f32_16x16x32_bf16 v[120:123], a[92:95], v[56:59], v[120:123]
v_cvt_pk_bf16_f32 v23, v18, v19
v_add_f32 v8, v8, v19
v_mfma_f32_16x16x32_bf16 v[124:127], a[92:95], v[60:63], v[124:127]
s_waitcnt vmcnt(14) lgkmcnt(3)
ds_write_b128 v4, v[20:23] offset:0
v_mfma_f32_16x16x32_bf16 v[96:99], a[96:99], v[32:35], v[96:99]
s_waitcnt lgkmcnt(3)
buffer_load_dwordx4 a[92:95], v1, s[44:47], s68 offen offset:3072 sc1
v_exp_f32 v14, v70
v_mfma_f32_16x16x32_bf16 v[100:103], a[96:99], v[36:39], v[100:103]
s_waitcnt lgkmcnt(2)
ds_read_b128 v[48:51], v2 offset:5200
v_exp_f32 v15, v71
v_mfma_f32_16x16x32_bf16 v[104:107], a[96:99], v[40:43], v[104:107]
s_waitcnt lgkmcnt(2)
ds_read_b128 v[52:55], v2 offset:13520
v_mfma_f32_16x16x32_bf16 v[108:111], a[96:99], v[44:47], v[108:111]
s_waitcnt vmcnt(14)
ds_read_b128 v[56:59], v2 offset:21840
v_add_f32 v9, v9, v12
v_mfma_f32_16x16x32_bf16 v[112:115], a[100:103], v[32:35], v[112:115]
s_add_u32 s68, s68, 4096
buffer_load_dwordx4 a[96:99], v1, s[44:47], s68 offen offset:0 sc1
v_mfma_f32_16x16x32_bf16 v[116:119], a[100:103], v[36:39], v[116:119]
ds_read_b128 v[60:63], v2 offset:30160
v_mfma_f32_16x16x32_bf16 v[120:123], a[100:103], v[40:43], v[120:123]
v_cvt_pk_bf16_f32 v24, v12, v13
v_add_f32 v9, v9, v13
v_mfma_f32_16x16x32_bf16 v[124:127], a[100:103], v[44:47], v[124:127]
s_waitcnt vmcnt(14) lgkmcnt(3)
v_exp_f32 v16, v84
v_mfma_f32_16x16x32_bf16 v[96:99], a[104:107], v[48:51], v[96:99]
s_waitcnt lgkmcnt(2)
buffer_load_dwordx4 a[100:103], v1, s[44:47], s68 offen offset:1024 sc1
v_mfma_f32_16x16x32_bf16 v[100:103], a[104:107], v[52:55], v[100:103]
s_waitcnt lgkmcnt(1)
ds_read_b128 v[32:35], v2 offset:6240
v_exp_f32 v17, v85
v_mfma_f32_16x16x32_bf16 v[104:107], a[104:107], v[56:59], v[104:107]
s_waitcnt lgkmcnt(1)
ds_read_b128 v[36:39], v2 offset:14560
v_mfma_f32_16x16x32_bf16 v[108:111], a[104:107], v[60:63], v[108:111]
s_waitcnt vmcnt(14)
ds_read_b128 v[40:43], v2 offset:22880
v_add_f32 v9, v9, v14
v_mfma_f32_16x16x32_bf16 v[112:115], a[108:111], v[48:51], v[112:115]
buffer_load_dwordx4 a[104:107], v1, s[44:47], s68 offen offset:2048 sc1
v_mfma_f32_16x16x32_bf16 v[116:119], a[108:111], v[52:55], v[116:119]
ds_read_b128 v[44:47], v2 offset:31200
v_cvt_pk_bf16_f32 v25, v14, v15
v_mfma_f32_16x16x32_bf16 v[120:123], a[108:111], v[56:59], v[120:123]
v_add_f32 v9, v9, v15
v_exp_f32 v18, v86
v_mfma_f32_16x16x32_bf16 v[124:127], a[108:111], v[60:63], v[124:127]
s_waitcnt vmcnt(14) lgkmcnt(3)
v_exp_f32 v19, v87
v_mfma_f32_16x16x32_bf16 v[96:99], a[112:115], v[32:35], v[96:99]
s_waitcnt lgkmcnt(2)
buffer_load_dwordx4 a[108:111], v1, s[44:47], s68 offen offset:3072 sc1
v_mfma_f32_16x16x32_bf16 v[100:103], a[112:115], v[36:39], v[100:103]
s_waitcnt lgkmcnt(1)
ds_read_b128 v[48:51], v2 offset:7280
v_mfma_f32_16x16x32_bf16 v[104:107], a[112:115], v[40:43], v[104:107]
s_waitcnt lgkmcnt(1)
ds_read_b128 v[52:55], v2 offset:15600
v_mfma_f32_16x16x32_bf16 v[108:111], a[112:115], v[44:47], v[108:111]
s_waitcnt vmcnt(14)
ds_read_b128 v[56:59], v2 offset:23920
v_add_f32 v9, v9, v16
v_mfma_f32_16x16x32_bf16 v[112:115], a[116:119], v[32:35], v[112:115]
s_add_u32 s68, s68, 4096
buffer_load_dwordx4 a[112:115], v1, s[44:47], s68 offen offset:0 sc1
v_mfma_f32_16x16x32_bf16 v[116:119], a[116:119], v[36:39], v[116:119]
ds_read_b128 v[60:63], v2 offset:32240
v_cvt_pk_bf16_f32 v26, v16, v17
v_mfma_f32_16x16x32_bf16 v[120:123], a[116:119], v[40:43], v[120:123]
v_add_f32 v9, v9, v17
v_exp_f32 v12, v72
v_mfma_f32_16x16x32_bf16 v[124:127], a[116:119], v[44:47], v[124:127]
s_waitcnt vmcnt(14) lgkmcnt(3)
v_exp_f32 v13, v73
v_mfma_f32_16x16x32_bf16 v[96:99], a[120:123], v[48:51], v[96:99]
s_waitcnt lgkmcnt(2)
buffer_load_dwordx4 a[116:119], v1, s[44:47], s68 offen offset:1024 sc1
v_mfma_f32_16x16x32_bf16 v[100:103], a[120:123], v[52:55], v[100:103]
s_waitcnt lgkmcnt(1)
v_add_f32 v9, v9, v18
v_cvt_pk_bf16_f32 v27, v18, v19
v_mfma_f32_16x16x32_bf16 v[104:107], a[120:123], v[56:59], v[104:107]
s_waitcnt lgkmcnt(0)
v_add_f32 v9, v9, v19
v_mfma_f32_16x16x32_bf16 v[108:111], a[120:123], v[60:63], v[108:111]
s_waitcnt vmcnt(14)
ds_write_b128 v4, v[24:27] offset:1024
v_mfma_f32_16x16x32_bf16 v[112:115], a[124:127], v[48:51], v[112:115]
buffer_load_dwordx4 a[120:123], v1, s[44:47], s68 offen offset:2048 sc1
v_exp_f32 v14, v74
v_mfma_f32_16x16x32_bf16 v[116:119], a[124:127], v[52:55], v[116:119]
v_exp_f32 v15, v75
v_mfma_f32_16x16x32_bf16 v[120:123], a[124:127], v[56:59], v[120:123]
v_add_f32 v10, v10, v12
v_cvt_pk_bf16_f32 v28, v12, v13
v_mfma_f32_16x16x32_bf16 v[124:127], a[124:127], v[60:63], v[124:127]
s_waitcnt vmcnt(14)
v_add_f32 v10, v10, v13
s_nop 7
s_nop 0
v_add_f32 v10, v10, v14
v_cvt_pk_bf16_f32 v29, v14, v15
v_add_f32 v10, v10, v15
v_exp_f32 v16, v88
v_exp_f32 v17, v89
v_exp_f32 v18, v90
v_exp_f32 v19, v91
s_nop 0
v_cvt_pk_bf16_f32 v30, v16, v17
v_cvt_pk_bf16_f32 v31, v18, v19
ds_write_b128 v4, v[28:31] offset:2048
v_add_f32 v10, v10, v16
v_add_f32 v10, v10, v17
v_add_f32 v10, v10, v18
v_add_f32 v10, v10, v19
v_exp_f32 v12, v76
v_exp_f32 v13, v77
v_exp_f32 v14, v78
v_exp_f32 v15, v79
v_exp_f32 v16, v92
v_exp_f32 v17, v93
v_exp_f32 v18, v94
v_exp_f32 v19, v95
s_nop 0
v_cvt_pk_bf16_f32 v20, v12, v13
v_cvt_pk_bf16_f32 v21, v14, v15
v_cvt_pk_bf16_f32 v22, v16, v17
v_cvt_pk_bf16_f32 v23, v18, v19
ds_write_b128 v4, v[20:23] offset:3072
v_add_f32 v11, v11, v12
v_add_f32 v11, v11, v13
v_add_f32 v11, v11, v14
v_add_f32 v11, v11, v15
v_add_f32 v11, v11, v16
v_add_f32 v11, v11, v17
v_add_f32 v11, v11, v18
v_add_f32 v11, v11, v19
v_exp_f32 v12, v96
v_exp_f32 v13, v97
v_exp_f32 v14, v98
v_exp_f32 v15, v99
v_exp_f32 v16, v112
v_exp_f32 v17, v113
v_exp_f32 v18, v114
v_exp_f32 v19, v115
s_nop 0
v_cvt_pk_bf16_f32 v24, v12, v13
v_cvt_pk_bf16_f32 v25, v14, v15
v_cvt_pk_bf16_f32 v26, v16, v17
v_cvt_pk_bf16_f32 v27, v18, v19
ds_write_b128 v4, v[24:27] offset:4096
v_add_f32 v8, v8, v12
v_add_f32 v8, v8, v13
v_add_f32 v8, v8, v14
v_add_f32 v8, v8, v15
v_add_f32 v8, v8, v16
v_add_f32 v8, v8, v17
v_add_f32 v8, v8, v18
v_add_f32 v8, v8, v19
v_exp_f32 v12, v100
v_exp_f32 v13, v101
v_exp_f32 v14, v102
v_exp_f32 v15, v103
v_exp_f32 v16, v116
v_exp_f32 v17, v117
v_exp_f32 v18, v118
v_exp_f32 v19, v119
s_nop 0
v_cvt_pk_bf16_f32 v28, v12, v13
v_cvt_pk_bf16_f32 v29, v14, v15
v_cvt_pk_bf16_f32 v30, v16, v17
v_cvt_pk_bf16_f32 v31, v18, v19
ds_write_b128 v4, v[28:31] offset:5120
v_add_f32 v9, v9, v12
v_add_f32 v9, v9, v13
v_add_f32 v9, v9, v14
v_add_f32 v9, v9, v15
v_add_f32 v9, v9, v16
v_add_f32 v9, v9, v17
v_add_f32 v9, v9, v18
v_add_f32 v9, v9, v19
v_exp_f32 v12, v104
v_exp_f32 v13, v105
v_exp_f32 v14, v106
v_exp_f32 v15, v107
v_exp_f32 v16, v120
v_exp_f32 v17, v121
v_exp_f32 v18, v122
v_exp_f32 v19, v123
s_nop 0
v_cvt_pk_bf16_f32 v20, v12, v13
v_cvt_pk_bf16_f32 v21, v14, v15
v_cvt_pk_bf16_f32 v22, v16, v17
v_cvt_pk_bf16_f32 v23, v18, v19
ds_write_b128 v4, v[20:23] offset:6144
v_add_f32 v10, v10, v12
v_add_f32 v10, v10, v13
v_add_f32 v10, v10, v14
v_add_f32 v10, v10, v15
v_add_f32 v10, v10, v16
v_add_f32 v10, v10, v17
v_add_f32 v10, v10, v18
v_add_f32 v10, v10, v19
v_exp_f32 v12, v108
v_exp_f32 v13, v109
v_exp_f32 v14, v110
v_exp_f32 v15, v111
v_exp_f32 v16, v124
v_exp_f32 v17, v125
v_exp_f32 v18, v126
v_exp_f32 v19, v127
s_nop 0
v_cvt_pk_bf16_f32 v24, v12, v13
v_cvt_pk_bf16_f32 v25, v14, v15
v_cvt_pk_bf16_f32 v26, v16, v17
v_cvt_pk_bf16_f32 v27, v18, v19
ds_write_b128 v4, v[24:27] offset:7168
v_add_f32 v11, v11, v12
v_add_f32 v11, v11, v13
v_add_f32 v11, v11, v14
v_add_f32 v11, v11, v15
v_add_f32 v11, v11, v16
v_add_f32 v11, v11, v17
v_add_f32 v11, v11, v18
v_add_f32 v11, v11, v19
s_add_u32 s67, s93, 1
v_mov_b32 v6, s67
ds_write_b32 v5, v6
v_xor_b32 v4, 0x8000, v4
ds_read_b128 v[32:35], v2 offset:0
ds_read_b128 v[36:39], v2 offset:8320
ds_read_b128 v[40:43], v2 offset:16640
ds_read_b128 v[44:47], v2 offset:24960
s_waitcnt lgkmcnt(3)
L_loop_f:
v_mfma_f32_16x16x32_bf16 v[64:67], a[64:67], v[32:35], 0
s_waitcnt lgkmcnt(2)
buffer_load_dwordx4 a[124:127], v1, s[44:47], s68 offen offset:3072 sc1
v_mfma_f32_16x16x32_bf16 v[68:71], a[64:67], v[36:39], 0
s_waitcnt lgkmcnt(1)
ds_read_b128 v[48:51], v2 offset:1040
v_mfma_f32_16x16x32_bf16 v[72:75], a[64:67], v[40:43], 0
s_waitcnt lgkmcnt(1)
ds_read_b128 v[52:55], v2 offset:9360
v_mfma_f32_16x16x32_bf16 v[76:79], a[64:67], v[44:47], 0
s_waitcnt vmcnt(14)
ds_read_b128 v[56:59], v2 offset:17680
v_mfma_f32_16x16x32_bf16 v[80:83], a[68:71], v[32:35], 0
s_add_u32 s68, s68, 4096
buffer_load_dwordx4 a[64:67], v1, s[44:47], s68 offen offset:0 sc1
v_mfma_f32_16x16x32_bf16 v[84:87], a[68:71], v[36:39], 0
ds_read_b128 v[60:63], v2 offset:26000
v_mfma_f32_16x16x32_bf16 v[88:91], a[68:71], v[40:43], 0
v_mfma_f32_16x16x32_bf16 v[92:95], a[68:71], v[44:47], 0
s_waitcnt vmcnt(14) lgkmcnt(3)
v_mfma_f32_16x16x32_bf16 v[64:67], a[72:75], v[48:51], v[64:67]
s_waitcnt lgkmcnt(2)
buffer_load_dwordx4 a[68:71], v1, s[44:47], s68 offen offset:1024 sc1
v_mfma_f32_16x16x32_bf16 v[68:71], a[72:75], v[52:55], v[68:71]
s_waitcnt lgkmcnt(1)
ds_read_b128 v[32:35], v2 offset:2080
v_mfma_f32_16x16x32_bf16 v[72:75], a[72:75], v[56:59], v[72:75]
s_waitcnt lgkmcnt(1)
ds_read_b128 v[36:39], v2 offset:10400
v_mfma_f32_16x16x32_bf16 v[76:79], a[72:75], v[60:63], v[76:79]
s_waitcnt vmcnt(14)
ds_read_b128 v[40:43], v2 offset:18720
s_lshl_b32 s92, s67, 3
s_lshr_b64 s[76:77], s[32:33], s92
s_and_b32 s92, s76, 0xff
ds_read_b32 v6, v0 offset:2048
v_mfma_f32_16x16x32_bf16 v[80:83], a[76:79], v[48:51], v[80:83]
buffer_load_dwordx4 a[72:75], v1, s[44:47], s68 offen offset:2048 sc1
v_mfma_f32_16x16x32_bf16 v[84:87], a[76:79], v[52:55], v[84:87]
ds_read_b128 v[44:47], v2 offset:27040
v_mfma_f32_16x16x32_bf16 v[88:91], a[76:79], v[56:59], v[88:91]
v_mfma_f32_16x16x32_bf16 v[92:95], a[76:79], v[60:63], v[92:95]
s_waitcnt vmcnt(14) lgkmcnt(4)
v_mfma_f32_16x16x32_bf16 v[64:67], a[80:83], v[32:35], v[64:67]
s_waitcnt lgkmcnt(3)
buffer_load_dwordx4 a[76:79], v1, s[44:47], s68 offen offset:3072 sc1
v_mfma_f32_16x16x32_bf16 v[68:71], a[80:83], v[36:39], v[68:71]
s_waitcnt lgkmcnt(2)
ds_read_b128 v[48:51], v2 offset:3120
v_mfma_f32_16x16x32_bf16 v[72:75], a[80:83], v[40:43], v[72:75]
s_waitcnt lgkmcnt(1)
ds_read_b128 v[52:55], v2 offset:11440
v_mfma_f32_16x16x32_bf16 v[76:79], a[80:83], v[44:47], v[76:79]
s_waitcnt vmcnt(14)
ds_read_b128 v[56:59], v2 offset:19760
v_mfma_f32_16x16x32_bf16 v[80:83], a[84:87], v[32:35], v[80:83]
s_add_u32 s68, s68, 4096
buffer_load_dwordx4 a[80:83], v1, s[44:47], s68 offen offset:0 sc1
v_mfma_f32_16x16x32_bf16 v[84:87], a[84:87], v[36:39], v[84:87]
ds_read_b128 v[60:63], v2 offset:28080
v_mfma_f32_16x16x32_bf16 v[88:91], a[84:87], v[40:43], v[88:91]
v_mfma_f32_16x16x32_bf16 v[92:95], a[84:87], v[44:47], v[92:95]
s_waitcnt vmcnt(14) lgkmcnt(3)
v_mfma_f32_16x16x32_bf16 v[64:67], a[88:91], v[48:51], v[64:67]
s_waitcnt lgkmcnt(2)
buffer_load_dwordx4 a[84:87], v1, s[44:47], s68 offen offset:1024 sc1
v_mfma_f32_16x16x32_bf16 v[68:71], a[88:91], v[52:55], v[68:71]
s_waitcnt lgkmcnt(1)
ds_read_b128 v[32:35], v2 offset:4160
v_mfma_f32_16x16x32_bf16 v[72:75], a[88:91], v[56:59], v[72:75]
s_waitcnt lgkmcnt(1)
ds_read_b128 v[36:39], v2 offset:12480
v_mfma_f32_16x16x32_bf16 v[76:79], a[88:91], v[60:63], v[76:79]
s_waitcnt vmcnt(14)
ds_read_b128 v[40:43], v2 offset:20800
v_mfma_f32_16x16x32_bf16 v[80:83], a[92:95], v[48:51], v[80:83]
buffer_load_dwordx4 a[88:91], v1, s[44:47], s68 offen offset:2048 sc1
v_mfma_f32_16x16x32_bf16 v[84:87], a[92:95], v[52:55], v[84:87]
ds_read_b128 v[44:47], v2 offset:29120
v_mfma_f32_16x16x32_bf16 v[88:91], a[92:95], v[56:59], v[88:91]
v_mfma_f32_16x16x32_bf16 v[92:95], a[92:95], v[60:63], v[92:95]
s_waitcnt vmcnt(14) lgkmcnt(3)
v_mfma_f32_16x16x32_bf16 v[64:67], a[96:99], v[32:35], v[64:67]
s_waitcnt lgkmcnt(2)
buffer_load_dwordx4 a[92:95], v1, s[44:47], s68 offen offset:3072 sc1
v_mfma_f32_16x16x32_bf16 v[68:71], a[96:99], v[36:39], v[68:71]
s_waitcnt lgkmcnt(1)
ds_read_b128 v[48:51], v2 offset:5200
v_mfma_f32_16x16x32_bf16 v[72:75], a[96:99], v[40:43], v[72:75]
s_waitcnt lgkmcnt(1)
ds_read_b128 v[52:55], v2 offset:13520
v_mfma_f32_16x16x32_bf16 v[76:79], a[96:99], v[44:47], v[76:79]
s_waitcnt vmcnt(14)
ds_read_b128 v[56:59], v2 offset:21840
v_mfma_f32_16x16x32_bf16 v[80:83], a[100:103], v[32:35], v[80:83]
s_add_u32 s68, s68, 4096
buffer_load_dwordx4 a[96:99], v1, s[44:47], s68 offen offset:0 sc1
v_mfma_f32_16x16x32_bf16 v[84:87], a[100:103], v[36:39], v[84:87]
ds_read_b128 v[60:63], v2 offset:30160
v_mfma_f32_16x16x32_bf16 v[88:91], a[100:103], v[40:43], v[88:91]
v_mfma_f32_16x16x32_bf16 v[92:95], a[100:103], v[44:47], v[92:95]
s_waitcnt vmcnt(14) lgkmcnt(3)
v_cmp_gt_u32 vcc, s92, v6
s_cbranch_vccnz L_spin_ta_f
L_back_ta_f:
v_mfma_f32_16x16x32_bf16 v[64:67], a[104:107], v[48:51], v[64:67]
s_waitcnt lgkmcnt(2)
buffer_load_dwordx4 a[100:103], v1, s[44:47], s68 offen offset:1024 sc1
v_mfma_f32_16x16x32_bf16 v[68:71], a[104:107], v[52:55], v[68:71]
s_waitcnt lgkmcnt(1)
ds_read_b128 v[32:35], v2 offset:6240
v_mfma_f32_16x16x32_bf16 v[72:75], a[104:107], v[56:59], v[72:75]
s_waitcnt lgkmcnt(1)
ds_read_b128 v[36:39], v2 offset:14560
v_mfma_f32_16x16x32_bf16 v[76:79], a[104:107], v[60:63], v[76:79]
s_waitcnt vmcnt(14)
ds_read_b128 v[40:43], v2 offset:22880
ds_read_b32 v6, v0
v_mfma_f32_16x16x32_bf16 v[80:83], a[108:111], v[48:51], v[80:83]
buffer_load_dwordx4 a[104:107], v1, s[44:47], s68 offen offset:2048 sc1
v_mfma_f32_16x16x32_bf16 v[84:87], a[108:111], v[52:55], v[84:87]
ds_read_b128 v[44:47], v2 offset:31200
v_mfma_f32_16x16x32_bf16 v[88:91], a[108:111], v[56:59], v[88:91]
v_mfma_f32_16x16x32_bf16 v[92:95], a[108:111], v[60:63], v[92:95]
s_waitcnt vmcnt(14) lgkmcnt(4)
v_mfma_f32_16x16x32_bf16 v[64:67], a[112:115], v[32:35], v[64:67]
s_waitcnt lgkmcnt(3)
buffer_load_dwordx4 a[108:111], v1, s[44:47], s68 offen offset:3072 sc1
v_mfma_f32_16x16x32_bf16 v[68:71], a[112:115], v[36:39], v[68:71]
s_waitcnt lgkmcnt(2)
ds_read_b128 v[48:51], v2 offset:7280
v_mfma_f32_16x16x32_bf16 v[72:75], a[112:115], v[40:43], v[72:75]
s_waitcnt lgkmcnt(1)
ds_read_b128 v[52:55], v2 offset:15600
v_mfma_f32_16x16x32_bf16 v[76:79], a[112:115], v[44:47], v[76:79]
s_waitcnt vmcnt(14)
ds_read_b128 v[56:59], v2 offset:23920
v_mfma_f32_16x16x32_bf16 v[80:83], a[116:119], v[32:35], v[80:83]
s_add_u32 s68, s68, 4096
buffer_load_dwordx4 a[112:115], v1, s[44:47], s68 offen offset:0 sc1
v_mfma_f32_16x16x32_bf16 v[84:87], a[116:119], v[36:39], v[84:87]
ds_read_b128 v[60:63], v2 offset:32240
v_mfma_f32_16x16x32_bf16 v[88:91], a[116:119], v[40:43], v[88:91]
v_mfma_f32_16x16x32_bf16 v[92:95], a[116:119], v[44:47], v[92:95]
s_waitcnt vmcnt(14) lgkmcnt(3)
v_mfma_f32_16x16x32_bf16 v[64:67], a[120:123], v[48:51], v[64:67]
s_waitcnt lgkmcnt(2)
buffer_load_dwordx4 a[116:119], v1, s[44:47], s68 offen offset:1024 sc1
v_mfma_f32_16x16x32_bf16 v[68:71], a[120:123], v[52:55], v[68:71]
s_waitcnt lgkmcnt(1)
ds_read_b128 v[32:35], v2 offset:0
v_mfma_f32_16x16x32_bf16 v[72:75], a[120:123], v[56:59], v[72:75]
s_waitcnt lgkmcnt(1)
ds_read_b128 v[36:39], v2 offset:8320
v_mfma_f32_16x16x32_bf16 v[76:79], a[120:123], v[60:63], v[76:79]
s_waitcnt vmcnt(14)
ds_read_b128 v[40:43], v2 offset:16640
v_mfma_f32_16x16x32_bf16 v[80:83], a[124:127], v[48:51], v[80:83]
buffer_load_dwordx4 a[120:123], v1, s[44:47], s68 offen offset:2048 sc1
v_mfma_f32_16x16x32_bf16 v[84:87], a[124:127], v[52:55], v[84:87]
ds_read_b128 v[44:47], v2 offset:24960
v_mfma_f32_16x16x32_bf16 v[88:91], a[124:127], v[56:59], v[88:91]
v_mfma_f32_16x16x32_bf16 v[92:95], a[124:127], v[60:63], v[92:95]
s_waitcnt vmcnt(14) lgkmcnt(3)
v_mfma_f32_16x16x32_bf16 v[96:99], a[64:67], v[32:35], 0
s_waitcnt lgkmcnt(2)
buffer_load_dwordx4 a[124:127], v1, s[44:47], s68 offen offset:3072 sc1
v_mfma_f32_16x16x32_bf16 v[100:103], a[64:67], v[36:39], 0
s_waitcnt lgkmcnt(1)
ds_read_b128 v[48:51], v2 offset:1040
v_mfma_f32_16x16x32_bf16 v[104:107], a[64:67], v[40:43], 0
s_waitcnt lgkmcnt(1)
ds_read_b128 v[52:55], v2 offset:9360
v_mfma_f32_16x16x32_bf16 v[108:111], a[64:67], v[44:47], 0
s_waitcnt vmcnt(14)
ds_read_b128 v[56:59], v2 offset:17680
v_cmp_gt_u32 vcc, s67, v6
s_cbranch_vccnz L_spin_p_f
L_back_p_f:
v_mfma_f32_16x16x32_bf16 v[112:115], a[68:71], v[32:35], 0
buffer_load_dwordx4 a[64:67], v1, s[44:47], s69 offen offset:0 sc1
v_exp_f32 v12, v64
v_mfma_f32_16x16x32_bf16 v[116:119], a[68:71], v[36:39], 0
ds_read_b128 v[60:63], v2 offset:26000
v_exp_f32 v13, v65
v_mfma_f32_16x16x32_bf16 v[120:123], a[68:71], v[40:43], 0
v_exp_f32 v14, v66
v_exp_f32 v15, v67
v_mfma_f32_16x16x32_bf16 v[124:127], a[68:71], v[44:47], 0
s_waitcnt vmcnt(14) lgkmcnt(3)
v_add_f32 v8, v8, v12
v_cvt_pk_bf16_f32 v20, v12, v13
v_add_f32 v8, v8, v13
v_mfma_f32_16x16x32_bf16 v[96:99], a[72:75], v[48:51], v[96:99]
s_waitcnt lgkmcnt(2)
buffer_load_dwordx4 a[68:71], v1, s[44:47], s69 offen offset:1024 sc1
v_exp_f32 v16, v80
v_mfma_f32_16x16x32_bf16 v[100:103], a[72:75], v[52:55], v[100:103]
s_waitcnt lgkmcnt(1)
ds_read_b128 v[32:35], v2 offset:2080
v_exp_f32 v17, v81
v_mfma_f32_16x16x32_bf16 v[104:107], a[72:75], v[56:59], v[104:107]
s_waitcnt lgkmcnt(1)
ds_read_b128 v[36:39], v2 offset:10400
v_add_f32 v8, v8, v14
v_cvt_pk_bf16_f32 v21, v14, v15
v_mfma_f32_16x16x32_bf16 v[108:111], a[72:75], v[60:63], v[108:111]
s_waitcnt vmcnt(14)
ds_read_b128 v[40:43], v2 offset:18720
v_add_f32 v8, v8, v15
v_exp_f32 v18, v82
v_mfma_f32_16x16x32_bf16 v[112:115], a[76:79], v[48:51], v[112:115]
buffer_load_dwordx4 a[72:75], v1, s[44:47], s69 offen offset:2048 sc1
v_mfma_f32_16x16x32_bf16 v[116:119], a[76:79], v[52:55], v[116:119]
ds_read_b128 v[44:47], v2 offset:27040
v_mfma_f32_16x16x32_bf16 v[120:123], a[76:79], v[56:59], v[120:123]
v_exp_f32 v19, v83
v_mfma_f32_16x16x32_bf16 v[124:127], a[76:79], v[60:63], v[124:127]
s_waitcnt vmcnt(14) lgkmcnt(3)
v_add_f32 v8, v8, v16
v_cvt_pk_bf16_f32 v22, v16, v17
v_mfma_f32_16x16x32_bf16 v[96:99], a[80:83], v[32:35], v[96:99]
s_waitcnt lgkmcnt(2)
buffer_load_dwordx4 a[76:79], v1, s[44:47], s69 offen offset:3072 sc1
v_mfma_f32_16x16x32_bf16 v[100:103], a[80:83], v[36:39], v[100:103]
s_waitcnt lgkmcnt(1)
ds_read_b128 v[48:51], v2 offset:3120
v_add_f32 v8, v8, v17
v_mfma_f32_16x16x32_bf16 v[104:107], a[80:83], v[40:43], v[104:107]
s_waitcnt lgkmcnt(1)
ds_read_b128 v[52:55], v2 offset:11440
v_mfma_f32_16x16x32_bf16 v[108:111], a[80:83], v[44:47], v[108:111]
s_waitcnt vmcnt(14)
ds_read_b128 v[56:59], v2 offset:19760
v_exp_f32 v12, v68
v_mfma_f32_16x16x32_bf16 v[112:115], a[84:87], v[32:35], v[112:115]
s_add_u32 s69, s69, 4096
buffer_load_dwordx4 a[80:83], v1, s[44:47], s69 offen offset:0 sc1
v_mfma_f32_16x16x32_bf16 v[116:119], a[84:87], v[36:39], v[116:119]
ds_read_b128 v[60:63], v2 offset:28080
v_mfma_f32_16x16x32_bf16 v[120:123], a[84:87], v[40:43], v[120:123]
v_exp_f32 v13, v69
v_mfma_f32_16x16x32_bf16 v[124:127], a[84:87], v[44:47], v[124:127]
s_waitcnt vmcnt(14) lgkmcnt(3)
v_add_f32 v8, v8, v18
v_cvt_pk_bf16_f32 v23, v18, v19
v_mfma_f32_16x16x32_bf16 v[96:99], a[88:91], v[48:51], v[96:99]
s_waitcnt lgkmcnt(2)
buffer_load_dwordx4 a[84:87], v1, s[44:47], s69 offen offset:1024 sc1
v_mfma_f32_16x16x32_bf16 v[100:103], a[88:91], v[52:55], v[100:103]
s_waitcnt lgkmcnt(1)
ds_read_b128 v[32:35], v2 offset:4160
v_add_f32 v8, v8, v19
v_mfma_f32_16x16x32_bf16 v[104:107], a[88:91], v[56:59], v[104:107]
s_waitcnt lgkmcnt(1)
ds_read_b128 v[36:39], v2 offset:12480
v_exp_f32 v14, v70
v_mfma_f32_16x16x32_bf16 v[108:111], a[88:91], v[60:63], v[108:111]
s_waitcnt vmcnt(14)
ds_read_b128 v[40:43], v2 offset:20800
v_mfma_f32_16x16x32_bf16 v[112:115], a[92:95], v[48:51], v[112:115]
buffer_load_dwordx4 a[88:91], v1, s[44:47], s69 offen offset:2048 sc1
v_mfma_f32_16x16x32_bf16 v[116:119], a[92:95], v[52:55], v[116:119]
ds_read_b128 v[44:47], v2 offset:29120
v_mfma_f32_16x16x32_bf16 v[120:123], a[92:95], v[56:59], v[120:123]
ds_write_b128 v4, v[20:23] offset:0
v_mfma_f32_16x16x32_bf16 v[124:127], a[92:95], v[60:63], v[124:127]
s_waitcnt vmcnt(14) lgkmcnt(4)
v_exp_f32 v15, v71
v_add_f32 v9, v9, v12
v_mfma_f32_16x16x32_bf16 v[96:99], a[96:99], v[32:35], v[96:99]
s_waitcnt lgkmcnt(3)
buffer_load_dwordx4 a[92:95], v1, s[44:47], s69 offen offset:3072 sc1
v_cvt_pk_bf16_f32 v24, v12, v13
v_mfma_f32_16x16x32_bf16 v[100:103], a[96:99], v[36:39], v[100:103]
s_waitcnt lgkmcnt(2)
ds_read_b128 v[48:51], v2 offset:5200
v_add_f32 v9, v9, v13
v_mfma_f32_16x16x32_bf16 v[104:107], a[96:99], v[40:43], v[104:107]
s_waitcnt lgkmcnt(2)
ds_read_b128 v[52:55], v2 offset:13520
v_exp_f32 v16, v84
v_mfma_f32_16x16x32_bf16 v[108:111], a[96:99], v[44:47], v[108:111]
s_waitcnt vmcnt(14)
ds_read_b128 v[56:59], v2 offset:21840
v_mfma_f32_16x16x32_bf16 v[112:115], a[100:103], v[32:35], v[112:115]
s_add_u32 s69, s69, 4096
buffer_load_dwordx4 a[96:99], v1, s[44:47], s69 offen offset:0 sc1
v_mfma_f32_16x16x32_bf16 v[116:119], a[100:103], v[36:39], v[116:119]
ds_read_b128 v[60:63], v2 offset:30160
v_exp_f32 v17, v85
v_mfma_f32_16x16x32_bf16 v[120:123], a[100:103], v[40:43], v[120:123]
v_add_f32 v9, v9, v14
v_cvt_pk_bf16_f32 v25, v14, v15
v_mfma_f32_16x16x32_bf16 v[124:127], a[100:103], v[44:47], v[124:127]
s_waitcnt vmcnt(14) lgkmcnt(3)
v_add_f32 v9, v9, v15
v_mfma_f32_16x16x32_bf16 v[96:99], a[104:107], v[48:51], v[96:99]
s_waitcnt lgkmcnt(2)
buffer_load_dwordx4 a[100:103], v1, s[44:47], s69 offen offset:1024 sc1
v_mfma_f32_16x16x32_bf16 v[100:103], a[104:107], v[52:55], v[100:103]
s_waitcnt lgkmcnt(1)
ds_read_b128 v[32:35], v2 offset:6240
v_mfma_f32_16x16x32_bf16 v[104:107], a[104:107], v[56:59], v[104:107]
s_waitcnt lgkmcnt(1)
ds_read_b128 v[36:39], v2 offset:14560
v_exp_f32 v18, v86
v_mfma_f32_16x16x32_bf16 v[108:111], a[104:107], v[60:63], v[108:111]
s_waitcnt vmcnt(14)
ds_read_b128 v[40:43], v2 offset:22880
v_mfma_f32_16x16x32_bf16 v[112:115], a[108:111], v[48:51], v[112:115]
buffer_load_dwordx4 a[104:107], v1, s[44:47], s69 offen offset:2048 sc1
v_mfma_f32_16x16x32_bf16 v[116:119], a[108:111], v[52:55], v[116:119]
ds_read_b128 v[44:47], v2 offset:31200
v_exp_f32 v19, v87
v_mfma_f32_16x16x32_bf16 v[120:123], a[108:111], v[56:59], v[120:123]
v_add_f32 v9, v9, v16
v_cvt_pk_bf16_f32 v26, v16, v17
v_mfma_f32_16x16x32_bf16 v[124:127], a[108:111], v[60:63], v[124:127]
s_waitcnt vmcnt(14) lgkmcnt(3)
v_add_f32 v9, v9, v17
v_mfma_f32_16x16x32_bf16 v[96:99], a[112:115], v[32:35], v[96:99]
s_waitcnt lgkmcnt(2)
buffer_load_dwordx4 a[108:111], v1, s[44:47], s69 offen offset:3072 sc1
v_mfma_f32_16x16x32_bf16 v[100:103], a[112:115], v[36:39], v[100:103]
s_waitcnt lgkmcnt(1)
ds_read_b128 v[48:51], v2 offset:7280
v_exp_f32 v12, v72
v_mfma_f32_16x16x32_bf16 v[104:107], a[112:115], v[40:43], v[104:107]
s_waitcnt lgkmcnt(1)
ds_read_b128 v[52:55], v2 offset:15600
v_mfma_f32_16x16x32_bf16 v[108:111], a[112:115], v[44:47], v[108:111]
s_waitcnt vmcnt(14)
ds_read_b128 v[56:59], v2 offset:23920
v_mfma_f32_16x16x32_bf16 v[112:115], a[116:119], v[32:35], v[112:115]
s_add_u32 s69, s69, 4096
buffer_load_dwordx4 a[112:115], v1, s[44:47], s69 offen offset:0 sc1
v_mfma_f32_16x16x32_bf16 v[116:119], a[116:119], v[36:39], v[116:119]
ds_read_b128 v[60:63], v2 offset:32240
v_exp_f32 v13, v73
v_mfma_f32_16x16x32_bf16 v[120:123], a[116:119], v[40:43], v[120:123]
v_add_f32 v9, v9, v18
v_cvt_pk_bf16_f32 v27, v18, v19
v_mfma_f32_16x16x32_bf16 v[124:127], a[116:119], v[44:47], v[124:127]
s_waitcnt vmcnt(14) lgkmcnt(3)
v_add_f32 v9, v9, v19
v_mfma_f32_16x16x32_bf16 v[96:99], a[120:123], v[48:51], v[96:99]
s_waitcnt lgkmcnt(2)
buffer_load_dwordx4 a[116:119], v1, s[44:47], s69 offen offset:1024 sc1
v_mfma_f32_16x16x32_bf16 v[100:103], a[120:123], v[52:55], v[100:103]
s_waitcnt lgkmcnt(1)
ds_read_b128 v[32:35], v3 offset:0
v_exp_f32 v14, v74
v_mfma_f32_16x16x32_bf16 v[104:107], a[120:123], v[56:59], v[104:107]
s_waitcnt lgkmcnt(1)
ds_read_b128 v[36:39], v3 offset:1024
v_mfma_f32_16x16x32_bf16 v[108:111], a[120:123], v[60:63], v[108:111]
s_waitcnt vmcnt(14)
ds_read_b128 v[40:43], v3 offset:2048
v_exp_f32 v15, v75
v_mfma_f32_16x16x32_bf16 v[112:115], a[124:127], v[48:51], v[112:115]
buffer_load_dwordx4 a[120:123], v1, s[44:47], s69 offen offset:2048 sc1
v_mfma_f32_16x16x32_bf16 v[116:119], a[124:127], v[52:55], v[116:119]
ds_read_b128 v[44:47], v3 offset:3072
v_mfma_f32_16x16x32_bf16 v[120:123], a[124:127], v[56:59], v[120:123]
ds_write_b128 v4, v[24:27] offset:1024
v_mfma_f32_16x16x32_bf16 v[124:127], a[124:127], v[60:63], v[124:127]
s_waitcnt vmcnt(14) lgkmcnt(4)
v_add_f32 v10, v10, v12
v_cvt_pk_bf16_f32 v28, v12, v13
v_add_f32 v10, v10, v13
v_mfma_f32_16x16x32_bf16 a[0:3], a[64:67], v[32:35], a[0:3]
s_waitcnt lgkmcnt(3)
buffer_load_dwordx4 a[124:127], v1, s[44:47], s69 offen offset:3072 sc1
v_exp_f32 v16, v88
v_mfma_f32_16x16x32_bf16 a[4:7], a[64:67], v[36:39], a[4:7]
s_waitcnt lgkmcnt(2)
ds_read_b128 v[48:51], v3 offset:4096
v_exp_f32 v17, v89
v_mfma_f32_16x16x32_bf16 a[8:11], a[64:67], v[40:43], a[8:11]
s_waitcnt lgkmcnt(2)
ds_read_b128 v[52:55], v3 offset:5120
v_add_f32 v10, v10, v14
v_cvt_pk_bf16_f32 v29, v14, v15
v_mfma_f32_16x16x32_bf16 a[12:15], a[64:67], v[44:47], a[12:15]
s_waitcnt vmcnt(14)
v_add_f32 v10, v10, v15
v_exp_f32 v18, v90
v_mfma_f32_16x16x32_bf16 a[16:19], a[68:71], v[32:35], a[16:19]
s_add_u32 s69, s69, 4096
buffer_load_dwordx4 a[64:67], v1, s[44:47], s69 offen offset:0 sc1
v_exp_f32 v19, v91
v_mfma_f32_16x16x32_bf16 a[20:23], a[68:71], v[36:39], a[20:23]
ds_read_b128 v[56:59], v3 offset:6144
v_add_f32 v10, v10, v16
v_cvt_pk_bf16_f32 v30, v16, v17
v_mfma_f32_16x16x32_bf16 a[24:27], a[68:71], v[40:43], a[24:27]
ds_read_b128 v[60:63], v3 offset:7168
v_add_f32 v10, v10, v17
v_mfma_f32_16x16x32_bf16 a[28:31], a[68:71], v[44:47], a[28:31]
s_waitcnt vmcnt(14)
v_exp_f32 v12, v76
v_mfma_f32_16x16x32_bf16 a[32:35], a[72:75], v[32:35], a[32:35]
buffer_load_dwordx4 a[68:71], v1, s[44:47], s69 offen offset:1024 sc1
v_mfma_f32_16x16x32_bf16 a[36:39], a[72:75], v[36:39], a[36:39]
v_exp_f32 v13, v77
v_mfma_f32_16x16x32_bf16 a[40:43], a[72:75], v[40:43], a[40:43]
v_add_f32 v10, v10, v18
v_cvt_pk_bf16_f32 v31, v18, v19
v_mfma_f32_16x16x32_bf16 a[44:47], a[72:75], v[44:47], a[44:47]
s_waitcnt vmcnt(14)
s_lshl_b32 s92, s67, 3
s_lshr_b64 s[76:77], s[34:35], s92
s_and_b32 s92, s76, 0xff
ds_read_b32 v6, v0 offset:2048
v_add_f32 v10, v10, v19
v_mfma_f32_16x16x32_bf16 a[48:51], a[76:79], v[32:35], a[48:51]
buffer_load_dwordx4 a[72:75], v1, s[44:47], s69 offen offset:2048 sc1
v_mfma_f32_16x16x32_bf16 a[52:55], a[76:79], v[36:39], a[52:55]
ds_write_b128 v4, v[28:31] offset:2048
v_mfma_f32_16x16x32_bf16 a[56:59], a[76:79], v[40:43], a[56:59]
v_exp_f32 v14, v78
v_exp_f32 v15, v79
v_mfma_f32_16x16x32_bf16 a[60:63], a[76:79], v[44:47], a[60:63]
s_waitcnt vmcnt(14) lgkmcnt(5)
v_add_f32 v11, v11, v12
v_cvt_pk_bf16_f32 v20, v12, v13
v_mfma_f32_16x16x32_bf16 a[0:3], a[80:83], v[48:51], a[0:3]
s_waitcnt lgkmcnt(4)
buffer_load_dwordx4 a[76:79], v1, s[44:47], s69 offen offset:3072 sc1
v_mfma_f32_16x16x32_bf16 a[4:7], a[80:83], v[52:55], a[4:7]
s_waitcnt lgkmcnt(3)
ds_read_b128 v[32:35], v3 offset:8192
v_mfma_f32_16x16x32_bf16 a[8:11], a[80:83], v[56:59], a[8:11]
s_waitcnt lgkmcnt(3)
ds_read_b128 v[36:39], v3 offset:9216
v_add_f32 v11, v11, v13
v_mfma_f32_16x16x32_bf16 a[12:15], a[80:83], v[60:63], a[12:15]
s_waitcnt vmcnt(14)
v_exp_f32 v16, v92
v_mfma_f32_16x16x32_bf16 a[16:19], a[84:87], v[48:51], a[16:19]
s_add_u32 s69, s69, 4096
buffer_load_dwordx4 a[80:83], v1, s[44:47], s69 offen offset:0 sc1
v_mfma_f32_16x16x32_bf16 a[20:23], a[84:87], v[52:55], a[20:23]
ds_read_b128 v[40:43], v3 offset:10240
v_exp_f32 v17, v93
v_mfma_f32_16x16x32_bf16 a[24:27], a[84:87], v[56:59], a[24:27]
ds_read_b128 v[44:47], v3 offset:11264
v_mfma_f32_16x16x32_bf16 a[28:31], a[84:87], v[60:63], a[28:31]
s_waitcnt vmcnt(14)
v_add_f32 v11, v11, v14
v_cvt_pk_bf16_f32 v21, v14, v15
v_mfma_f32_16x16x32_bf16 a[32:35], a[88:91], v[48:51], a[32:35]
buffer_load_dwordx4 a[84:87], v1, s[44:47], s69 offen offset:1024 sc1
v_mfma_f32_16x16x32_bf16 a[36:39], a[88:91], v[52:55], a[36:39]
v_add_f32 v11, v11, v15
v_exp_f32 v18, v94
v_mfma_f32_16x16x32_bf16 a[40:43], a[88:91], v[56:59], a[40:43]
v_exp_f32 v19, v95
v_mfma_f32_16x16x32_bf16 a[44:47], a[88:91], v[60:63], a[44:47]
s_waitcnt vmcnt(14)
v_add_f32 v11, v11, v16
v_cvt_pk_bf16_f32 v22, v16, v17
v_mfma_f32_16x16x32_bf16 a[48:51], a[92:95], v[48:51], a[48:51]
buffer_load_dwordx4 a[88:91], v1, s[44:47], s69 offen offset:2048 sc1
v_mfma_f32_16x16x32_bf16 a[52:55], a[92:95], v[52:55], a[52:55]
v_add_f32 v11, v11, v17
v_mfma_f32_16x16x32_bf16 a[56:59], a[92:95], v[56:59], a[56:59]
v_exp_f32 v12, v96
v_mfma_f32_16x16x32_bf16 a[60:63], a[92:95], v[60:63], a[60:63]
s_waitcnt vmcnt(14) lgkmcnt(3)
v_exp_f32 v13, v97
v_mfma_f32_16x16x32_bf16 a[0:3], a[96:99], v[32:35], a[0:3]
s_waitcnt lgkmcnt(2)
buffer_load_dwordx4 a[92:95], v1, s[44:47], s69 offen offset:3072 sc1
v_mfma_f32_16x16x32_bf16 a[4:7], a[96:99], v[36:39], a[4:7]
s_waitcnt lgkmcnt(1)
ds_read_b128 v[48:51], v3 offset:12288
v_add_f32 v11, v11, v18
v_mfma_f32_16x16x32_bf16 a[8:11], a[96:99], v[40:43], a[8:11]
s_waitcnt lgkmcnt(1)
ds_read_b128 v[52:55], v3 offset:13312
v_mfma_f32_16x16x32_bf16 a[12:15], a[96:99], v[44:47], a[12:15]
s_waitcnt vmcnt(14)
v_cvt_pk_bf16_f32 v23, v18, v19
v_add_f32 v11, v11, v19
v_mfma_f32_16x16x32_bf16 a[16:19], a[100:103], v[32:35], a[16:19]
s_add_u32 s69, s69, 4096
buffer_load_dwordx4 a[96:99], v1, s[44:47], s69 offen offset:0 sc1
v_mfma_f32_16x16x32_bf16 a[20:23], a[100:103], v[36:39], a[20:23]
ds_read_b128 v[56:59], v3 offset:14336
v_exp_f32 v14, v98
v_mfma_f32_16x16x32_bf16 a[24:27], a[100:103], v[40:43], a[24:27]
ds_read_b128 v[60:63], v3 offset:15360
v_mfma_f32_16x16x32_bf16 a[28:31], a[100:103], v[44:47], a[28:31]
s_waitcnt vmcnt(14)
ds_write_b128 v4, v[20:23] offset:3072
v_mfma_f32_16x16x32_bf16 a[32:35], a[104:107], v[32:35], a[32:35]
buffer_load_dwordx4 a[100:103], v1, s[44:47], s69 offen offset:1024 sc1
v_exp_f32 v15, v99
v_mfma_f32_16x16x32_bf16 a[36:39], a[104:107], v[36:39], a[36:39]
v_add_f32 v8, v8, v12
v_cvt_pk_bf16_f32 v24, v12, v13
v_mfma_f32_16x16x32_bf16 a[40:43], a[104:107], v[40:43], a[40:43]
v_add_f32 v8, v8, v13
v_exp_f32 v16, v112
v_mfma_f32_16x16x32_bf16 a[44:47], a[104:107], v[44:47], a[44:47]
s_waitcnt vmcnt(14)
v_exp_f32 v17, v113
v_mfma_f32_16x16x32_bf16 a[48:51], a[108:111], v[32:35], a[48:51]
buffer_load_dwordx4 a[104:107], v1, s[44:47], s69 offen offset:2048 sc1
v_mfma_f32_16x16x32_bf16 a[52:55], a[108:111], v[36:39], a[52:55]
v_add_f32 v8, v8, v14
v_cvt_pk_bf16_f32 v25, v14, v15
v_mfma_f32_16x16x32_bf16 a[56:59], a[108:111], v[40:43], a[56:59]
v_add_f32 v8, v8, v15
v_mfma_f32_16x16x32_bf16 a[60:63], a[108:111], v[44:47], a[60:63]
s_waitcnt vmcnt(14) lgkmcnt(4)
v_exp_f32 v18, v114
v_mfma_f32_16x16x32_bf16 a[0:3], a[112:115], v[48:51], a[0:3]
s_waitcnt lgkmcnt(3)
buffer_load_dwordx4 a[108:111], v1, s[44:47], s69 offen offset:3072 sc1
v_mfma_f32_16x16x32_bf16 a[4:7], a[112:115], v[52:55], a[4:7]
s_waitcnt lgkmcnt(2)
ds_read_b128 v[32:35], v3 offset:16384
v_mfma_f32_16x16x32_bf16 a[8:11], a[112:115], v[56:59], a[8:11]
s_waitcnt lgkmcnt(2)
ds_read_b128 v[36:39], v3 offset:17408
v_exp_f32 v19, v115
v_mfma_f32_16x16x32_bf16 a[12:15], a[112:115], v[60:63], a[12:15]
s_waitcnt vmcnt(14)
v_cmp_gt_u32 vcc, s92, v6
s_cbranch_vccnz L_spin_tb_f
L_back_tb_f:
v_mfma_f32_16x16x32_bf16 a[16:19], a[116:119], v[48:51], a[16:19]
s_add_u32 s69, s69, 4096
buffer_load_dwordx4 a[112:115], v1, s[44:47], s69 offen offset:0 sc1
v_mfma_f32_16x16x32_bf16 a[20:23], a[116:119], v[52:55], a[20:23]
ds_read_b128 v[40:43], v3 offset:18432
v_mfma_f32_16x16x32_bf16 a[24:27], a[116:119], v[56:59], a[24:27]
ds_read_b128 v[44:47], v3 offset:19456
v_add_f32 v8, v8, v16
v_mfma_f32_16x16x32_bf16 a[28:31], a[116:119], v[60:63], a[28:31]
s_waitcnt vmcnt(14)
v_cvt_pk_bf16_f32 v26, v16, v17
v_add_f32 v8, v8, v17
v_mfma_f32_16x16x32_bf16 a[32:35], a[120:123], v[48:51], a[32:35]
buffer_load_dwordx4 a[116:119], v1, s[44:47], s69 offen offset:1024 sc1
v_mfma_f32_16x16x32_bf16 a[36:39], a[120:123], v[52:55], a[36:39]
v_exp_f32 v12, v100
v_mfma_f32_16x16x32_bf16 a[40:43], a[120:123], v[56:59], a[40:43]
v_exp_f32 v13, v101
v_mfma_f32_16x16x32_bf16 a[44:47], a[120:123], v[60:63], a[44:47]
s_waitcnt vmcnt(14)
v_add_f32 v8, v8, v18
v_cvt_pk_bf16_f32 v27, v18, v19
v_mfma_f32_16x16x32_bf16 a[48:51], a[124:127], v[48:51], a[48:51]
buffer_load_dwordx4 a[120:123], v1, s[44:47], s69 offen offset:2048 sc1
v_mfma_f32_16x16x32_bf16 a[52:55], a[124:127], v[52:55], a[52:55]
v_add_f32 v8, v8, v19
v_exp_f32 v14, v102
v_mfma_f32_16x16x32_bf16 a[56:59], a[124:127], v[56:59], a[56:59]
ds_write_b128 v4, v[24:27] offset:4096
v_mfma_f32_16x16x32_bf16 a[60:63], a[124:127], v[60:63], a[60:63]
s_waitcnt vmcnt(14) lgkmcnt(4)
v_exp_f32 v15, v103
v_add_f32 v9, v9, v12
v_mfma_f32_16x16x32_bf16 a[0:3], a[64:67], v[32:35], a[0:3]
s_waitcnt lgkmcnt(3)
buffer_load_dwordx4 a[124:127], v1, s[44:47], s69 offen offset:3072 sc1
v_mfma_f32_16x16x32_bf16 a[4:7], a[64:67], v[36:39], a[4:7]
s_waitcnt lgkmcnt(2)
ds_read_b128 v[48:51], v3 offset:20480
v_cvt_pk_bf16_f32 v28, v12, v13
v_mfma_f32_16x16x32_bf16 a[8:11], a[64:67], v[40:43], a[8:11]
s_waitcnt lgkmcnt(2)
ds_read_b128 v[52:55], v3 offset:21504
v_mfma_f32_16x16x32_bf16 a[12:15], a[64:67], v[44:47], a[12:15]
s_waitcnt vmcnt(14)
v_add_f32 v9, v9, v13
v_exp_f32 v16, v116
v_mfma_f32_16x16x32_bf16 a[16:19], a[68:71], v[32:35], a[16:19]
s_sub_u32 s70, s67, s93
s_mov_b32 s71, 233472
s_cmp_lt_u32 s70, 7
s_cselect_b32 s70, s71, 102400
s_add_u32 s68, s68, s70
buffer_load_dwordx4 a[64:67], v1, s[44:47], s68 offen offset:0 sc1
v_mfma_f32_16x16x32_bf16 a[20:23], a[68:71], v[36:39], a[20:23]
ds_read_b128 v[56:59], v3 offset:22528
v_mfma_f32_16x16x32_bf16 a[24:27], a[68:71], v[40:43], a[24:27]
ds_read_b128 v[60:63], v3 offset:23552
v_exp_f32 v17, v117
v_mfma_f32_16x16x32_bf16 a[28:31], a[68:71], v[44:47], a[28:31]
s_waitcnt vmcnt(14)
v_add_f32 v9, v9, v14
v_cvt_pk_bf16_f32 v29, v14, v15
v_mfma_f32_16x16x32_bf16 a[32:35], a[72:75], v[32:35], a[32:35]
buffer_load_dwordx4 a[68:71], v1, s[44:47], s68 offen offset:1024 sc1
v_mfma_f32_16x16x32_bf16 a[36:39], a[72:75], v[36:39], a[36:39]
v_add_f32 v9, v9, v15
v_mfma_f32_16x16x32_bf16 a[40:43], a[72:75], v[40:43], a[40:43]
v_exp_f32 v18, v118
v_mfma_f32_16x16x32_bf16 a[44:47], a[72:75], v[44:47], a[44:47]
s_waitcnt vmcnt(14)
v_exp_f32 v19, v119
v_mfma_f32_16x16x32_bf16 a[48:51], a[76:79], v[32:35], a[48:51]
buffer_load_dwordx4 a[72:75], v1, s[44:47], s68 offen offset:2048 sc1
v_mfma_f32_16x16x32_bf16 a[52:55], a[76:79], v[36:39], a[52:55]
v_add_f32 v9, v9, v16
v_cvt_pk_bf16_f32 v30, v16, v17
v_mfma_f32_16x16x32_bf16 a[56:59], a[76:79], v[40:43], a[56:59]
v_add_f32 v9, v9, v17
v_exp_f32 v12, v104
v_mfma_f32_16x16x32_bf16 a[60:63], a[76:79], v[44:47], a[60:63]
s_waitcnt vmcnt(14) lgkmcnt(3)
v_exp_f32 v13, v105
v_mfma_f32_16x16x32_bf16 a[0:3], a[80:83], v[48:51], a[0:3]
s_waitcnt lgkmcnt(2)
buffer_load_dwordx4 a[76:79], v1, s[44:47], s68 offen offset:3072 sc1
v_mfma_f32_16x16x32_bf16 a[4:7], a[80:83], v[52:55], a[4:7]
s_waitcnt lgkmcnt(1)
ds_read_b128 v[32:35], v3 offset:24576
v_mfma_f32_16x16x32_bf16 a[8:11], a[80:83], v[56:59], a[8:11]
s_waitcnt lgkmcnt(1)
ds_read_b128 v[36:39], v3 offset:25600
v_mfma_f32_16x16x32_bf16 a[12:15], a[80:83], v[60:63], a[12:15]
s_waitcnt vmcnt(14)
v_add_f32 v9, v9, v18
v_cvt_pk_bf16_f32 v31, v18, v19
v_mfma_f32_16x16x32_bf16 a[16:19], a[84:87], v[48:51], a[16:19]
s_add_u32 s68, s68, 4096
buffer_load_dwordx4 a[80:83], v1, s[44:47], s68 offen offset:0 sc1
v_mfma_f32_16x16x32_bf16 a[20:23], a[84:87], v[52:55], a[20:23]
ds_read_b128 v[40:43], v3 offset:26624
v_add_f32 v9, v9, v19
v_mfma_f32_16x16x32_bf16 a[24:27], a[84:87], v[56:59], a[24:27]
ds_read_b128 v[44:47], v3 offset:27648
v_exp_f32 v14, v106
v_mfma_f32_16x16x32_bf16 a[28:31], a[84:87], v[60:63], a[28:31]
s_waitcnt vmcnt(14)
ds_write_b128 v4, v[28:31] offset:5120
v_mfma_f32_16x16x32_bf16 a[32:35], a[88:91], v[48:51], a[32:35]
buffer_load_dwordx4 a[84:87], v1, s[44:47], s68 offen offset:1024 sc1
v_exp_f32 v15, v107
v_mfma_f32_16x16x32_bf16 a[36:39], a[88:91], v[52:55], a[36:39]
v_add_f32 v10, v10, v12
v_cvt_pk_bf16_f32 v20, v12, v13
v_mfma_f32_16x16x32_bf16 a[40:43], a[88:91], v[56:59], a[40:43]
v_add_f32 v10, v10, v13
v_mfma_f32_16x16x32_bf16 a[44:47], a[88:91], v[60:63], a[44:47]
s_waitcnt vmcnt(14)
v_exp_f32 v16, v120
v_mfma_f32_16x16x32_bf16 a[48:51], a[92:95], v[48:51], a[48:51]
buffer_load_dwordx4 a[88:91], v1, s[44:47], s68 offen offset:2048 sc1
v_mfma_f32_16x16x32_bf16 a[52:55], a[92:95], v[52:55], a[52:55]
v_exp_f32 v17, v121
v_mfma_f32_16x16x32_bf16 a[56:59], a[92:95], v[56:59], a[56:59]
v_add_f32 v10, v10, v14
v_cvt_pk_bf16_f32 v21, v14, v15
v_mfma_f32_16x16x32_bf16 a[60:63], a[92:95], v[60:63], a[60:63]
s_waitcnt vmcnt(14) lgkmcnt(4)
v_add_f32 v10, v10, v15
v_exp_f32 v18, v122
v_mfma_f32_16x16x32_bf16 a[0:3], a[96:99], v[32:35], a[0:3]
s_waitcnt lgkmcnt(3)
buffer_load_dwordx4 a[92:95], v1, s[44:47], s68 offen offset:3072 sc1
v_mfma_f32_16x16x32_bf16 a[4:7], a[96:99], v[36:39], a[4:7]
s_waitcnt lgkmcnt(2)
ds_read_b128 v[48:51], v3 offset:28672
v_mfma_f32_16x16x32_bf16 a[8:11], a[96:99], v[40:43], a[8:11]
s_waitcnt lgkmcnt(2)
ds_read_b128 v[52:55], v3 offset:29696
v_mfma_f32_16x16x32_bf16 a[12:15], a[96:99], v[44:47], a[12:15]
s_waitcnt vmcnt(14)
v_exp_f32 v19, v123
v_mfma_f32_16x16x32_bf16 a[16:19], a[100:103], v[32:35], a[16:19]
s_add_u32 s68, s68, 4096
buffer_load_dwordx4 a[96:99], v1, s[44:47], s68 offen offset:0 sc1
v_mfma_f32_16x16x32_bf16 a[20:23], a[100:103], v[36:39], a[20:23]
ds_read_b128 v[56:59], v3 offset:30720
v_add_f32 v10, v10, v16
v_mfma_f32_16x16x32_bf16 a[24:27], a[100:103], v[40:43], a[24:27]
ds_read_b128 v[60:63], v3 offset:31744
v_cvt_pk_bf16_f32 v22, v16, v17
v_mfma_f32_16x16x32_bf16 a[28:31], a[100:103], v[44:47], a[28:31]
s_waitcnt vmcnt(14)
v_add_f32 v10, v10, v17
v_exp_f32 v12, v108
v_mfma_f32_16x16x32_bf16 a[32:35], a[104:107], v[32:35], a[32:35]
buffer_load_dwordx4 a[100:103], v1, s[44:47], s68 offen offset:1024 sc1
v_mfma_f32_16x16x32_bf16 a[36:39], a[104:107], v[36:39], a[36:39]
v_exp_f32 v13, v109
v_mfma_f32_16x16x32_bf16 a[40:43], a[104:107], v[40:43], a[40:43]
v_add_f32 v10, v10, v18
v_cvt_pk_bf16_f32 v23, v18, v19
v_mfma_f32_16x16x32_bf16 a[44:47], a[104:107], v[44:47], a[44:47]
s_waitcnt vmcnt(14)
v_add_f32 v10, v10, v19
v_mfma_f32_16x16x32_bf16 a[48:51], a[108:111], v[32:35], a[48:51]
buffer_load_dwordx4 a[104:107], v1, s[44:47], s68 offen offset:2048 sc1
v_mfma_f32_16x16x32_bf16 a[52:55], a[108:111], v[36:39], a[52:55]
ds_write_b128 v4, v[20:23] offset:6144
v_mfma_f32_16x16x32_bf16 a[56:59], a[108:111], v[40:43], a[56:59]
v_exp_f32 v14, v110
v_exp_f32 v15, v111
v_mfma_f32_16x16x32_bf16 a[60:63], a[108:111], v[44:47], a[60:63]
s_waitcnt vmcnt(14) lgkmcnt(4)
v_add_f32 v11, v11, v12
v_cvt_pk_bf16_f32 v24, v12, v13
v_mfma_f32_16x16x32_bf16 a[0:3], a[112:115], v[48:51], a[0:3]
s_waitcnt lgkmcnt(3)
buffer_load_dwordx4 a[108:111], v1, s[44:47], s68 offen offset:3072 sc1
v_mfma_f32_16x16x32_bf16 a[4:7], a[112:115], v[52:55], a[4:7]
s_waitcnt lgkmcnt(2)
ds_read_b128 v[32:35], v2 offset:0
v_mfma_f32_16x16x32_bf16 a[8:11], a[112:115], v[56:59], a[8:11]
s_waitcnt lgkmcnt(2)
ds_read_b128 v[36:39], v2 offset:8320
v_add_f32 v11, v11, v13
v_mfma_f32_16x16x32_bf16 a[12:15], a[112:115], v[60:63], a[12:15]
s_waitcnt vmcnt(14)
v_exp_f32 v16, v124
v_mfma_f32_16x16x32_bf16 a[16:19], a[116:119], v[48:51], a[16:19]
s_add_u32 s68, s68, 4096
buffer_load_dwordx4 a[112:115], v1, s[44:47], s68 offen offset:0 sc1
v_mfma_f32_16x16x32_bf16 a[20:23], a[116:119], v[52:55], a[20:23]
ds_read_b128 v[40:43], v2 offset:16640
v_exp_f32 v17, v125
v_mfma_f32_16x16x32_bf16 a[24:27], a[116:119], v[56:59], a[24:27]
ds_read_b128 v[44:47], v2 offset:24960
v_mfma_f32_16x16x32_bf16 a[28:31], a[116:119], v[60:63], a[28:31]
s_waitcnt vmcnt(14)
v_add_f32 v11, v11, v14
v_cvt_pk_bf16_f32 v25, v14, v15
v_mfma_f32_16x16x32_bf16 a[32:35], a[120:123], v[48:51], a[32:35]
buffer_load_dwordx4 a[116:119], v1, s[44:47], s68 offen offset:1024 sc1
v_mfma_f32_16x16x32_bf16 a[36:39], a[120:123], v[52:55], a[36:39]
v_add_f32 v11, v11, v15
v_exp_f32 v18, v126
v_mfma_f32_16x16x32_bf16 a[40:43], a[120:123], v[56:59], a[40:43]
v_exp_f32 v19, v127
v_mfma_f32_16x16x32_bf16 a[44:47], a[120:123], v[60:63], a[44:47]
s_waitcnt vmcnt(14)
v_add_f32 v11, v11, v16
v_cvt_pk_bf16_f32 v26, v16, v17
v_mfma_f32_16x16x32_bf16 a[48:51], a[124:127], v[48:51], a[48:51]
buffer_load_dwordx4 a[120:123], v1, s[44:47], s68 offen offset:2048 sc1
v_mfma_f32_16x16x32_bf16 a[52:55], a[124:127], v[52:55], a[52:55]
v_add_f32 v11, v11, v17
v_add_f32 v11, v11, v18
v_mfma_f32_16x16x32_bf16 a[56:59], a[124:127], v[56:59], a[56:59]
v_cvt_pk_bf16_f32 v27, v18, v19
v_add_f32 v11, v11, v19
v_mfma_f32_16x16x32_bf16 a[60:63], a[124:127], v[60:63], a[60:63]
s_waitcnt vmcnt(14) lgkmcnt(3)
ds_write_b128 v4, v[24:27] offset:7168
s_add_u32 s67, s67, 1
v_mov_b32 v6, s67
ds_write_b32 v5, v6
v_xor_b32 v4, 0x8000, v4
v_xor_b32 v3, 0x8000, v3
s_add_u32 s69, s69, 233472
s_sub_u32 s70, s67, s93
s_cmp_lt_u32 s70, 8
s_cbranch_scc1 L_loop_f
v_mov_b32 v12, v8
v_mov_b32 v13, v9
v_mov_b32 v14, v10
v_mov_b32 v15, v11
s_nop 0
v_permlane32_swap_b32 v8, v12
v_permlane32_swap_b32 v9, v13
v_permlane32_swap_b32 v10, v14
v_permlane32_swap_b32 v11, v15
v_add_f32 v8, v8, v12
v_add_f32 v9, v9, v13
v_add_f32 v10, v10, v14
v_add_f32 v11, v11, v15
v_mov_b32 v12, v8
v_mov_b32 v13, v9
v_mov_b32 v14, v10
v_mov_b32 v15, v11
s_nop 0
v_permlane16_swap_b32 v8, v12
v_permlane16_swap_b32 v9, v13
v_permlane16_swap_b32 v10, v14
v_permlane16_swap_b32 v11, v15
v_add_f32 v8, v8, v12
v_add_f32 v9, v9, v13
v_add_f32 v10, v10, v14
v_add_f32 v11, v11, v15
s_lshl_b32 s70, s64, 10
s_add_u32 s70, s70, 102912
v_lshrrev_b32 v12, 2, v1
v_add_u32 v12, s70, v12
ds_write_b32 v12, v8 offset:0
ds_write_b32 v12, v9 offset:256
ds_write_b32 v12, v10 offset:512
ds_write_b32 v12, v11 offset:768
s_add_u32 s67, s67, 1
v_mov_b32 v6, s67
ds_write_b32 v5, v6
s_waitcnt lgkmcnt(0)
ds_read_b32 v6, v0
v_lshrrev_b32 v13, 4, v1
v_and_b32 v14, 15, v13
v_lshrrev_b32 v13, 4, v13
v_lshlrev_b32 v12, 2, v14
v_add_u32 v12, 102912, v12
s_waitcnt lgkmcnt(0)
v_cmp_gt_u32 vcc, s67, v6
s_cbranch_vccnz L_spin_pt_f
L_back_pt_f:
ds_read_b128 v[32:35], v3 offset:0
ds_read_b128 v[36:39], v3 offset:1024
ds_read_b128 v[40:43], v3 offset:2048
ds_read_b128 v[44:47], v3 offset:3072
s_waitcnt lgkmcnt(3)
v_mfma_f32_16x16x32_bf16 a[0:3], a[64:67], v[32:35], a[0:3]
s_waitcnt lgkmcnt(2)
buffer_load_dwordx4 a[124:127], v1, s[44:47], s68 offen offset:3072 sc1
v_mfma_f32_16x16x32_bf16 a[4:7], a[64:67], v[36:39], a[4:7]
s_waitcnt lgkmcnt(1)
ds_read_b128 v[48:51], v3 offset:4096
v_mfma_f32_16x16x32_bf16 a[8:11], a[64:67], v[40:43], a[8:11]
s_waitcnt lgkmcnt(1)
ds_read_b128 v[52:55], v3 offset:5120
v_mfma_f32_16x16x32_bf16 a[12:15], a[64:67], v[44:47], a[12:15]
s_waitcnt vmcnt(14)
ds_read_b32 v64, v12 offset:0
v_mfma_f32_16x16x32_bf16 a[16:19], a[68:71], v[32:35], a[16:19]
s_add_u32 s68, s68, 4096
buffer_load_dwordx4 a[64:67], v1, s[44:47], s68 offen offset:0 sc1
v_mfma_f32_16x16x32_bf16 a[20:23], a[68:71], v[36:39], a[20:23]
ds_read_b128 v[56:59], v3 offset:6144
v_mfma_f32_16x16x32_bf16 a[24:27], a[68:71], v[40:43], a[24:27]
ds_read_b128 v[60:63], v3 offset:7168
v_mfma_f32_16x16x32_bf16 a[28:31], a[68:71], v[44:47], a[28:31]
s_waitcnt vmcnt(14)
ds_read_b32 v65, v12 offset:1024
v_mfma_f32_16x16x32_bf16 a[32:35], a[72:75], v[32:35], a[32:35]
buffer_load_dwordx4 a[68:71], v1, s[44:47], s68 offen offset:1024 sc1
v_mfma_f32_16x16x32_bf16 a[36:39], a[72:75], v[36:39], a[36:39]
v_mfma_f32_16x16x32_bf16 a[40:43], a[72:75], v[40:43], a[40:43]
v_mfma_f32_16x16x32_bf16 a[44:47], a[72:75], v[44:47], a[44:47]
s_waitcnt vmcnt(14)
ds_read_b32 v66, v12 offset:2048
v_mfma_f32_16x16x32_bf16 a[48:51], a[76:79], v[32:35], a[48:51]
buffer_load_dwordx4 a[72:75], v1, s[44:47], s68 offen offset:2048 sc1
v_mfma_f32_16x16x32_bf16 a[52:55], a[76:79], v[36:39], a[52:55]
v_mfma_f32_16x16x32_bf16 a[56:59], a[76:79], v[40:43], a[56:59]
v_mfma_f32_16x16x32_bf16 a[60:63], a[76:79], v[44:47], a[60:63]
s_waitcnt vmcnt(14) lgkmcnt(6)
ds_read_b32 v67, v12 offset:3072
v_mfma_f32_16x16x32_bf16 a[0:3], a[80:83], v[48:51], a[0:3]
s_waitcnt lgkmcnt(6)
buffer_load_dwordx4 a[76:79], v1, s[44:47], s68 offen offset:3072 sc1
v_mfma_f32_16x16x32_bf16 a[4:7], a[80:83], v[52:55], a[4:7]
s_waitcnt lgkmcnt(4)
ds_read_b128 v[32:35], v3 offset:8192
v_mfma_f32_16x16x32_bf16 a[8:11], a[80:83], v[56:59], a[8:11]
s_waitcnt lgkmcnt(4)
ds_read_b128 v[36:39], v3 offset:9216
v_mfma_f32_16x16x32_bf16 a[12:15], a[80:83], v[60:63], a[12:15]
s_waitcnt vmcnt(14)
ds_read_b32 v68, v12 offset:256
v_mfma_f32_16x16x32_bf16 a[16:19], a[84:87], v[48:51], a[16:19]
s_add_u32 s68, s68, 4096
buffer_load_dwordx4 a[80:83], v1, s[44:47], s68 offen offset:0 sc1
v_mfma_f32_16x16x32_bf16 a[20:23], a[84:87], v[52:55], a[20:23]
ds_read_b128 v[40:43], v3 offset:10240
v_mfma_f32_16x16x32_bf16 a[24:27], a[84:87], v[56:59], a[24:27]
ds_read_b128 v[44:47], v3 offset:11264
v_mfma_f32_16x16x32_bf16 a[28:31], a[84:87], v[60:63], a[28:31]
s_waitcnt vmcnt(14)
ds_read_b32 v69, v12 offset:1280
v_mfma_f32_16x16x32_bf16 a[32:35], a[88:91], v[48:51], a[32:35]
buffer_load_dwordx4 a[84:87], v1, s[44:47], s68 offen offset:1024 sc1
v_mfma_f32_16x16x32_bf16 a[36:39], a[88:91], v[52:55], a[36:39]
v_mfma_f32_16x16x32_bf16 a[40:43], a[88:91], v[56:59], a[40:43]
v_mfma_f32_16x16x32_bf16 a[44:47], a[88:91], v[60:63], a[44:47]
s_waitcnt vmcnt(14)
ds_read_b32 v70, v12 offset:2304
v_mfma_f32_16x16x32_bf16 a[48:51], a[92:95], v[48:51], a[48:51]
buffer_load_dwordx4 a[88:91], v1, s[44:47], s68 offen offset:2048 sc1
v_mfma_f32_16x16x32_bf16 a[52:55], a[92:95], v[52:55], a[52:55]
v_mfma_f32_16x16x32_bf16 a[56:59], a[92:95], v[56:59], a[56:59]
v_mfma_f32_16x16x32_bf16 a[60:63], a[92:95], v[60:63], a[60:63]
s_waitcnt vmcnt(14) lgkmcnt(6)
ds_read_b32 v71, v12 offset:3328
v_mfma_f32_16x16x32_bf16 a[0:3], a[96:99], v[32:35], a[0:3]
s_waitcnt lgkmcnt(6)
buffer_load_dwordx4 a[92:95], v1, s[44:47], s68 offen offset:3072 sc1
v_mfma_f32_16x16x32_bf16 a[4:7], a[96:99], v[36:39], a[4:7]
s_waitcnt lgkmcnt(4)
ds_read_b128 v[48:51], v3 offset:12288
v_mfma_f32_16x16x32_bf16 a[8:11], a[96:99], v[40:43], a[8:11]
s_waitcnt lgkmcnt(4)
ds_read_b128 v[52:55], v3 offset:13312
v_mfma_f32_16x16x32_bf16 a[12:15], a[96:99], v[44:47], a[12:15]
s_waitcnt vmcnt(14)
ds_read_b32 v72, v12 offset:512
v_mfma_f32_16x16x32_bf16 a[16:19], a[100:103], v[32:35], a[16:19]
s_add_u32 s68, s68, 4096
buffer_load_dwordx4 a[96:99], v1, s[44:47], s68 offen offset:0 sc1
v_mfma_f32_16x16x32_bf16 a[20:23], a[100:103], v[36:39], a[20:23]
ds_read_b128 v[56:59], v3 offset:14336
v_mfma_f32_16x16x32_bf16 a[24:27], a[100:103], v[40:43], a[24:27]
ds_read_b128 v[60:63], v3 offset:15360
v_mfma_f32_16x16x32_bf16 a[28:31], a[100:103], v[44:47], a[28:31]
s_waitcnt vmcnt(14)
ds_read_b32 v73, v12 offset:1536
v_mfma_f32_16x16x32_bf16 a[32:35], a[104:107], v[32:35], a[32:35]
buffer_load_dwordx4 a[100:103], v1, s[44:47], s68 offen offset:1024 sc1
v_mfma_f32_16x16x32_bf16 a[36:39], a[104:107], v[36:39], a[36:39]
v_mfma_f32_16x16x32_bf16 a[40:43], a[104:107], v[40:43], a[40:43]
v_mfma_f32_16x16x32_bf16 a[44:47], a[104:107], v[44:47], a[44:47]
s_waitcnt vmcnt(14)
ds_read_b32 v74, v12 offset:2560
v_mfma_f32_16x16x32_bf16 a[48:51], a[108:111], v[32:35], a[48:51]
buffer_load_dwordx4 a[104:107], v1, s[44:47], s68 offen offset:2048 sc1
v_mfma_f32_16x16x32_bf16 a[52:55], a[108:111], v[36:39], a[52:55]
v_mfma_f32_16x16x32_bf16 a[56:59], a[108:111], v[40:43], a[56:59]
v_mfma_f32_16x16x32_bf16 a[60:63], a[108:111], v[44:47], a[60:63]
s_waitcnt vmcnt(14) lgkmcnt(6)
ds_read_b32 v75, v12 offset:3584
v_mfma_f32_16x16x32_bf16 a[0:3], a[112:115], v[48:51], a[0:3]
s_waitcnt lgkmcnt(6)
buffer_load_dwordx4 a[108:111], v1, s[44:47], s68 offen offset:3072 sc1
v_mfma_f32_16x16x32_bf16 a[4:7], a[112:115], v[52:55], a[4:7]
s_waitcnt lgkmcnt(4)
ds_read_b128 v[32:35], v3 offset:16384
v_mfma_f32_16x16x32_bf16 a[8:11], a[112:115], v[56:59], a[8:11]
s_waitcnt lgkmcnt(4)
ds_read_b128 v[36:39], v3 offset:17408
v_mfma_f32_16x16x32_bf16 a[12:15], a[112:115], v[60:63], a[12:15]
s_waitcnt vmcnt(14)
ds_read_b32 v76, v12 offset:768
v_mfma_f32_16x16x32_bf16 a[16:19], a[116:119], v[48:51], a[16:19]
s_add_u32 s68, s68, 4096
buffer_load_dwordx4 a[112:115], v1, s[44:47], s68 offen offset:0 sc1
v_mfma_f32_16x16x32_bf16 a[20:23], a[116:119], v[52:55], a[20:23]
ds_read_b128 v[40:43], v3 offset:18432
v_mfma_f32_16x16x32_bf16 a[24:27], a[116:119], v[56:59], a[24:27]
ds_read_b128 v[44:47], v3 offset:19456
v_mfma_f32_16x16x32_bf16 a[28:31], a[116:119], v[60:63], a[28:31]
s_waitcnt vmcnt(14)
ds_read_b32 v77, v12 offset:1792
v_mfma_f32_16x16x32_bf16 a[32:35], a[120:123], v[48:51], a[32:35]
buffer_load_dwordx4 a[116:119], v1, s[44:47], s68 offen offset:1024 sc1
v_mfma_f32_16x16x32_bf16 a[36:39], a[120:123], v[52:55], a[36:39]
v_mfma_f32_16x16x32_bf16 a[40:43], a[120:123], v[56:59], a[40:43]
v_mfma_f32_16x16x32_bf16 a[44:47], a[120:123], v[60:63], a[44:47]
s_waitcnt vmcnt(14)
ds_read_b32 v78, v12 offset:2816
v_mfma_f32_16x16x32_bf16 a[48:51], a[124:127], v[48:51], a[48:51]
buffer_load_dwordx4 a[120:123], v1, s[44:47], s68 offen offset:2048 sc1
v_mfma_f32_16x16x32_bf16 a[52:55], a[124:127], v[52:55], a[52:55]
v_mfma_f32_16x16x32_bf16 a[56:59], a[124:127], v[56:59], a[56:59]
v_mfma_f32_16x16x32_bf16 a[60:63], a[124:127], v[60:63], a[60:63]
s_waitcnt vmcnt(14) lgkmcnt(6)
ds_read_b32 v79, v12 offset:3840
v_mfma_f32_16x16x32_bf16 a[0:3], a[64:67], v[32:35], a[0:3]
s_waitcnt lgkmcnt(6)
buffer_load_dwordx4 a[124:127], v1, s[44:47], s68 offen offset:3072 sc1
v_mfma_f32_16x16x32_bf16 a[4:7], a[64:67], v[36:39], a[4:7]
s_waitcnt lgkmcnt(4)
ds_read_b128 v[48:51], v3 offset:20480
v_mfma_f32_16x16x32_bf16 a[8:11], a[64:67], v[40:43], a[8:11]
s_waitcnt lgkmcnt(4)
ds_read_b128 v[52:55], v3 offset:21504
v_mfma_f32_16x16x32_bf16 a[12:15], a[64:67], v[44:47], a[12:15]
s_waitcnt vmcnt(14)
v_mfma_f32_16x16x32_bf16 a[16:19], a[68:71], v[32:35], a[16:19]
v_mfma_f32_16x16x32_bf16 a[20:23], a[68:71], v[36:39], a[20:23]
ds_read_b128 v[56:59], v3 offset:22528
v_mfma_f32_16x16x32_bf16 a[24:27], a[68:71], v[40:43], a[24:27]
ds_read_b128 v[60:63], v3 offset:23552
v_mfma_f32_16x16x32_bf16 a[28:31], a[68:71], v[44:47], a[28:31]
s_waitcnt vmcnt(13)
v_mfma_f32_16x16x32_bf16 a[32:35], a[72:75], v[32:35], a[32:35]
v_mfma_f32_16x16x32_bf16 a[36:39], a[72:75], v[36:39], a[36:39]
v_mfma_f32_16x16x32_bf16 a[40:43], a[72:75], v[40:43], a[40:43]
v_mfma_f32_16x16x32_bf16 a[44:47], a[72:75], v[44:47], a[44:47]
s_waitcnt vmcnt(12)
s_waitcnt lgkmcnt(4)
v_add_f32 v64, v64, v65
v_add_f32 v66, v66, v67
v_add_f32 v68, v68, v69
v_add_f32 v70, v70, v71
v_add_f32 v72, v72, v73
v_add_f32 v74, v74, v75
v_add_f32 v76, v76, v77
v_add_f32 v78, v78, v79
v_mfma_f32_16x16x32_bf16 a[48:51], a[76:79], v[32:35], a[48:51]
v_mfma_f32_16x16x32_bf16 a[52:55], a[76:79], v[36:39], a[52:55]
v_mfma_f32_16x16x32_bf16 a[56:59], a[76:79], v[40:43], a[56:59]
v_mfma_f32_16x16x32_bf16 a[60:63], a[76:79], v[44:47], a[60:63]
s_waitcnt vmcnt(11) lgkmcnt(3)
v_add_f32 v80, v64, v66
v_add_f32 v81, v68, v70
v_add_f32 v82, v72, v74
v_add_f32 v83, v76, v78
v_mfma_f32_16x16x32_bf16 a[0:3], a[80:83], v[48:51], a[0:3]
s_waitcnt lgkmcnt(2)
v_mfma_f32_16x16x32_bf16 a[4:7], a[80:83], v[52:55], a[4:7]
s_waitcnt lgkmcnt(1)
ds_read_b128 v[32:35], v3 offset:24576
v_mfma_f32_16x16x32_bf16 a[8:11], a[80:83], v[56:59], a[8:11]
s_waitcnt lgkmcnt(1)
ds_read_b128 v[36:39], v3 offset:25600
v_mfma_f32_16x16x32_bf16 a[12:15], a[80:83], v[60:63], a[12:15]
s_waitcnt vmcnt(10)
s_mov_b32 s70, 0x2f800000
s_mov_b32 s71, 0x4f800000
v_mfma_f32_16x16x32_bf16 a[16:19], a[84:87], v[48:51], a[16:19]
v_mfma_f32_16x16x32_bf16 a[20:23], a[84:87], v[52:55], a[20:23]
ds_read_b128 v[40:43], v3 offset:26624
v_mfma_f32_16x16x32_bf16 a[24:27], a[84:87], v[56:59], a[24:27]
ds_read_b128 v[44:47], v3 offset:27648
v_mfma_f32_16x16x32_bf16 a[28:31], a[84:87], v[60:63], a[28:31]
s_waitcnt vmcnt(9)
v_cmp_lt_f32 vcc, s70, v80
v_cmp_lt_f32_e64 s[76:77], s70, v81
v_cmp_lt_f32_e64 s[78:79], s70, v82
v_cmp_lt_f32_e64 s[74:75], s70, v83
v_mfma_f32_16x16x32_bf16 a[32:35], a[88:91], v[48:51], a[32:35]
v_mfma_f32_16x16x32_bf16 a[36:39], a[88:91], v[52:55], a[36:39]
v_mfma_f32_16x16x32_bf16 a[40:43], a[88:91], v[56:59], a[40:43]
v_mfma_f32_16x16x32_bf16 a[44:47], a[88:91], v[60:63], a[44:47]
s_waitcnt vmcnt(8)
s_and_b64 s[76:77], s[76:77], vcc
s_and_b64 s[74:75], s[74:75], s[78:79]
s_and_b64 s[74:75], s[74:75], s[76:77]
v_mfma_f32_16x16x32_bf16 a[48:51], a[92:95], v[48:51], a[48:51]
v_mfma_f32_16x16x32_bf16 a[52:55], a[92:95], v[52:55], a[52:55]
v_mfma_f32_16x16x32_bf16 a[56:59], a[92:95], v[56:59], a[56:59]
v_mfma_f32_16x16x32_bf16 a[60:63], a[92:95], v[60:63], a[60:63]
s_waitcnt vmcnt(7) lgkmcnt(3)
v_cmp_gt_f32 vcc, s71, v80
v_cmp_gt_f32_e64 s[76:77], s71, v81
v_cmp_gt_f32_e64 s[78:79], s71, v82
v_cmp_gt_f32_e64 s[72:73], s71, v83
v_mfma_f32_16x16x32_bf16 a[0:3], a[96:99], v[32:35], a[0:3]
s_waitcnt lgkmcnt(2)
v_mfma_f32_16x16x32_bf16 a[4:7], a[96:99], v[36:39], a[4:7]
s_waitcnt lgkmcnt(1)
ds_read_b128 v[48:51], v3 offset:28672
v_mfma_f32_16x16x32_bf16 a[8:11], a[96:99], v[40:43], a[8:11]
s_waitcnt lgkmcnt(1)
ds_read_b128 v[52:55], v3 offset:29696
v_mfma_f32_16x16x32_bf16 a[12:15], a[96:99], v[44:47], a[12:15]
s_waitcnt vmcnt(6)
s_and_b64 s[76:77], s[76:77], vcc
s_and_b64 s[78:79], s[78:79], s[72:73]
s_and_b64 s[74:75], s[74:75], s[76:77]
s_and_b64 s[74:75], s[74:75], s[78:79]
v_mfma_f32_16x16x32_bf16 a[16:19], a[100:103], v[32:35], a[16:19]
v_mfma_f32_16x16x32_bf16 a[20:23], a[100:103], v[36:39], a[20:23]
ds_read_b128 v[56:59], v3 offset:30720
v_mfma_f32_16x16x32_bf16 a[24:27], a[100:103], v[40:43], a[24:27]
ds_read_b128 v[60:63], v3 offset:31744
v_mfma_f32_16x16x32_bf16 a[28:31], a[100:103], v[44:47], a[28:31]
s_waitcnt vmcnt(5)
v_rcp_f32 v88, v80
v_rcp_f32 v90, v81
v_rcp_f32 v92, v82
v_rcp_f32 v94, v83
v_mfma_f32_16x16x32_bf16 a[32:35], a[104:107], v[32:35], a[32:35]
v_mfma_f32_16x16x32_bf16 a[36:39], a[104:107], v[36:39], a[36:39]
v_mfma_f32_16x16x32_bf16 a[40:43], a[104:107], v[40:43], a[40:43]
v_mfma_f32_16x16x32_bf16 a[44:47], a[104:107], v[44:47], a[44:47]
s_waitcnt vmcnt(4)
v_mov_b32 v89, v88
v_mov_b32 v91, v90
v_mov_b32 v93, v92
v_mov_b32 v95, v94
v_mfma_f32_16x16x32_bf16 a[48:51], a[108:111], v[32:35], a[48:51]
v_mfma_f32_16x16x32_bf16 a[52:55], a[108:111], v[36:39], a[52:55]
v_mfma_f32_16x16x32_bf16 a[56:59], a[108:111], v[40:43], a[56:59]
v_mfma_f32_16x16x32_bf16 a[60:63], a[108:111], v[44:47], a[60:63]
s_waitcnt vmcnt(3) lgkmcnt(3)
s_lshl_b32 s70, s65, 20
s_add_u32 s48, s38, s70
s_addc_u32 s49, s39, 0
s_and_b32 s49, s49, 0xffff
s_mov_b32 s50, 0x100000
s_mov_b32 s51, 0x20000
v_mfma_f32_16x16x32_bf16 a[0:3], a[112:115], v[48:51], a[0:3]
s_waitcnt lgkmcnt(2)
v_mfma_f32_16x16x32_bf16 a[4:7], a[112:115], v[52:55], a[4:7]
s_waitcnt lgkmcnt(1)
v_mfma_f32_16x16x32_bf16 a[8:11], a[112:115], v[56:59], a[8:11]
s_waitcnt lgkmcnt(0)
v_mfma_f32_16x16x32_bf16 a[12:15], a[112:115], v[60:63], a[12:15]
s_waitcnt vmcnt(2)
s_lshl_b32 s71, s66, 15
s_lshl_b32 s70, s64, 7
s_add_u32 s71, s71, s70
v_mfma_f32_16x16x32_bf16 a[16:19], a[116:119], v[48:51], a[16:19]
v_mfma_f32_16x16x32_bf16 a[20:23], a[116:119], v[52:55], a[20:23]
v_mfma_f32_16x16x32_bf16 a[24:27], a[116:119], v[56:59], a[24:27]
v_mfma_f32_16x16x32_bf16 a[28:31], a[116:119], v[60:63], a[28:31]
s_waitcnt vmcnt(1)
v_mfma_f32_16x16x32_bf16 a[32:35], a[120:123], v[48:51], a[32:35]
v_mfma_f32_16x16x32_bf16 a[36:39], a[120:123], v[52:55], a[36:39]
v_mfma_f32_16x16x32_bf16 a[40:43], a[120:123], v[56:59], a[40:43]
v_mfma_f32_16x16x32_bf16 a[44:47], a[120:123], v[60:63], a[44:47]
s_waitcnt vmcnt(0)
v_mfma_f32_16x16x32_bf16 a[48:51], a[124:127], v[48:51], a[48:51]
v_mfma_f32_16x16x32_bf16 a[52:55], a[124:127], v[52:55], a[52:55]
v_mfma_f32_16x16x32_bf16 a[56:59], a[124:127], v[56:59], a[56:59]
v_mfma_f32_16x16x32_bf16 a[60:63], a[124:127], v[60:63], a[60:63]
s_cmp_eq_u64 s[74:75], -1
s_cbranch_scc0 L_fallback
L_epilogue:
s_nop 7
s_nop 7
s_lshl_b32 s70, s64, 13
v_and_b32 v16, 7, v14
v_lshlrev_b32 v17, 1, v13
v_xor_b32 v16, v16, v17
v_lshlrev_b32 v16, 4, v16
v_lshl_add_u32 v16, v14, 7, v16
v_add_u32 v16, s70, v16
v_xor_b32 v20, 16, v16
v_lshrrev_b32 v17, 4, v1
v_lshrrev_b32 v18, 3, v17
v_and_b32 v17, 7, v17
v_xor_b32 v19, v17, v18
v_lshlrev_b32 v19, 4, v19
v_lshl_add_u32 v19, v18, 7, v19
v_add_u32 v19, s70, v19
v_lshlrev_b32 v15, 9, v18
v_lshl_add_u32 v15, v17, 4, v15
v_accvgpr_read_b32 v40, a0
v_accvgpr_read_b32 v41, a16
v_accvgpr_read_b32 v42, a32
v_accvgpr_read_b32 v43, a48
v_pk_mul_f32 v[40:41], v[40:41], v[88:89]
v_pk_mul_f32 v[42:43], v[42:43], v[88:89]
v_cvt_pk_bf16_f32 v32, v40, v41
v_cvt_pk_bf16_f32 v33, v42, v43
v_accvgpr_read_b32 v44, a1
v_accvgpr_read_b32 v45, a17
v_accvgpr_read_b32 v46, a33
v_accvgpr_read_b32 v47, a49
v_pk_mul_f32 v[44:45], v[44:45], v[88:89]
v_pk_mul_f32 v[46:47], v[46:47], v[88:89]
v_cvt_pk_bf16_f32 v34, v44, v45
v_cvt_pk_bf16_f32 v35, v46, v47
v_accvgpr_read_b32 v40, a2
v_accvgpr_read_b32 v41, a18
v_accvgpr_read_b32 v42, a34
v_accvgpr_read_b32 v43, a50
v_pk_mul_f32 v[40:41], v[40:41], v[88:89]
v_pk_mul_f32 v[42:43], v[42:43], v[88:89]
v_cvt_pk_bf16_f32 v36, v40, v41
v_cvt_pk_bf16_f32 v37, v42, v43
v_accvgpr_read_b32 v44, a3
v_accvgpr_read_b32 v45, a19
v_accvgpr_read_b32 v46, a35
v_accvgpr_read_b32 v47, a51
v_pk_mul_f32 v[44:45], v[44:45], v[88:89]
v_pk_mul_f32 v[46:47], v[46:47], v[88:89]
v_cvt_pk_bf16_f32 v38, v44, v45
v_cvt_pk_bf16_f32 v39, v46, v47
ds_write_b128 v16, v[32:35] offset:0
ds_write_b128 v20, v[36:39] offset:0
v_accvgpr_read_b32 v56, a4
v_accvgpr_read_b32 v57, a20
v_accvgpr_read_b32 v58, a36
v_accvgpr_read_b32 v59, a52
v_pk_mul_f32 v[56:57], v[56:57], v[90:91]
v_pk_mul_f32 v[58:59], v[58:59], v[90:91]
v_cvt_pk_bf16_f32 v48, v56, v57
v_cvt_pk_bf16_f32 v49, v58, v59
v_accvgpr_read_b32 v60, a5
v_accvgpr_read_b32 v61, a21
v_accvgpr_read_b32 v62, a37
v_accvgpr_read_b32 v63, a53
v_pk_mul_f32 v[60:61], v[60:61], v[90:91]
v_pk_mul_f32 v[62:63], v[62:63], v[90:91]
v_cvt_pk_bf16_f32 v50, v60, v61
v_cvt_pk_bf16_f32 v51, v62, v63
v_accvgpr_read_b32 v56, a6
v_accvgpr_read_b32 v57, a22
v_accvgpr_read_b32 v58, a38
v_accvgpr_read_b32 v59, a54
v_pk_mul_f32 v[56:57], v[56:57], v[90:91]
v_pk_mul_f32 v[58:59], v[58:59], v[90:91]
v_cvt_pk_bf16_f32 v52, v56, v57
v_cvt_pk_bf16_f32 v53, v58, v59
v_accvgpr_read_b32 v60, a7
v_accvgpr_read_b32 v61, a23
v_accvgpr_read_b32 v62, a39
v_accvgpr_read_b32 v63, a55
v_pk_mul_f32 v[60:61], v[60:61], v[90:91]
v_pk_mul_f32 v[62:63], v[62:63], v[90:91]
v_cvt_pk_bf16_f32 v54, v60, v61
v_cvt_pk_bf16_f32 v55, v62, v63
ds_write_b128 v16, v[48:51] offset:2048
ds_write_b128 v20, v[52:55] offset:2048
s_waitcnt lgkmcnt(0)
ds_read_b128 v[64:67], v19 offset:0
ds_read_b128 v[68:71], v19 offset:1024
ds_read_b128 v[72:75], v19 offset:2048
ds_read_b128 v[76:79], v19 offset:3072
s_add_u32 s72, s71, 0
s_waitcnt lgkmcnt(3)
buffer_store_dwordx4 v[64:67], v15, s[48:51], s72 offen sc1
s_add_u32 s72, s71, 4096
s_waitcnt lgkmcnt(2)
buffer_store_dwordx4 v[68:71], v15, s[48:51], s72 offen sc1
s_add_u32 s72, s71, 8192
s_waitcnt lgkmcnt(1)
buffer_store_dwordx4 v[72:75], v15, s[48:51], s72 offen sc1
s_add_u32 s72, s71, 12288
s_waitcnt lgkmcnt(0)
buffer_store_dwordx4 v[76:79], v15, s[48:51], s72 offen sc1
v_accvgpr_read_b32 v104, a8
v_accvgpr_read_b32 v105, a24
v_accvgpr_read_b32 v106, a40
v_accvgpr_read_b32 v107, a56
v_pk_mul_f32 v[104:105], v[104:105], v[92:93]
v_pk_mul_f32 v[106:107], v[106:107], v[92:93]
v_cvt_pk_bf16_f32 v96, v104, v105
v_cvt_pk_bf16_f32 v97, v106, v107
v_accvgpr_read_b32 v108, a9
v_accvgpr_read_b32 v109, a25
v_accvgpr_read_b32 v110, a41
v_accvgpr_read_b32 v111, a57
v_pk_mul_f32 v[108:109], v[108:109], v[92:93]
v_pk_mul_f32 v[110:111], v[110:111], v[92:93]
v_cvt_pk_bf16_f32 v98, v108, v109
v_cvt_pk_bf16_f32 v99, v110, v111
v_accvgpr_read_b32 v104, a10
v_accvgpr_read_b32 v105, a26
v_accvgpr_read_b32 v106, a42
v_accvgpr_read_b32 v107, a58
v_pk_mul_f32 v[104:105], v[104:105], v[92:93]
v_pk_mul_f32 v[106:107], v[106:107], v[92:93]
v_cvt_pk_bf16_f32 v100, v104, v105
v_cvt_pk_bf16_f32 v101, v106, v107
v_accvgpr_read_b32 v108, a11
v_accvgpr_read_b32 v109, a27
v_accvgpr_read_b32 v110, a43
v_accvgpr_read_b32 v111, a59
v_pk_mul_f32 v[108:109], v[108:109], v[92:93]
v_pk_mul_f32 v[110:111], v[110:111], v[92:93]
v_cvt_pk_bf16_f32 v102, v108, v109
v_cvt_pk_bf16_f32 v103, v110, v111
ds_write_b128 v16, v[96:99] offset:4096
ds_write_b128 v20, v[100:103] offset:4096
v_accvgpr_read_b32 v120, a12
v_accvgpr_read_b32 v121, a28
v_accvgpr_read_b32 v122, a44
v_accvgpr_read_b32 v123, a60
v_pk_mul_f32 v[120:121], v[120:121], v[94:95]
v_pk_mul_f32 v[122:123], v[122:123], v[94:95]
v_cvt_pk_bf16_f32 v112, v120, v121
v_cvt_pk_bf16_f32 v113, v122, v123
v_accvgpr_read_b32 v124, a13
v_accvgpr_read_b32 v125, a29
v_accvgpr_read_b32 v126, a45
v_accvgpr_read_b32 v127, a61
v_pk_mul_f32 v[124:125], v[124:125], v[94:95]
v_pk_mul_f32 v[126:127], v[126:127], v[94:95]
v_cvt_pk_bf16_f32 v114, v124, v125
v_cvt_pk_bf16_f32 v115, v126, v127
v_accvgpr_read_b32 v120, a14
v_accvgpr_read_b32 v121, a30
v_accvgpr_read_b32 v122, a46
v_accvgpr_read_b32 v123, a62
v_pk_mul_f32 v[120:121], v[120:121], v[94:95]
v_pk_mul_f32 v[122:123], v[122:123], v[94:95]
v_cvt_pk_bf16_f32 v116, v120, v121
v_cvt_pk_bf16_f32 v117, v122, v123
v_accvgpr_read_b32 v124, a15
v_accvgpr_read_b32 v125, a31
v_accvgpr_read_b32 v126, a47
v_accvgpr_read_b32 v127, a63
v_pk_mul_f32 v[124:125], v[124:125], v[94:95]
v_pk_mul_f32 v[126:127], v[126:127], v[94:95]
v_cvt_pk_bf16_f32 v118, v124, v125
v_cvt_pk_bf16_f32 v119, v126, v127
ds_write_b128 v16, v[112:115] offset:6144
ds_write_b128 v20, v[116:119] offset:6144
s_waitcnt lgkmcnt(0)
ds_read_b128 v[96:99], v19 offset:4096
ds_read_b128 v[100:103], v19 offset:5120
ds_read_b128 v[104:107], v19 offset:6144
ds_read_b128 v[108:111], v19 offset:7168
s_add_u32 s72, s71, 16384
s_waitcnt lgkmcnt(3)
buffer_store_dwordx4 v[96:99], v15, s[48:51], s72 offen sc1
s_add_u32 s72, s71, 20480
s_waitcnt lgkmcnt(2)
buffer_store_dwordx4 v[100:103], v15, s[48:51], s72 offen sc1
s_add_u32 s72, s71, 24576
s_waitcnt lgkmcnt(1)
buffer_store_dwordx4 v[104:107], v15, s[48:51], s72 offen sc1
s_add_u32 s72, s71, 28672
s_waitcnt lgkmcnt(0)
buffer_store_dwordx4 v[108:111], v15, s[48:51], s72 offen sc1
L_exit:
s_endpgm
L_producer:
s_setprio 1
s_sub_u32 s64, s64, 4
s_cmp_eq_u32 s64, 3
s_cbranch_scc1 L_poller
v_lshrrev_b32 v12, 5, v1
v_and_b32 v13, 31, v1
v_lshlrev_b32 v2, 10, v12
v_lshl_add_u32 v2, v13, 4, v2
v_lshlrev_b32 v9, 4, v1
s_lshr_b32 s95, s66, 3
s_lshl_b32 s70, s64, 2
s_add_u32 s95, s95, s70
s_add_u32 s95, s95, 4
s_and_b32 s101, s66, 7
s_lshr_b32 s75, 0x7ab, s95
s_and_b32 s75, s75, 1
s_mov_b32 s76, 0x42312010
s_mov_b32 s77, 0x76543765
s_lshl_b32 s70, s95, 2
s_lshr_b64 s[76:77], s[76:77], s70
s_and_b32 s97, s76, 7
s_lshl_b32 s96, s65, 3
s_add_u32 s96, s96, s97
s_lshl_b32 s96, s96, 18
s_lshl_b32 s71, s97, 8
s_lshl_b32 s70, s101, 5
s_add_u32 s71, s71, s70
s_lshl_b32 s72, s71, 10
s_lshl_b32 s74, s65, 11
s_add_u32 s74, s74, s71
s_lshl_b32 s74, s74, 1
s_lshl_b32 s70, s65, 21
s_waitcnt lgkmcnt(0)
v_lshrrev_b32 v12, 5, v1
v_and_b32 v13, 31, v1
v_mov_b32 v3, v12
v_lshlrev_b32 v5, 4, v12
v_sub_u32 v5, 16, v5
v_and_b32 v14, 7, v13
v_xor_b32 v14, v14, v12
v_lshlrev_b32 v14, 4, v14
v_lshl_add_u32 v6, v13, 7, v14
s_lshl_b32 s70, s64, 12
s_add_u32 s70, s70, 107008
v_add_u32 v6, s70, v6
v_lshrrev_b32 v14, 3, v1
v_and_b32 v15, 7, v1
v_xor_b32 v7, v14, v15
v_lshlrev_b32 v7, 4, v7
v_lshl_add_u32 v7, v14, 7, v7
v_add_u32 v7, s70, v7
v_lshrrev_b32 v8, 2, v14
v_lshlrev_b32 v8, 11, v8
v_and_b32 v14, 3, v14
v_lshl_add_u32 v8, v14, 8, v8
v_lshl_add_u32 v8, v15, 4, v8
v_lshrrev_b32 v10, 4, v1
v_lshlrev_b32 v10, 15, v10
v_and_b32 v14, 15, v1
v_lshl_add_u32 v10, v14, 4, v10
s_mov_b32 s44, s42
s_and_b32 s45, s43, 0xffff
s_mov_b32 s46, 0x1100000
s_mov_b32 s47, 0x20000
v_lshlrev_b32 v4, 2, v13
v_add_u32 v96, 0, v4
v_add_u32 v97, 1, v4
v_add_u32 v98, 2, v4
v_add_u32 v99, 3, v4
v_cvt_f32_u32 v96, v96
v_cvt_f32_u32 v97, v97
v_cvt_f32_u32 v98, v98
v_cvt_f32_u32 v99, v99
v_mul_f32 v96, 0xbdd49a78, v96
v_mul_f32 v97, 0xbdd49a78, v97
v_mul_f32 v98, 0xbdd49a78, v98
v_mul_f32 v99, 0xbdd49a78, v99
v_exp_f32 v96, v96
v_exp_f32 v97, v97
v_exp_f32 v98, v98
v_exp_f32 v99, v99
s_nop 0
v_mul_f32 v96, 0.15915494, v96
v_mul_f32 v97, 0.15915494, v97
v_mul_f32 v98, 0.15915494, v98
v_mul_f32 v99, 0.15915494, v99
s_lshl_b32 s70, s65, 21
s_barrier
s_cmp_eq_u32 s64, 0
s_cbranch_scc1 L_h_go
s_cmp_lg_u32 s64, 2
s_cbranch_scc1 L_h_nd2
s_setprio 0
s_cmp_eq_u32 s75, 1
s_cbranch_scc1 L_h_pk2
s_setprio 0
L_h_pk2:
s_lshr_b32 s73, s66, 3
s_lshl_b32 s73, s73, 3
s_lshr_b32 s76, 0x4030201, s73
s_and_b32 s76, s76, 0xff
s_mov_b32 s73, 98816
s_cmp_eq_u32 s76, 0
s_cselect_b32 s73, 100864, s73
s_cselect_b32 s76, 2, s76
v_mov_b32 v14, s73
s_mov_b32 s90, 0x80000
L_h_dw2:
ds_read_b32 v15, v14
s_waitcnt lgkmcnt(0)
v_readfirstlane_b32 s73, v15
s_cmp_ge_u32 s73, s76
s_cbranch_scc1 L_h_go
s_sleep 4
s_sub_u32 s90, s90, 1
s_cmp_lg_u32 s90, 0
s_cbranch_scc1 L_h_dw2
s_branch L_h_go
L_h_nd2:
v_mov_b32 v14, 102400
s_mov_b32 s90, 0x80000
L_h_cw:
ds_read_b32 v15, v14
s_waitcnt lgkmcnt(0)
v_readfirstlane_b32 s73, v15
s_cmp_ge_u32 s73, s64
s_cbranch_scc1 L_h_go
s_sleep 1
s_sub_u32 s90, s90, 1
s_cmp_lg_u32 s90, 0
s_cbranch_scc1 L_h_cw
L_h_go:
s_cmp_eq_u32 s75, 1
s_cbranch_scc0 L_h_lv
s_add_u32 s48, s18, s70
s_addc_u32 s49, s19, 0
s_and_b32 s49, s49, 0xffff
s_mov_b32 s50, 0x200000
s_mov_b32 s51, 0x20000
buffer_load_dwordx4 a[0:3], v2, s[48:51], s72 offen offset:0 nt
buffer_load_dwordx4 a[4:7], v2, s[48:51], s72 offen offset:512 nt
buffer_load_dwordx4 a[8:11], v2, s[48:51], s72 offen offset:2048 nt
buffer_load_dwordx4 a[12:15], v2, s[48:51], s72 offen offset:2560 nt
s_add_u32 s72, s72, 4096
buffer_load_dwordx4 a[16:19], v2, s[48:51], s72 offen offset:0 nt
buffer_load_dwordx4 a[20:23], v2, s[48:51], s72 offen offset:512 nt
buffer_load_dwordx4 a[24:27], v2, s[48:51], s72 offen offset:2048 nt
buffer_load_dwordx4 a[28:31], v2, s[48:51], s72 offen offset:2560 nt
s_add_u32 s72, s72, 4096
buffer_load_dwordx4 a[32:35], v2, s[48:51], s72 offen offset:0 nt
buffer_load_dwordx4 a[36:39], v2, s[48:51], s72 offen offset:512 nt
buffer_load_dwordx4 a[40:43], v2, s[48:51], s72 offen offset:2048 nt
buffer_load_dwordx4 a[44:47], v2, s[48:51], s72 offen offset:2560 nt
s_add_u32 s72, s72, 4096
buffer_load_dwordx4 a[48:51], v2, s[48:51], s72 offen offset:0 nt
buffer_load_dwordx4 a[52:55], v2, s[48:51], s72 offen offset:512 nt
buffer_load_dwordx4 a[56:59], v2, s[48:51], s72 offen offset:2048 nt
buffer_load_dwordx4 a[60:63], v2, s[48:51], s72 offen offset:2560 nt
s_add_u32 s72, s72, 4096
buffer_load_dwordx4 a[64:67], v2, s[48:51], s72 offen offset:0 nt
buffer_load_dwordx4 a[68:71], v2, s[48:51], s72 offen offset:512 nt
buffer_load_dwordx4 a[72:75], v2, s[48:51], s72 offen offset:2048 nt
buffer_load_dwordx4 a[76:79], v2, s[48:51], s72 offen offset:2560 nt
s_add_u32 s72, s72, 4096
buffer_load_dwordx4 a[80:83], v2, s[48:51], s72 offen offset:0 nt
buffer_load_dwordx4 a[84:87], v2, s[48:51], s72 offen offset:512 nt
buffer_load_dwordx4 a[88:91], v2, s[48:51], s72 offen offset:2048 nt
buffer_load_dwordx4 a[92:95], v2, s[48:51], s72 offen offset:2560 nt
s_add_u32 s72, s72, 4096
buffer_load_dwordx4 a[96:99], v2, s[48:51], s72 offen offset:0 nt
buffer_load_dwordx4 a[100:103], v2, s[48:51], s72 offen offset:512 nt
buffer_load_dwordx4 a[104:107], v2, s[48:51], s72 offen offset:2048 nt
buffer_load_dwordx4 a[108:111], v2, s[48:51], s72 offen offset:2560 nt
s_add_u32 s72, s72, 4096
buffer_load_dwordx4 a[112:115], v2, s[48:51], s72 offen offset:0 nt
buffer_load_dwordx4 a[116:119], v2, s[48:51], s72 offen offset:512 nt
buffer_load_dwordx4 a[120:123], v2, s[48:51], s72 offen offset:2048 nt
buffer_load_dwordx4 a[124:127], v2, s[48:51], s72 offen offset:2560 nt
s_mov_b64 s[76:77], s[20:21]
s_mov_b64 s[78:79], s[22:23]
s_load_dwordx16 s[16:31], s[76:77], s74
s_load_dwordx16 s[48:63], s[78:79], s74
s_branch L_h_ld
L_h_lv:
s_add_u32 s48, s24, s70
s_addc_u32 s49, s25, 0
s_and_b32 s49, s49, 0xffff
s_mov_b32 s50, 0x200000
s_mov_b32 s51, 0x20000
s_add_u32 s73, s72, 0
buffer_load_dwordx4 a[0:3], v9, s[48:51], s73 offen offset:0 nt
buffer_load_dwordx4 a[4:7], v9, s[48:51], s73 offen offset:1024 nt
buffer_load_dwordx4 a[8:11], v9, s[48:51], s73 offen offset:2048 nt
buffer_load_dwordx4 a[12:15], v9, s[48:51], s73 offen offset:3072 nt
s_add_u32 s73, s72, 16384
buffer_load_dwordx4 a[16:19], v9, s[48:51], s73 offen offset:0 nt
buffer_load_dwordx4 a[20:23], v9, s[48:51], s73 offen offset:1024 nt
buffer_load_dwordx4 a[24:27], v9, s[48:51], s73 offen offset:2048 nt
buffer_load_dwordx4 a[28:31], v9, s[48:51], s73 offen offset:3072 nt
s_add_u32 s73, s72, 4096
buffer_load_dwordx4 a[32:35], v9, s[48:51], s73 offen offset:0 nt
buffer_load_dwordx4 a[36:39], v9, s[48:51], s73 offen offset:1024 nt
buffer_load_dwordx4 a[40:43], v9, s[48:51], s73 offen offset:2048 nt
buffer_load_dwordx4 a[44:47], v9, s[48:51], s73 offen offset:3072 nt
s_add_u32 s73, s72, 20480
buffer_load_dwordx4 a[48:51], v9, s[48:51], s73 offen offset:0 nt
buffer_load_dwordx4 a[52:55], v9, s[48:51], s73 offen offset:1024 nt
buffer_load_dwordx4 a[56:59], v9, s[48:51], s73 offen offset:2048 nt
buffer_load_dwordx4 a[60:63], v9, s[48:51], s73 offen offset:3072 nt
s_add_u32 s73, s72, 8192
buffer_load_dwordx4 a[64:67], v9, s[48:51], s73 offen offset:0 nt
buffer_load_dwordx4 a[68:71], v9, s[48:51], s73 offen offset:1024 nt
buffer_load_dwordx4 a[72:75], v9, s[48:51], s73 offen offset:2048 nt
buffer_load_dwordx4 a[76:79], v9, s[48:51], s73 offen offset:3072 nt
s_add_u32 s73, s72, 24576
buffer_load_dwordx4 a[80:83], v9, s[48:51], s73 offen offset:0 nt
buffer_load_dwordx4 a[84:87], v9, s[48:51], s73 offen offset:1024 nt
buffer_load_dwordx4 a[88:91], v9, s[48:51], s73 offen offset:2048 nt
buffer_load_dwordx4 a[92:95], v9, s[48:51], s73 offen offset:3072 nt
s_add_u32 s73, s72, 12288
buffer_load_dwordx4 a[96:99], v9, s[48:51], s73 offen offset:0 nt
buffer_load_dwordx4 a[100:103], v9, s[48:51], s73 offen offset:1024 nt
buffer_load_dwordx4 a[104:107], v9, s[48:51], s73 offen offset:2048 nt
buffer_load_dwordx4 a[108:111], v9, s[48:51], s73 offen offset:3072 nt
s_add_u32 s73, s72, 28672
buffer_load_dwordx4 a[112:115], v9, s[48:51], s73 offen offset:0 nt
buffer_load_dwordx4 a[116:119], v9, s[48:51], s73 offen offset:1024 nt
buffer_load_dwordx4 a[120:123], v9, s[48:51], s73 offen offset:2048 nt
buffer_load_dwordx4 a[124:127], v9, s[48:51], s73 offen offset:3072 nt
s_mov_b64 s[76:77], s[26:27]
s_mov_b64 s[78:79], s[28:29]
s_load_dwordx16 s[16:31], s[76:77], s74
s_load_dwordx16 s[48:63], s[78:79], s74
L_h_ld:
s_cmp_eq_u32 s75, 1
s_cbranch_scc0 L_h_v
s_lshr_b32 s70, s101, 1
s_lshl_b32 s70, s70, 15
s_add_u32 s34, s96, s70
s_and_b32 s70, s101, 1
s_lshl_b32 s70, s70, 14
s_add_u32 s34, s34, s70
s_mov_b32 s100, 0
s_mov_b32 s33, s34
s_mov_b32 s32, s71
L_h_loop_k:
v_add_u32 v100, s32, v3
v_cvt_f32_u32 v100, v100
v_mul_f32 v104, v100, v96
v_mul_f32 v105, v100, v97
v_mul_f32 v106, v100, v98
v_mul_f32 v107, v100, v99
v_fract_f32 v104, v104
v_fract_f32 v105, v105
v_fract_f32 v106, v106
v_fract_f32 v107, v107
v_sin_f32 v108, v104
v_sin_f32 v109, v105
v_sin_f32 v110, v106
v_sin_f32 v111, v107
v_cos_f32 v104, v104
v_cos_f32 v105, v105
v_cos_f32 v106, v106
v_cos_f32 v107, v107
s_nop 0
v_cvt_pk_bf16_f32 v104, v104, v108
v_cvt_pk_bf16_f32 v105, v105, v109
v_cvt_pk_bf16_f32 v106, v106, v110
v_cvt_pk_bf16_f32 v107, v107, v111
v_lshlrev_b32 v48, 16, v104
v_and_b32 v52, 0xffff0000, v104
v_lshlrev_b32 v49, 16, v105
v_and_b32 v53, 0xffff0000, v105
v_lshlrev_b32 v50, 16, v106
v_and_b32 v54, 0xffff0000, v106
v_lshlrev_b32 v51, 16, v107
v_and_b32 v55, 0xffff0000, v107
v_add_f32 v100, 2.0, v100
v_mul_f32 v104, v100, v96
v_mul_f32 v105, v100, v97
v_mul_f32 v106, v100, v98
v_mul_f32 v107, v100, v99
v_fract_f32 v104, v104
v_fract_f32 v105, v105
v_fract_f32 v106, v106
v_fract_f32 v107, v107
v_sin_f32 v108, v104
v_sin_f32 v109, v105
v_sin_f32 v110, v106
v_sin_f32 v111, v107
v_cos_f32 v104, v104
v_cos_f32 v105, v105
v_cos_f32 v106, v106
v_cos_f32 v107, v107
s_nop 0
v_cvt_pk_bf16_f32 v104, v104, v108
v_cvt_pk_bf16_f32 v105, v105, v109
v_cvt_pk_bf16_f32 v106, v106, v110
v_cvt_pk_bf16_f32 v107, v107, v111
v_lshlrev_b32 v56, 16, v104
v_and_b32 v60, 0xffff0000, v104
v_lshlrev_b32 v57, 16, v105
v_and_b32 v61, 0xffff0000, v105
v_lshlrev_b32 v58, 16, v106
v_and_b32 v62, 0xffff0000, v106
v_lshlrev_b32 v59, 16, v107
v_and_b32 v63, 0xffff0000, v107
v_add_f32 v100, 2.0, v100
v_mul_f32 v104, v100, v96
v_mul_f32 v105, v100, v97
v_mul_f32 v106, v100, v98
v_mul_f32 v107, v100, v99
v_fract_f32 v104, v104
v_fract_f32 v105, v105
v_fract_f32 v106, v106
v_fract_f32 v107, v107
v_sin_f32 v108, v104
v_sin_f32 v109, v105
v_sin_f32 v110, v106
v_sin_f32 v111, v107
v_cos_f32 v104, v104
v_cos_f32 v105, v105
v_cos_f32 v106, v106
v_cos_f32 v107, v107
s_nop 0
v_cvt_pk_bf16_f32 v104, v104, v108
v_cvt_pk_bf16_f32 v105, v105, v109
v_cvt_pk_bf16_f32 v106, v106, v110
v_cvt_pk_bf16_f32 v107, v107, v111
v_lshlrev_b32 v64, 16, v104
v_and_b32 v68, 0xffff0000, v104
v_lshlrev_b32 v65, 16, v105
v_and_b32 v69, 0xffff0000, v105
v_lshlrev_b32 v66, 16, v106
v_and_b32 v70, 0xffff0000, v106
v_lshlrev_b32 v67, 16, v107
v_and_b32 v71, 0xffff0000, v107
v_add_f32 v100, 2.0, v100
v_mul_f32 v104, v100, v96
v_mul_f32 v105, v100, v97
v_mul_f32 v106, v100, v98
v_mul_f32 v107, v100, v99
v_fract_f32 v104, v104
v_fract_f32 v105, v105
v_fract_f32 v106, v106
v_fract_f32 v107, v107
v_sin_f32 v108, v104
v_sin_f32 v109, v105
v_sin_f32 v110, v106
v_sin_f32 v111, v107
v_cos_f32 v104, v104
v_cos_f32 v105, v105
v_cos_f32 v106, v106
v_cos_f32 v107, v107
s_nop 0
v_cvt_pk_bf16_f32 v104, v104, v108
v_cvt_pk_bf16_f32 v105, v105, v109
v_cvt_pk_bf16_f32 v106, v106, v110
v_cvt_pk_bf16_f32 v107, v107, v111
v_lshlrev_b32 v72, 16, v104
v_and_b32 v76, 0xffff0000, v104
v_lshlrev_b32 v73, 16, v105
v_and_b32 v77, 0xffff0000, v105
v_lshlrev_b32 v74, 16, v106
v_and_b32 v78, 0xffff0000, v106
v_lshlrev_b32 v75, 16, v107
v_and_b32 v79, 0xffff0000, v107
s_cmp_lg_u32 s100, 0
s_cbranch_scc1 L_h_mv1_k
s_waitcnt vmcnt(24) lgkmcnt(0)
v_mov_b32 v14, 102400
s_add_u32 s73, s64, 1
v_mov_b32 v15, s73
ds_write_b32 v14, v15
v_accvgpr_read_b32 v16, a0
v_accvgpr_read_b32 v17, a1
v_accvgpr_read_b32 v18, a2
v_accvgpr_read_b32 v19, a3
v_accvgpr_read_b32 v20, a4
v_accvgpr_read_b32 v21, a5
v_accvgpr_read_b32 v22, a6
v_accvgpr_read_b32 v23, a7
v_accvgpr_read_b32 v24, a8
v_accvgpr_read_b32 v25, a9
v_accvgpr_read_b32 v26, a10
v_accvgpr_read_b32 v27, a11
v_accvgpr_read_b32 v28, a12
v_accvgpr_read_b32 v29, a13
v_accvgpr_read_b32 v30, a14
v_accvgpr_read_b32 v31, a15
v_accvgpr_read_b32 v32, a16
v_accvgpr_read_b32 v33, a17
v_accvgpr_read_b32 v34, a18
v_accvgpr_read_b32 v35, a19
v_accvgpr_read_b32 v36, a20
v_accvgpr_read_b32 v37, a21
v_accvgpr_read_b32 v38, a22
v_accvgpr_read_b32 v39, a23
v_accvgpr_read_b32 v40, a24
v_accvgpr_read_b32 v41, a25
v_accvgpr_read_b32 v42, a26
v_accvgpr_read_b32 v43, a27
v_accvgpr_read_b32 v44, a28
v_accvgpr_read_b32 v45, a29
v_accvgpr_read_b32 v46, a30
v_accvgpr_read_b32 v47, a31
s_mov_b32 s80, s16
s_mov_b32 s84, s48
s_mov_b32 s81, s17
s_mov_b32 s85, s49
s_mov_b32 s82, s18
s_mov_b32 s86, s50
s_mov_b32 s83, s19
s_mov_b32 s87, s51
s_branch L_h_cmp_k
L_h_mv1_k:
s_cmp_lg_u32 s100, 1
s_cbranch_scc1 L_h_mv2_k
s_waitcnt vmcnt(20) lgkmcnt(0)
v_accvgpr_read_b32 v16, a32
v_accvgpr_read_b32 v17, a33
v_accvgpr_read_b32 v18, a34
v_accvgpr_read_b32 v19, a35
v_accvgpr_read_b32 v20, a36
v_accvgpr_read_b32 v21, a37
v_accvgpr_read_b32 v22, a38
v_accvgpr_read_b32 v23, a39
v_accvgpr_read_b32 v24, a40
v_accvgpr_read_b32 v25, a41
v_accvgpr_read_b32 v26, a42
v_accvgpr_read_b32 v27, a43
v_accvgpr_read_b32 v28, a44
v_accvgpr_read_b32 v29, a45
v_accvgpr_read_b32 v30, a46
v_accvgpr_read_b32 v31, a47
v_accvgpr_read_b32 v32, a48
v_accvgpr_read_b32 v33, a49
v_accvgpr_read_b32 v34, a50
v_accvgpr_read_b32 v35, a51
v_accvgpr_read_b32 v36, a52
v_accvgpr_read_b32 v37, a53
v_accvgpr_read_b32 v38, a54
v_accvgpr_read_b32 v39, a55
v_accvgpr_read_b32 v40, a56
v_accvgpr_read_b32 v41, a57
v_accvgpr_read_b32 v42, a58
v_accvgpr_read_b32 v43, a59
v_accvgpr_read_b32 v44, a60
v_accvgpr_read_b32 v45, a61
v_accvgpr_read_b32 v46, a62
v_accvgpr_read_b32 v47, a63
s_mov_b32 s80, s20
s_mov_b32 s84, s52
s_mov_b32 s81, s21
s_mov_b32 s85, s53
s_mov_b32 s82, s22
s_mov_b32 s86, s54
s_mov_b32 s83, s23
s_mov_b32 s87, s55
s_branch L_h_cmp_k
L_h_mv2_k:
s_cmp_lg_u32 s100, 2
s_cbranch_scc1 L_h_mv3_k
s_waitcnt vmcnt(16) lgkmcnt(0)
v_accvgpr_read_b32 v16, a64
v_accvgpr_read_b32 v17, a65
v_accvgpr_read_b32 v18, a66
v_accvgpr_read_b32 v19, a67
v_accvgpr_read_b32 v20, a68
v_accvgpr_read_b32 v21, a69
v_accvgpr_read_b32 v22, a70
v_accvgpr_read_b32 v23, a71
v_accvgpr_read_b32 v24, a72
v_accvgpr_read_b32 v25, a73
v_accvgpr_read_b32 v26, a74
v_accvgpr_read_b32 v27, a75
v_accvgpr_read_b32 v28, a76
v_accvgpr_read_b32 v29, a77
v_accvgpr_read_b32 v30, a78
v_accvgpr_read_b32 v31, a79
v_accvgpr_read_b32 v32, a80
v_accvgpr_read_b32 v33, a81
v_accvgpr_read_b32 v34, a82
v_accvgpr_read_b32 v35, a83
v_accvgpr_read_b32 v36, a84
v_accvgpr_read_b32 v37, a85
v_accvgpr_read_b32 v38, a86
v_accvgpr_read_b32 v39, a87
v_accvgpr_read_b32 v40, a88
v_accvgpr_read_b32 v41, a89
v_accvgpr_read_b32 v42, a90
v_accvgpr_read_b32 v43, a91
v_accvgpr_read_b32 v44, a92
v_accvgpr_read_b32 v45, a93
v_accvgpr_read_b32 v46, a94
v_accvgpr_read_b32 v47, a95
s_mov_b32 s80, s24
s_mov_b32 s84, s56
s_mov_b32 s81, s25
s_mov_b32 s85, s57
s_mov_b32 s82, s26
s_mov_b32 s86, s58
s_mov_b32 s83, s27
s_mov_b32 s87, s59
s_branch L_h_cmp_k
L_h_mv3_k:
s_waitcnt vmcnt(12) lgkmcnt(0)
v_accvgpr_read_b32 v16, a96
v_accvgpr_read_b32 v17, a97
v_accvgpr_read_b32 v18, a98
v_accvgpr_read_b32 v19, a99
v_accvgpr_read_b32 v20, a100
v_accvgpr_read_b32 v21, a101
v_accvgpr_read_b32 v22, a102
v_accvgpr_read_b32 v23, a103
v_accvgpr_read_b32 v24, a104
v_accvgpr_read_b32 v25, a105
v_accvgpr_read_b32 v26, a106
v_accvgpr_read_b32 v27, a107
v_accvgpr_read_b32 v28, a108
v_accvgpr_read_b32 v29, a109
v_accvgpr_read_b32 v30, a110
v_accvgpr_read_b32 v31, a111
v_accvgpr_read_b32 v32, a112
v_accvgpr_read_b32 v33, a113
v_accvgpr_read_b32 v34, a114
v_accvgpr_read_b32 v35, a115
v_accvgpr_read_b32 v36, a116
v_accvgpr_read_b32 v37, a117
v_accvgpr_read_b32 v38, a118
v_accvgpr_read_b32 v39, a119
v_accvgpr_read_b32 v40, a120
v_accvgpr_read_b32 v41, a121
v_accvgpr_read_b32 v42, a122
v_accvgpr_read_b32 v43, a123
v_accvgpr_read_b32 v44, a124
v_accvgpr_read_b32 v45, a125
v_accvgpr_read_b32 v46, a126
v_accvgpr_read_b32 v47, a127
s_mov_b32 s80, s28
s_mov_b32 s84, s60
s_mov_b32 s81, s29
s_mov_b32 s85, s61
s_mov_b32 s82, s30
s_mov_b32 s86, s62
s_mov_b32 s83, s31
s_mov_b32 s87, s63
L_h_cmp_k:
s_mov_b32 s77, 0x3db8aa3b
v_mov_b32 v88, s80
v_mov_b32 v92, s84
v_mov_b32 v89, s81
v_mov_b32 v93, s85
v_mov_b32 v90, s82
v_mov_b32 v94, s86
v_mov_b32 v91, s83
v_mov_b32 v95, s87
v_lshlrev_b32 v88, v5, v88
v_lshlrev_b32 v92, v5, v92
v_lshlrev_b32 v89, v5, v89
v_lshlrev_b32 v93, v5, v93
v_lshlrev_b32 v90, v5, v90
v_lshlrev_b32 v94, v5, v94
v_lshlrev_b32 v91, v5, v91
v_lshlrev_b32 v95, v5, v95
v_and_b32 v88, 0xffff0000, v88
v_and_b32 v92, 0xffff0000, v92
v_and_b32 v89, 0xffff0000, v89
v_and_b32 v93, 0xffff0000, v93
v_and_b32 v90, 0xffff0000, v90
v_and_b32 v94, 0xffff0000, v94
v_and_b32 v91, 0xffff0000, v91
v_and_b32 v95, 0xffff0000, v95
v_mul_f32 v88, s77, v88
v_mul_f32 v89, s77, v89
v_mul_f32 v90, s77, v90
v_mul_f32 v91, s77, v91
v_mul_f32_e64 v92, -v92, v88
v_mul_f32_e64 v93, -v93, v89
v_mul_f32_e64 v94, -v94, v90
v_mul_f32_e64 v95, -v95, v91
v_cvt_f32_i32 v16, v16
v_cvt_f32_i32 v20, v20
v_cvt_f32_i32 v17, v17
v_cvt_f32_i32 v21, v21
v_cvt_f32_i32 v18, v18
v_cvt_f32_i32 v22, v22
v_cvt_f32_i32 v19, v19
v_cvt_f32_i32 v23, v23
v_fma_f32 v16, v16, v88, v92
v_fma_f32 v20, v20, v88, v92
v_fma_f32 v17, v17, v88, v92
v_fma_f32 v21, v21, v88, v92
v_fma_f32 v18, v18, v88, v92
v_fma_f32 v22, v22, v88, v92
v_fma_f32 v19, v19, v88, v92
v_fma_f32 v23, v23, v88, v92
v_mul_f32 v104, v20, v52
v_mul_f32 v108, v16, v52
v_mul_f32 v105, v21, v53
v_mul_f32 v109, v17, v53
v_mul_f32 v106, v22, v54
v_mul_f32 v110, v18, v54
v_mul_f32 v107, v23, v55
v_mul_f32 v111, v19, v55
v_fma_f32 v104, v16, v48, -v104
v_fma_f32 v108, v20, v48, v108
v_fma_f32 v105, v17, v49, -v105
v_fma_f32 v109, v21, v49, v109
v_fma_f32 v106, v18, v50, -v106
v_fma_f32 v110, v22, v50, v110
v_fma_f32 v107, v19, v51, -v107
v_fma_f32 v111, v23, v51, v111
v_xor_b32 v12, 0, v6
v_cvt_pk_bf16_f32 v112, v104, v105
v_cvt_pk_bf16_f32 v113, v106, v107
v_cvt_pk_bf16_f32 v114, v108, v109
v_cvt_pk_bf16_f32 v115, v110, v111
ds_write_b128 v12, v[112:115]
v_cvt_f32_i32 v24, v24
v_cvt_f32_i32 v28, v28
v_cvt_f32_i32 v25, v25
v_cvt_f32_i32 v29, v29
v_cvt_f32_i32 v26, v26
v_cvt_f32_i32 v30, v30
v_cvt_f32_i32 v27, v27
v_cvt_f32_i32 v31, v31
v_fma_f32 v24, v24, v89, v93
v_fma_f32 v28, v28, v89, v93
v_fma_f32 v25, v25, v89, v93
v_fma_f32 v29, v29, v89, v93
v_fma_f32 v26, v26, v89, v93
v_fma_f32 v30, v30, v89, v93
v_fma_f32 v27, v27, v89, v93
v_fma_f32 v31, v31, v89, v93
v_mul_f32 v104, v28, v60
v_mul_f32 v108, v24, v60
v_mul_f32 v105, v29, v61
v_mul_f32 v109, v25, v61
v_mul_f32 v106, v30, v62
v_mul_f32 v110, v26, v62
v_mul_f32 v107, v31, v63
v_mul_f32 v111, v27, v63
v_fma_f32 v104, v24, v56, -v104
v_fma_f32 v108, v28, v56, v108
v_fma_f32 v105, v25, v57, -v105
v_fma_f32 v109, v29, v57, v109
v_fma_f32 v106, v26, v58, -v106
v_fma_f32 v110, v30, v58, v110
v_fma_f32 v107, v27, v59, -v107
v_fma_f32 v111, v31, v59, v111
v_xor_b32 v13, 32, v6
v_cvt_pk_bf16_f32 v116, v104, v105
v_cvt_pk_bf16_f32 v117, v106, v107
v_cvt_pk_bf16_f32 v118, v108, v109
v_cvt_pk_bf16_f32 v119, v110, v111
ds_write_b128 v13, v[116:119]
v_cvt_f32_i32 v32, v32
v_cvt_f32_i32 v36, v36
v_cvt_f32_i32 v33, v33
v_cvt_f32_i32 v37, v37
v_cvt_f32_i32 v34, v34
v_cvt_f32_i32 v38, v38
v_cvt_f32_i32 v35, v35
v_cvt_f32_i32 v39, v39
v_fma_f32 v32, v32, v90, v94
v_fma_f32 v36, v36, v90, v94
v_fma_f32 v33, v33, v90, v94
v_fma_f32 v37, v37, v90, v94
v_fma_f32 v34, v34, v90, v94
v_fma_f32 v38, v38, v90, v94
v_fma_f32 v35, v35, v90, v94
v_fma_f32 v39, v39, v90, v94
v_mul_f32 v104, v36, v68
v_mul_f32 v108, v32, v68
v_mul_f32 v105, v37, v69
v_mul_f32 v109, v33, v69
v_mul_f32 v106, v38, v70
v_mul_f32 v110, v34, v70
v_mul_f32 v107, v39, v71
v_mul_f32 v111, v35, v71
v_fma_f32 v104, v32, v64, -v104
v_fma_f32 v108, v36, v64, v108
v_fma_f32 v105, v33, v65, -v105
v_fma_f32 v109, v37, v65, v109
v_fma_f32 v106, v34, v66, -v106
v_fma_f32 v110, v38, v66, v110
v_fma_f32 v107, v35, v67, -v107
v_fma_f32 v111, v39, v67, v111
v_xor_b32 v14, 64, v6
v_cvt_pk_bf16_f32 v120, v104, v105
v_cvt_pk_bf16_f32 v121, v106, v107
v_cvt_pk_bf16_f32 v122, v108, v109
v_cvt_pk_bf16_f32 v123, v110, v111
ds_write_b128 v14, v[120:123]
v_cvt_f32_i32 v40, v40
v_cvt_f32_i32 v44, v44
v_cvt_f32_i32 v41, v41
v_cvt_f32_i32 v45, v45
v_cvt_f32_i32 v42, v42
v_cvt_f32_i32 v46, v46
v_cvt_f32_i32 v43, v43
v_cvt_f32_i32 v47, v47
v_fma_f32 v40, v40, v91, v95
v_fma_f32 v44, v44, v91, v95
v_fma_f32 v41, v41, v91, v95
v_fma_f32 v45, v45, v91, v95
v_fma_f32 v42, v42, v91, v95
v_fma_f32 v46, v46, v91, v95
v_fma_f32 v43, v43, v91, v95
v_fma_f32 v47, v47, v91, v95
v_mul_f32 v104, v44, v76
v_mul_f32 v108, v40, v76
v_mul_f32 v105, v45, v77
v_mul_f32 v109, v41, v77
v_mul_f32 v106, v46, v78
v_mul_f32 v110, v42, v78
v_mul_f32 v107, v47, v79
v_mul_f32 v111, v43, v79
v_fma_f32 v104, v40, v72, -v104
v_fma_f32 v108, v44, v72, v108
v_fma_f32 v105, v41, v73, -v105
v_fma_f32 v109, v45, v73, v109
v_fma_f32 v106, v42, v74, -v106
v_fma_f32 v110, v46, v74, v110
v_fma_f32 v107, v43, v75, -v107
v_fma_f32 v111, v47, v75, v111
v_xor_b32 v15, 96, v6
v_cvt_pk_bf16_f32 v124, v104, v105
v_cvt_pk_bf16_f32 v125, v106, v107
v_cvt_pk_bf16_f32 v126, v108, v109
v_cvt_pk_bf16_f32 v127, v110, v111
ds_write_b128 v15, v[124:127]
s_waitcnt lgkmcnt(0)
ds_read_b128 v[112:115], v7 offset:0
ds_read_b128 v[116:119], v7 offset:1024
ds_read_b128 v[120:123], v7 offset:2048
ds_read_b128 v[124:127], v7 offset:3072
s_add_u32 s78, s33, 0
s_waitcnt lgkmcnt(3)
buffer_store_dwordx4 v[112:115], v8, s[44:47], s78 offen sc1
s_add_u32 s78, s33, 4096
s_waitcnt lgkmcnt(2)
buffer_store_dwordx4 v[116:119], v8, s[44:47], s78 offen sc1
s_add_u32 s78, s33, 8192
s_waitcnt lgkmcnt(1)
buffer_store_dwordx4 v[120:123], v8, s[44:47], s78 offen sc1
s_add_u32 s78, s33, 12288
s_waitcnt lgkmcnt(0)
buffer_store_dwordx4 v[124:127], v8, s[44:47], s78 offen sc1
s_add_u32 s70, s100, 1
s_lshr_b32 s79, s70, 1
s_lshl_b32 s79, s79, 10
s_and_b32 s70, s70, 1
s_lshl_b32 s70, s70, 7
s_add_u32 s33, s34, s79
s_add_u32 s33, s33, s70
s_add_u32 s32, s32, 8
s_add_u32 s100, s100, 1
s_cmp_lt_u32 s100, 4
s_cbranch_scc1 L_h_loop_k
s_waitcnt vmcnt(0)
s_branch L_h_done
L_h_v:
s_lshl_b32 s70, s101, 12
s_add_u32 s34, s96, s70
s_add_u32 s34, s34, 131072
s_mov_b32 s100, 0
s_mov_b32 s33, s34
s_mov_b32 s32, s71
L_h_loop_v:
s_cmp_lg_u32 s100, 0
s_cbranch_scc1 L_h_mv1_v
s_waitcnt vmcnt(24) lgkmcnt(0)
v_mov_b32 v14, 102400
s_add_u32 s73, s64, 1
v_mov_b32 v15, s73
ds_write_b32 v14, v15
v_accvgpr_read_b32 v16, a0
v_accvgpr_read_b32 v17, a1
v_accvgpr_read_b32 v18, a2
v_accvgpr_read_b32 v19, a3
v_accvgpr_read_b32 v20, a4
v_accvgpr_read_b32 v21, a5
v_accvgpr_read_b32 v22, a6
v_accvgpr_read_b32 v23, a7
v_accvgpr_read_b32 v24, a8
v_accvgpr_read_b32 v25, a9
v_accvgpr_read_b32 v26, a10
v_accvgpr_read_b32 v27, a11
v_accvgpr_read_b32 v28, a12
v_accvgpr_read_b32 v29, a13
v_accvgpr_read_b32 v30, a14
v_accvgpr_read_b32 v31, a15
v_accvgpr_read_b32 v32, a16
v_accvgpr_read_b32 v33, a17
v_accvgpr_read_b32 v34, a18
v_accvgpr_read_b32 v35, a19
v_accvgpr_read_b32 v36, a20
v_accvgpr_read_b32 v37, a21
v_accvgpr_read_b32 v38, a22
v_accvgpr_read_b32 v39, a23
v_accvgpr_read_b32 v40, a24
v_accvgpr_read_b32 v41, a25
v_accvgpr_read_b32 v42, a26
v_accvgpr_read_b32 v43, a27
v_accvgpr_read_b32 v44, a28
v_accvgpr_read_b32 v45, a29
v_accvgpr_read_b32 v46, a30
v_accvgpr_read_b32 v47, a31
s_mov_b32 s80, s16
s_mov_b32 s84, s48
s_mov_b32 s81, s17
s_mov_b32 s85, s49
s_mov_b32 s82, s24
s_mov_b32 s86, s56
s_mov_b32 s83, s25
s_mov_b32 s87, s57
s_branch L_h_cmp_v
L_h_mv1_v:
s_cmp_lg_u32 s100, 1
s_cbranch_scc1 L_h_mv2_v
s_waitcnt vmcnt(20) lgkmcnt(0)
v_accvgpr_read_b32 v16, a32
v_accvgpr_read_b32 v17, a33
v_accvgpr_read_b32 v18, a34
v_accvgpr_read_b32 v19, a35
v_accvgpr_read_b32 v20, a36
v_accvgpr_read_b32 v21, a37
v_accvgpr_read_b32 v22, a38
v_accvgpr_read_b32 v23, a39
v_accvgpr_read_b32 v24, a40
v_accvgpr_read_b32 v25, a41
v_accvgpr_read_b32 v26, a42
v_accvgpr_read_b32 v27, a43
v_accvgpr_read_b32 v28, a44
v_accvgpr_read_b32 v29, a45
v_accvgpr_read_b32 v30, a46
v_accvgpr_read_b32 v31, a47
v_accvgpr_read_b32 v32, a48
v_accvgpr_read_b32 v33, a49
v_accvgpr_read_b32 v34, a50
v_accvgpr_read_b32 v35, a51
v_accvgpr_read_b32 v36, a52
v_accvgpr_read_b32 v37, a53
v_accvgpr_read_b32 v38, a54
v_accvgpr_read_b32 v39, a55
v_accvgpr_read_b32 v40, a56
v_accvgpr_read_b32 v41, a57
v_accvgpr_read_b32 v42, a58
v_accvgpr_read_b32 v43, a59
v_accvgpr_read_b32 v44, a60
v_accvgpr_read_b32 v45, a61
v_accvgpr_read_b32 v46, a62
v_accvgpr_read_b32 v47, a63
s_mov_b32 s80, s18
s_mov_b32 s84, s50
s_mov_b32 s81, s19
s_mov_b32 s85, s51
s_mov_b32 s82, s26
s_mov_b32 s86, s58
s_mov_b32 s83, s27
s_mov_b32 s87, s59
s_branch L_h_cmp_v
L_h_mv2_v:
s_cmp_lg_u32 s100, 2
s_cbranch_scc1 L_h_mv3_v
s_waitcnt vmcnt(16) lgkmcnt(0)
v_accvgpr_read_b32 v16, a64
v_accvgpr_read_b32 v17, a65
v_accvgpr_read_b32 v18, a66
v_accvgpr_read_b32 v19, a67
v_accvgpr_read_b32 v20, a68
v_accvgpr_read_b32 v21, a69
v_accvgpr_read_b32 v22, a70
v_accvgpr_read_b32 v23, a71
v_accvgpr_read_b32 v24, a72
v_accvgpr_read_b32 v25, a73
v_accvgpr_read_b32 v26, a74
v_accvgpr_read_b32 v27, a75
v_accvgpr_read_b32 v28, a76
v_accvgpr_read_b32 v29, a77
v_accvgpr_read_b32 v30, a78
v_accvgpr_read_b32 v31, a79
v_accvgpr_read_b32 v32, a80
v_accvgpr_read_b32 v33, a81
v_accvgpr_read_b32 v34, a82
v_accvgpr_read_b32 v35, a83
v_accvgpr_read_b32 v36, a84
v_accvgpr_read_b32 v37, a85
v_accvgpr_read_b32 v38, a86
v_accvgpr_read_b32 v39, a87
v_accvgpr_read_b32 v40, a88
v_accvgpr_read_b32 v41, a89
v_accvgpr_read_b32 v42, a90
v_accvgpr_read_b32 v43, a91
v_accvgpr_read_b32 v44, a92
v_accvgpr_read_b32 v45, a93
v_accvgpr_read_b32 v46, a94
v_accvgpr_read_b32 v47, a95
s_mov_b32 s80, s20
s_mov_b32 s84, s52
s_mov_b32 s81, s21
s_mov_b32 s85, s53
s_mov_b32 s82, s28
s_mov_b32 s86, s60
s_mov_b32 s83, s29
s_mov_b32 s87, s61
s_branch L_h_cmp_v
L_h_mv3_v:
s_waitcnt vmcnt(12) lgkmcnt(0)
v_accvgpr_read_b32 v16, a96
v_accvgpr_read_b32 v17, a97
v_accvgpr_read_b32 v18, a98
v_accvgpr_read_b32 v19, a99
v_accvgpr_read_b32 v20, a100
v_accvgpr_read_b32 v21, a101
v_accvgpr_read_b32 v22, a102
v_accvgpr_read_b32 v23, a103
v_accvgpr_read_b32 v24, a104
v_accvgpr_read_b32 v25, a105
v_accvgpr_read_b32 v26, a106
v_accvgpr_read_b32 v27, a107
v_accvgpr_read_b32 v28, a108
v_accvgpr_read_b32 v29, a109
v_accvgpr_read_b32 v30, a110
v_accvgpr_read_b32 v31, a111
v_accvgpr_read_b32 v32, a112
v_accvgpr_read_b32 v33, a113
v_accvgpr_read_b32 v34, a114
v_accvgpr_read_b32 v35, a115
v_accvgpr_read_b32 v36, a116
v_accvgpr_read_b32 v37, a117
v_accvgpr_read_b32 v38, a118
v_accvgpr_read_b32 v39, a119
v_accvgpr_read_b32 v40, a120
v_accvgpr_read_b32 v41, a121
v_accvgpr_read_b32 v42, a122
v_accvgpr_read_b32 v43, a123
v_accvgpr_read_b32 v44, a124
v_accvgpr_read_b32 v45, a125
v_accvgpr_read_b32 v46, a126
v_accvgpr_read_b32 v47, a127
s_mov_b32 s80, s22
s_mov_b32 s84, s54
s_mov_b32 s81, s23
s_mov_b32 s85, s55
s_mov_b32 s82, s30
s_mov_b32 s86, s62
s_mov_b32 s83, s31
s_mov_b32 s87, s63
L_h_cmp_v:
s_lshl_b32 s79, s84, 16
v_mov_b32 v88, s79
s_and_b32 s79, s84, 0xffff0000
v_mov_b32 v89, s79
s_lshl_b32 s79, s85, 16
v_mov_b32 v90, s79
s_and_b32 s79, s85, 0xffff0000
v_mov_b32 v91, s79
s_lshl_b32 s79, s86, 16
v_mov_b32 v92, s79
s_and_b32 s79, s86, 0xffff0000
v_mov_b32 v93, s79
s_lshl_b32 s79, s87, 16
v_mov_b32 v94, s79
s_and_b32 s79, s87, 0xffff0000
v_mov_b32 v95, s79
s_lshl_b32 s4, s80, 16
s_and_b32 s5, s80, 0xffff0000
s_lshl_b32 s6, s81, 16
s_and_b32 s7, s81, 0xffff0000
s_lshl_b32 s8, s82, 16
s_and_b32 s9, s82, 0xffff0000
s_lshl_b32 s10, s83, 16
s_and_b32 s11, s83, 0xffff0000
v_mul_f32_e64 v88, -s4, v88
v_mul_f32_e64 v89, -s5, v89
v_mul_f32_e64 v90, -s6, v90
v_mul_f32_e64 v91, -s7, v91
v_mul_f32_e64 v92, -s8, v92
v_mul_f32_e64 v93, -s9, v93
v_mul_f32_e64 v94, -s10, v94
v_mul_f32_e64 v95, -s11, v95
v_cvt_f32_i32 v16, v16
v_cvt_f32_i32 v17, v17
v_cvt_f32_i32 v18, v18
v_cvt_f32_i32 v19, v19
v_cvt_f32_i32 v20, v20
v_cvt_f32_i32 v21, v21
v_cvt_f32_i32 v22, v22
v_cvt_f32_i32 v23, v23
v_cvt_f32_i32 v24, v24
v_cvt_f32_i32 v25, v25
v_cvt_f32_i32 v26, v26
v_cvt_f32_i32 v27, v27
v_cvt_f32_i32 v28, v28
v_cvt_f32_i32 v29, v29
v_cvt_f32_i32 v30, v30
v_cvt_f32_i32 v31, v31
v_cvt_f32_i32 v32, v32
v_cvt_f32_i32 v33, v33
v_cvt_f32_i32 v34, v34
v_cvt_f32_i32 v35, v35
v_cvt_f32_i32 v36, v36
v_cvt_f32_i32 v37, v37
v_cvt_f32_i32 v38, v38
v_cvt_f32_i32 v39, v39
v_cvt_f32_i32 v40, v40
v_cvt_f32_i32 v41, v41
v_cvt_f32_i32 v42, v42
v_cvt_f32_i32 v43, v43
v_cvt_f32_i32 v44, v44
v_cvt_f32_i32 v45, v45
v_cvt_f32_i32 v46, v46
v_cvt_f32_i32 v47, v47
v_fma_f32 v16, v16, s4, v88
v_fma_f32 v17, v17, s4, v88
v_fma_f32 v18, v18, s4, v88
v_fma_f32 v19, v19, s4, v88
v_fma_f32 v20, v20, s5, v89
v_fma_f32 v21, v21, s5, v89
v_fma_f32 v22, v22, s5, v89
v_fma_f32 v23, v23, s5, v89
v_fma_f32 v24, v24, s6, v90
v_fma_f32 v25, v25, s6, v90
v_fma_f32 v26, v26, s6, v90
v_fma_f32 v27, v27, s6, v90
v_fma_f32 v28, v28, s7, v91
v_fma_f32 v29, v29, s7, v91
v_fma_f32 v30, v30, s7, v91
v_fma_f32 v31, v31, s7, v91
v_fma_f32 v32, v32, s8, v92
v_fma_f32 v33, v33, s8, v92
v_fma_f32 v34, v34, s8, v92
v_fma_f32 v35, v35, s8, v92
v_fma_f32 v36, v36, s9, v93
v_fma_f32 v37, v37, s9, v93
v_fma_f32 v38, v38, s9, v93
v_fma_f32 v39, v39, s9, v93
v_fma_f32 v40, v40, s10, v94
v_fma_f32 v41, v41, s10, v94
v_fma_f32 v42, v42, s10, v94
v_fma_f32 v43, v43, s10, v94
v_fma_f32 v44, v44, s11, v95
v_fma_f32 v45, v45, s11, v95
v_fma_f32 v46, v46, s11, v95
v_fma_f32 v47, v47, s11, v95
v_cvt_pk_bf16_f32 v112, v16, v20
v_cvt_pk_bf16_f32 v113, v24, v28
v_cvt_pk_bf16_f32 v114, v32, v36
v_cvt_pk_bf16_f32 v115, v40, v44
buffer_store_dwordx4 v[112:115], v10, s[44:47], s33 offen offset:0 sc1
v_cvt_pk_bf16_f32 v116, v17, v21
v_cvt_pk_bf16_f32 v117, v25, v29
v_cvt_pk_bf16_f32 v118, v33, v37
v_cvt_pk_bf16_f32 v119, v41, v45
buffer_store_dwordx4 v[116:119], v10, s[44:47], s33 offen offset:1024 sc1
v_cvt_pk_bf16_f32 v120, v18, v22
v_cvt_pk_bf16_f32 v121, v26, v30
v_cvt_pk_bf16_f32 v122, v34, v38
v_cvt_pk_bf16_f32 v123, v42, v46
buffer_store_dwordx4 v[120:123], v10, s[44:47], s33 offen offset:2048 sc1
v_cvt_pk_bf16_f32 v124, v19, v23
v_cvt_pk_bf16_f32 v125, v27, v31
v_cvt_pk_bf16_f32 v126, v35, v39
v_cvt_pk_bf16_f32 v127, v43, v47
buffer_store_dwordx4 v[124:127], v10, s[44:47], s33 offen offset:3072 sc1
s_add_u32 s33, s33, 256
s_add_u32 s100, s100, 1
s_cmp_lt_u32 s100, 4
s_cbranch_scc1 L_h_loop_v
s_waitcnt vmcnt(0)
L_h_done:
v_mov_b32 v12, 101888
s_mov_b32 s90, 0x80000
L_nw_p:
ds_read_b32 v13, v12
s_waitcnt lgkmcnt(0)
v_readfirstlane_b32 s94, v13
s_cmp_lg_u32 s94, 0
s_cbranch_scc1 L_nw_done_p
s_sleep 1
s_sub_u32 s90, s90, 1
s_cmp_lg_u32 s90, 0
s_cbranch_scc1 L_nw_p
L_nw_done_p:
s_add_u32 s70, s64, 1
s_lshl_b32 s70, s70, 5
s_add_u32 s70, s70, s66
s_lshl_b32 s79, s65, 7
s_add_u32 s70, s70, s79
s_lshl_b32 s70, s70, 7
s_add_u32 s70, s70, 16777216
v_mov_b32 v13, s94
v_mov_b32 v12, 0
s_mov_b64 exec, 1
buffer_store_dword v13, v12, s[44:47], s70 offen sc1
s_mov_b64 exec, -1
s_branch L_p_end
L_poller:
s_setprio 0
s_waitcnt lgkmcnt(0)
s_mov_b32 s4, s40
s_and_b32 s5, s41, 0xffff
s_mov_b32 s6, 0x100
s_mov_b32 s7, 0x20000
s_cmp_lg_u32 s2, 0
s_cbranch_scc1 L_p_z
s_memtime s[72:73]
v_mov_b32 v12, 0
v_mov_b32 v17, 0
s_waitcnt lgkmcnt(0)
s_or_b32 s72, s72, 1
v_mov_b32 v16, s72
s_mov_b64 exec, 1
buffer_atomic_cmpswap v[16:17], v12, s[4:7], 0 offen sc1
s_mov_b64 exec, -1
L_p_z:
v_mov_b32 v12, 0
buffer_load_dword v13, v12, s[4:7], 0 offen sc1
v_lshlrev_b32 v6, 4, v1
v_add_u32 v6, 98816, v6
v_mov_b32 v8, 0
v_mov_b32 v9, 0
v_mov_b32 v10, 0
v_mov_b32 v11, 0
ds_write_b128 v6, v[8:11] offset:0
ds_write_b128 v6, v[8:11] offset:1024
ds_write_b128 v6, v[8:11] offset:2048
ds_write_b128 v6, v[8:11] offset:3072
s_mov_b32 s44, s42
s_and_b32 s45, s43, 0xffff
s_mov_b32 s46, 0x1100000
s_mov_b32 s47, 0x20000
s_waitcnt lgkmcnt(0)
s_barrier
s_mov_b32 s90, 0x20000
L_p_nw2:
s_waitcnt vmcnt(0)
v_readfirstlane_b32 s94, v13
s_cmp_lg_u32 s94, 0
s_cbranch_scc1 L_p_ngot
buffer_load_dword v13, v12, s[4:7], 0 offen sc1
s_sub_u32 s90, s90, 1
s_cmp_lg_u32 s90, 0
s_cbranch_scc1 L_p_nw2
L_p_ngot:
v_lshlrev_b32 v12, 2, v1
v_add_u32 v12, 101888, v12
v_mov_b32 v13, s94
ds_write_b32 v12, v13
s_mov_b32 s32, 0x8060402
s_mov_b32 s33, 0x100e0d0c
v_lshlrev_b32 v14, 7, v1
v_lshlrev_b32 v15, 4, v1
v_add_u32 v15, 100864, v15
s_mov_b32 s90, 0x40000
s_lshl_b32 s79, s65, 14
s_add_u32 s79, s79, 16777216
s_add_u32 s78, s79, 8192
v_mov_b32 v16, 98816
s_mov_b32 s77, 0
L_poll:
buffer_load_dword v12, v14, s[44:47], s79 offen sc1
buffer_load_dword v13, v14, s[44:47], s78 offen sc1
s_waitcnt vmcnt(0)
v_cmp_eq_u32 vcc, s94, v12
v_cmp_eq_u32_e64 s[72:73], s94, v13
s_nop 3
s_ff0_i32_b64 s91, vcc
s_lshr_b32 s91, s91, 3
s_min_u32 s91, s91, 8
s_ff0_i32_b64 s92, s[72:73]
s_lshr_b32 s92, s92, 3
s_min_u32 s92, s92, 8
s_add_u32 s92, s92, 8
s_cmp_eq_u32 s91, 8
s_cselect_b32 s74, s92, s91
v_mov_b32 v12, s74
ds_write_b32 v15, v12
L_poll_after:
s_cmp_ge_u32 s74, 16
s_cbranch_scc1 L_p_end
s_cmp_lt_u32 s74, 2
s_cbranch_scc1 L_poll_next
s_sleep 16
L_poll_w:
ds_read_b32 v17, v16
s_waitcnt lgkmcnt(0)
v_readfirstlane_b32 s70, v17
s_add_u32 s70, s70, 1
s_min_u32 s70, s70, 7
s_lshl_b32 s70, s70, 3
s_lshr_b64 s[72:73], s[32:33], s70
s_and_b32 s70, s72, 0xff
s_cmp_eq_u32 s70, 0
s_cselect_b32 s70, 16, s70
s_cmp_lt_u32 s74, s70
s_cbranch_scc1 L_poll_next
s_sleep 4
s_sub_u32 s90, s90, 1
s_cmp_lg_u32 s90, 0
s_cbranch_scc1 L_poll_w
L_poll_next:
s_sub_u32 s90, s90, 1
s_cmp_lg_u32 s90, 0
s_cbranch_scc1 L_poll
L_p_end:
s_waitcnt vmcnt(0) lgkmcnt(0)
s_endpgm
L_fallback:
s_barrier
v_mov_b32 v28, 0xff800000
v_mov_b32 v29, 0xff800000
v_mov_b32 v30, 0xff800000
v_mov_b32 v31, 0xff800000
s_lshl_b32 s70, s65, 21
s_lshl_b32 s71, s64, 15
s_add_u32 s73, s70, s71
s_mov_b32 s74, 0
L_mx_loop:
s_mov_b32 s68, s73
buffer_load_dwordx4 a[64:67], v1, s[44:47], s68 offen offset:0 sc1
buffer_load_dwordx4 a[68:71], v1, s[44:47], s68 offen offset:1024 sc1
buffer_load_dwordx4 a[72:75], v1, s[44:47], s68 offen offset:2048 sc1
buffer_load_dwordx4 a[76:79], v1, s[44:47], s68 offen offset:3072 sc1
s_add_u32 s68, s68, 4096
buffer_load_dwordx4 a[80:83], v1, s[44:47], s68 offen offset:0 sc1
buffer_load_dwordx4 a[84:87], v1, s[44:47], s68 offen offset:1024 sc1
buffer_load_dwordx4 a[88:91], v1, s[44:47], s68 offen offset:2048 sc1
buffer_load_dwordx4 a[92:95], v1, s[44:47], s68 offen offset:3072 sc1
s_add_u32 s68, s68, 4096
buffer_load_dwordx4 a[96:99], v1, s[44:47], s68 offen offset:0 sc1
buffer_load_dwordx4 a[100:103], v1, s[44:47], s68 offen offset:1024 sc1
buffer_load_dwordx4 a[104:107], v1, s[44:47], s68 offen offset:2048 sc1
buffer_load_dwordx4 a[108:111], v1, s[44:47], s68 offen offset:3072 sc1
s_add_u32 s68, s68, 4096
buffer_load_dwordx4 a[112:115], v1, s[44:47], s68 offen offset:0 sc1
buffer_load_dwordx4 a[116:119], v1, s[44:47], s68 offen offset:1024 sc1
buffer_load_dwordx4 a[120:123], v1, s[44:47], s68 offen offset:2048 sc1
ds_read_b128 v[32:35], v2 offset:0
ds_read_b128 v[36:39], v2 offset:8320
ds_read_b128 v[40:43], v2 offset:16640
ds_read_b128 v[44:47], v2 offset:24960
s_waitcnt vmcnt(14) lgkmcnt(3)
v_mfma_f32_16x16x32_bf16 v[64:67], a[64:67], v[32:35], 0
s_waitcnt lgkmcnt(2)
buffer_load_dwordx4 a[124:127], v1, s[44:47], s68 offen offset:3072 sc1
v_mfma_f32_16x16x32_bf16 v[68:71], a[64:67], v[36:39], 0
s_waitcnt lgkmcnt(1)
ds_read_b128 v[48:51], v2 offset:1040
v_mfma_f32_16x16x32_bf16 v[72:75], a[64:67], v[40:43], 0
s_waitcnt lgkmcnt(1)
ds_read_b128 v[52:55], v2 offset:9360
v_mfma_f32_16x16x32_bf16 v[76:79], a[64:67], v[44:47], 0
s_waitcnt vmcnt(14)
ds_read_b128 v[56:59], v2 offset:17680
v_mfma_f32_16x16x32_bf16 v[80:83], a[68:71], v[32:35], 0
s_add_u32 s68, s68, 4096
buffer_load_dwordx4 a[64:67], v1, s[44:47], s68 offen offset:0 sc1
v_mfma_f32_16x16x32_bf16 v[84:87], a[68:71], v[36:39], 0
ds_read_b128 v[60:63], v2 offset:26000
v_mfma_f32_16x16x32_bf16 v[88:91], a[68:71], v[40:43], 0
v_mfma_f32_16x16x32_bf16 v[92:95], a[68:71], v[44:47], 0
s_waitcnt vmcnt(14) lgkmcnt(3)
v_mfma_f32_16x16x32_bf16 v[64:67], a[72:75], v[48:51], v[64:67]
s_waitcnt lgkmcnt(2)
buffer_load_dwordx4 a[68:71], v1, s[44:47], s68 offen offset:1024 sc1
v_mfma_f32_16x16x32_bf16 v[68:71], a[72:75], v[52:55], v[68:71]
s_waitcnt lgkmcnt(1)
ds_read_b128 v[32:35], v2 offset:2080
v_mfma_f32_16x16x32_bf16 v[72:75], a[72:75], v[56:59], v[72:75]
s_waitcnt lgkmcnt(1)
ds_read_b128 v[36:39], v2 offset:10400
v_mfma_f32_16x16x32_bf16 v[76:79], a[72:75], v[60:63], v[76:79]
s_waitcnt vmcnt(14)
ds_read_b128 v[40:43], v2 offset:18720
v_mfma_f32_16x16x32_bf16 v[80:83], a[76:79], v[48:51], v[80:83]
buffer_load_dwordx4 a[72:75], v1, s[44:47], s68 offen offset:2048 sc1
v_mfma_f32_16x16x32_bf16 v[84:87], a[76:79], v[52:55], v[84:87]
ds_read_b128 v[44:47], v2 offset:27040
v_mfma_f32_16x16x32_bf16 v[88:91], a[76:79], v[56:59], v[88:91]
v_mfma_f32_16x16x32_bf16 v[92:95], a[76:79], v[60:63], v[92:95]
s_waitcnt vmcnt(14) lgkmcnt(3)
v_mfma_f32_16x16x32_bf16 v[64:67], a[80:83], v[32:35], v[64:67]
s_waitcnt lgkmcnt(2)
buffer_load_dwordx4 a[76:79], v1, s[44:47], s68 offen offset:3072 sc1
v_mfma_f32_16x16x32_bf16 v[68:71], a[80:83], v[36:39], v[68:71]
s_waitcnt lgkmcnt(1)
ds_read_b128 v[48:51], v2 offset:3120
v_mfma_f32_16x16x32_bf16 v[72:75], a[80:83], v[40:43], v[72:75]
s_waitcnt lgkmcnt(1)
ds_read_b128 v[52:55], v2 offset:11440
v_mfma_f32_16x16x32_bf16 v[76:79], a[80:83], v[44:47], v[76:79]
s_waitcnt vmcnt(14)
ds_read_b128 v[56:59], v2 offset:19760
v_mfma_f32_16x16x32_bf16 v[80:83], a[84:87], v[32:35], v[80:83]
s_add_u32 s68, s68, 4096
buffer_load_dwordx4 a[80:83], v1, s[44:47], s68 offen offset:0 sc1
v_mfma_f32_16x16x32_bf16 v[84:87], a[84:87], v[36:39], v[84:87]
ds_read_b128 v[60:63], v2 offset:28080
v_mfma_f32_16x16x32_bf16 v[88:91], a[84:87], v[40:43], v[88:91]
v_mfma_f32_16x16x32_bf16 v[92:95], a[84:87], v[44:47], v[92:95]
s_waitcnt vmcnt(14) lgkmcnt(3)
v_mfma_f32_16x16x32_bf16 v[64:67], a[88:91], v[48:51], v[64:67]
s_waitcnt lgkmcnt(2)
buffer_load_dwordx4 a[84:87], v1, s[44:47], s68 offen offset:1024 sc1
v_mfma_f32_16x16x32_bf16 v[68:71], a[88:91], v[52:55], v[68:71]
s_waitcnt lgkmcnt(1)
ds_read_b128 v[32:35], v2 offset:4160
v_mfma_f32_16x16x32_bf16 v[72:75], a[88:91], v[56:59], v[72:75]
s_waitcnt lgkmcnt(1)
ds_read_b128 v[36:39], v2 offset:12480
v_mfma_f32_16x16x32_bf16 v[76:79], a[88:91], v[60:63], v[76:79]
s_waitcnt vmcnt(14)
ds_read_b128 v[40:43], v2 offset:20800
v_mfma_f32_16x16x32_bf16 v[80:83], a[92:95], v[48:51], v[80:83]
buffer_load_dwordx4 a[88:91], v1, s[44:47], s68 offen offset:2048 sc1
v_mfma_f32_16x16x32_bf16 v[84:87], a[92:95], v[52:55], v[84:87]
ds_read_b128 v[44:47], v2 offset:29120
v_mfma_f32_16x16x32_bf16 v[88:91], a[92:95], v[56:59], v[88:91]
v_mfma_f32_16x16x32_bf16 v[92:95], a[92:95], v[60:63], v[92:95]
s_waitcnt vmcnt(14) lgkmcnt(3)
v_mfma_f32_16x16x32_bf16 v[64:67], a[96:99], v[32:35], v[64:67]
s_waitcnt lgkmcnt(2)
buffer_load_dwordx4 a[92:95], v1, s[44:47], s68 offen offset:3072 sc1
v_mfma_f32_16x16x32_bf16 v[68:71], a[96:99], v[36:39], v[68:71]
s_waitcnt lgkmcnt(1)
ds_read_b128 v[48:51], v2 offset:5200
v_mfma_f32_16x16x32_bf16 v[72:75], a[96:99], v[40:43], v[72:75]
s_waitcnt lgkmcnt(1)
ds_read_b128 v[52:55], v2 offset:13520
v_mfma_f32_16x16x32_bf16 v[76:79], a[96:99], v[44:47], v[76:79]
s_waitcnt vmcnt(14)
ds_read_b128 v[56:59], v2 offset:21840
v_mfma_f32_16x16x32_bf16 v[80:83], a[100:103], v[32:35], v[80:83]
s_add_u32 s68, s68, 4096
buffer_load_dwordx4 a[96:99], v1, s[44:47], s68 offen offset:0 sc1
v_mfma_f32_16x16x32_bf16 v[84:87], a[100:103], v[36:39], v[84:87]
ds_read_b128 v[60:63], v2 offset:30160
v_mfma_f32_16x16x32_bf16 v[88:91], a[100:103], v[40:43], v[88:91]
v_mfma_f32_16x16x32_bf16 v[92:95], a[100:103], v[44:47], v[92:95]
s_waitcnt vmcnt(14) lgkmcnt(3)
v_mfma_f32_16x16x32_bf16 v[64:67], a[104:107], v[48:51], v[64:67]
s_waitcnt lgkmcnt(2)
buffer_load_dwordx4 a[100:103], v1, s[44:47], s68 offen offset:1024 sc1
v_mfma_f32_16x16x32_bf16 v[68:71], a[104:107], v[52:55], v[68:71]
s_waitcnt lgkmcnt(1)
ds_read_b128 v[32:35], v2 offset:6240
v_mfma_f32_16x16x32_bf16 v[72:75], a[104:107], v[56:59], v[72:75]
s_waitcnt lgkmcnt(1)
ds_read_b128 v[36:39], v2 offset:14560
v_mfma_f32_16x16x32_bf16 v[76:79], a[104:107], v[60:63], v[76:79]
s_waitcnt vmcnt(14)
ds_read_b128 v[40:43], v2 offset:22880
v_mfma_f32_16x16x32_bf16 v[80:83], a[108:111], v[48:51], v[80:83]
buffer_load_dwordx4 a[104:107], v1, s[44:47], s68 offen offset:2048 sc1
v_mfma_f32_16x16x32_bf16 v[84:87], a[108:111], v[52:55], v[84:87]
ds_read_b128 v[44:47], v2 offset:31200
v_mfma_f32_16x16x32_bf16 v[88:91], a[108:111], v[56:59], v[88:91]
v_mfma_f32_16x16x32_bf16 v[92:95], a[108:111], v[60:63], v[92:95]
s_waitcnt vmcnt(14) lgkmcnt(3)
v_mfma_f32_16x16x32_bf16 v[64:67], a[112:115], v[32:35], v[64:67]
s_waitcnt lgkmcnt(2)
buffer_load_dwordx4 a[108:111], v1, s[44:47], s68 offen offset:3072 sc1
v_mfma_f32_16x16x32_bf16 v[68:71], a[112:115], v[36:39], v[68:71]
s_waitcnt lgkmcnt(1)
ds_read_b128 v[48:51], v2 offset:7280
v_mfma_f32_16x16x32_bf16 v[72:75], a[112:115], v[40:43], v[72:75]
s_waitcnt lgkmcnt(1)
ds_read_b128 v[52:55], v2 offset:15600
v_mfma_f32_16x16x32_bf16 v[76:79], a[112:115], v[44:47], v[76:79]
s_waitcnt vmcnt(14)
ds_read_b128 v[56:59], v2 offset:23920
v_mfma_f32_16x16x32_bf16 v[80:83], a[116:119], v[32:35], v[80:83]
s_add_u32 s68, s68, 4096
buffer_load_dwordx4 a[112:115], v1, s[44:47], s68 offen offset:0 sc1
v_mfma_f32_16x16x32_bf16 v[84:87], a[116:119], v[36:39], v[84:87]
ds_read_b128 v[60:63], v2 offset:32240
v_mfma_f32_16x16x32_bf16 v[88:91], a[116:119], v[40:43], v[88:91]
v_mfma_f32_16x16x32_bf16 v[92:95], a[116:119], v[44:47], v[92:95]
s_waitcnt vmcnt(14) lgkmcnt(3)
v_mfma_f32_16x16x32_bf16 v[64:67], a[120:123], v[48:51], v[64:67]
s_waitcnt lgkmcnt(2)
buffer_load_dwordx4 a[116:119], v1, s[44:47], s68 offen offset:1024 sc1
v_mfma_f32_16x16x32_bf16 v[68:71], a[120:123], v[52:55], v[68:71]
s_waitcnt lgkmcnt(1)
ds_read_b128 v[32:35], v2 offset:0
v_mfma_f32_16x16x32_bf16 v[72:75], a[120:123], v[56:59], v[72:75]
s_waitcnt lgkmcnt(1)
ds_read_b128 v[36:39], v2 offset:8320
v_mfma_f32_16x16x32_bf16 v[76:79], a[120:123], v[60:63], v[76:79]
s_waitcnt vmcnt(14)
ds_read_b128 v[40:43], v2 offset:16640
v_mfma_f32_16x16x32_bf16 v[80:83], a[124:127], v[48:51], v[80:83]
buffer_load_dwordx4 a[120:123], v1, s[44:47], s68 offen offset:2048 sc1
v_mfma_f32_16x16x32_bf16 v[84:87], a[124:127], v[52:55], v[84:87]
ds_read_b128 v[44:47], v2 offset:24960
v_mfma_f32_16x16x32_bf16 v[88:91], a[124:127], v[56:59], v[88:91]
v_mfma_f32_16x16x32_bf16 v[92:95], a[124:127], v[60:63], v[92:95]
s_waitcnt vmcnt(14) lgkmcnt(3)
v_mfma_f32_16x16x32_bf16 v[96:99], a[64:67], v[32:35], 0
s_waitcnt lgkmcnt(2)
buffer_load_dwordx4 a[124:127], v1, s[44:47], s68 offen offset:3072 sc1
v_mfma_f32_16x16x32_bf16 v[100:103], a[64:67], v[36:39], 0
s_waitcnt lgkmcnt(1)
ds_read_b128 v[48:51], v2 offset:1040
v_mfma_f32_16x16x32_bf16 v[104:107], a[64:67], v[40:43], 0
s_waitcnt lgkmcnt(1)
ds_read_b128 v[52:55], v2 offset:9360
v_mfma_f32_16x16x32_bf16 v[108:111], a[64:67], v[44:47], 0
s_waitcnt vmcnt(14)
ds_read_b128 v[56:59], v2 offset:17680
v_mfma_f32_16x16x32_bf16 v[112:115], a[68:71], v[32:35], 0
v_mfma_f32_16x16x32_bf16 v[116:119], a[68:71], v[36:39], 0
ds_read_b128 v[60:63], v2 offset:26000
v_mfma_f32_16x16x32_bf16 v[120:123], a[68:71], v[40:43], 0
v_mfma_f32_16x16x32_bf16 v[124:127], a[68:71], v[44:47], 0
s_waitcnt vmcnt(13) lgkmcnt(3)
v_mfma_f32_16x16x32_bf16 v[96:99], a[72:75], v[48:51], v[96:99]
s_waitcnt lgkmcnt(2)
v_mfma_f32_16x16x32_bf16 v[100:103], a[72:75], v[52:55], v[100:103]
s_waitcnt lgkmcnt(1)
ds_read_b128 v[32:35], v2 offset:2080
v_mfma_f32_16x16x32_bf16 v[104:107], a[72:75], v[56:59], v[104:107]
s_waitcnt lgkmcnt(1)
ds_read_b128 v[36:39], v2 offset:10400
v_mfma_f32_16x16x32_bf16 v[108:111], a[72:75], v[60:63], v[108:111]
s_waitcnt vmcnt(12)
ds_read_b128 v[40:43], v2 offset:18720
v_mfma_f32_16x16x32_bf16 v[112:115], a[76:79], v[48:51], v[112:115]
v_mfma_f32_16x16x32_bf16 v[116:119], a[76:79], v[52:55], v[116:119]
ds_read_b128 v[44:47], v2 offset:27040
v_mfma_f32_16x16x32_bf16 v[120:123], a[76:79], v[56:59], v[120:123]
v_mfma_f32_16x16x32_bf16 v[124:127], a[76:79], v[60:63], v[124:127]
s_waitcnt vmcnt(11) lgkmcnt(3)
v_mfma_f32_16x16x32_bf16 v[96:99], a[80:83], v[32:35], v[96:99]
s_waitcnt lgkmcnt(2)
v_mfma_f32_16x16x32_bf16 v[100:103], a[80:83], v[36:39], v[100:103]
s_waitcnt lgkmcnt(1)
ds_read_b128 v[48:51], v2 offset:3120
v_mfma_f32_16x16x32_bf16 v[104:107], a[80:83], v[40:43], v[104:107]
s_waitcnt lgkmcnt(1)
ds_read_b128 v[52:55], v2 offset:11440
v_mfma_f32_16x16x32_bf16 v[108:111], a[80:83], v[44:47], v[108:111]
s_waitcnt vmcnt(10)
ds_read_b128 v[56:59], v2 offset:19760
v_mfma_f32_16x16x32_bf16 v[112:115], a[84:87], v[32:35], v[112:115]
v_mfma_f32_16x16x32_bf16 v[116:119], a[84:87], v[36:39], v[116:119]
ds_read_b128 v[60:63], v2 offset:28080
v_mfma_f32_16x16x32_bf16 v[120:123], a[84:87], v[40:43], v[120:123]
v_mfma_f32_16x16x32_bf16 v[124:127], a[84:87], v[44:47], v[124:127]
s_waitcnt vmcnt(9) lgkmcnt(3)
v_mfma_f32_16x16x32_bf16 v[96:99], a[88:91], v[48:51], v[96:99]
s_waitcnt lgkmcnt(2)
v_mfma_f32_16x16x32_bf16 v[100:103], a[88:91], v[52:55], v[100:103]
s_waitcnt lgkmcnt(1)
ds_read_b128 v[32:35], v2 offset:4160
v_mfma_f32_16x16x32_bf16 v[104:107], a[88:91], v[56:59], v[104:107]
s_waitcnt lgkmcnt(1)
ds_read_b128 v[36:39], v2 offset:12480
v_mfma_f32_16x16x32_bf16 v[108:111], a[88:91], v[60:63], v[108:111]
s_waitcnt vmcnt(8)
ds_read_b128 v[40:43], v2 offset:20800
v_mfma_f32_16x16x32_bf16 v[112:115], a[92:95], v[48:51], v[112:115]
v_mfma_f32_16x16x32_bf16 v[116:119], a[92:95], v[52:55], v[116:119]
ds_read_b128 v[44:47], v2 offset:29120
v_mfma_f32_16x16x32_bf16 v[120:123], a[92:95], v[56:59], v[120:123]
v_mfma_f32_16x16x32_bf16 v[124:127], a[92:95], v[60:63], v[124:127]
s_waitcnt vmcnt(7) lgkmcnt(3)
v_mfma_f32_16x16x32_bf16 v[96:99], a[96:99], v[32:35], v[96:99]
s_waitcnt lgkmcnt(2)
v_mfma_f32_16x16x32_bf16 v[100:103], a[96:99], v[36:39], v[100:103]
s_waitcnt lgkmcnt(1)
ds_read_b128 v[48:51], v2 offset:5200
v_mfma_f32_16x16x32_bf16 v[104:107], a[96:99], v[40:43], v[104:107]
s_waitcnt lgkmcnt(1)
ds_read_b128 v[52:55], v2 offset:13520
v_mfma_f32_16x16x32_bf16 v[108:111], a[96:99], v[44:47], v[108:111]
s_waitcnt vmcnt(6)
ds_read_b128 v[56:59], v2 offset:21840
v_mfma_f32_16x16x32_bf16 v[112:115], a[100:103], v[32:35], v[112:115]
v_mfma_f32_16x16x32_bf16 v[116:119], a[100:103], v[36:39], v[116:119]
ds_read_b128 v[60:63], v2 offset:30160
v_mfma_f32_16x16x32_bf16 v[120:123], a[100:103], v[40:43], v[120:123]
v_mfma_f32_16x16x32_bf16 v[124:127], a[100:103], v[44:47], v[124:127]
s_waitcnt vmcnt(5) lgkmcnt(3)
v_mfma_f32_16x16x32_bf16 v[96:99], a[104:107], v[48:51], v[96:99]
s_waitcnt lgkmcnt(2)
v_mfma_f32_16x16x32_bf16 v[100:103], a[104:107], v[52:55], v[100:103]
s_waitcnt lgkmcnt(1)
ds_read_b128 v[32:35], v2 offset:6240
v_mfma_f32_16x16x32_bf16 v[104:107], a[104:107], v[56:59], v[104:107]
s_waitcnt lgkmcnt(1)
ds_read_b128 v[36:39], v2 offset:14560
v_mfma_f32_16x16x32_bf16 v[108:111], a[104:107], v[60:63], v[108:111]
s_waitcnt vmcnt(4)
ds_read_b128 v[40:43], v2 offset:22880
v_mfma_f32_16x16x32_bf16 v[112:115], a[108:111], v[48:51], v[112:115]
v_mfma_f32_16x16x32_bf16 v[116:119], a[108:111], v[52:55], v[116:119]
ds_read_b128 v[44:47], v2 offset:31200
v_mfma_f32_16x16x32_bf16 v[120:123], a[108:111], v[56:59], v[120:123]
v_mfma_f32_16x16x32_bf16 v[124:127], a[108:111], v[60:63], v[124:127]
s_waitcnt vmcnt(3) lgkmcnt(3)
v_mfma_f32_16x16x32_bf16 v[96:99], a[112:115], v[32:35], v[96:99]
s_waitcnt lgkmcnt(2)
v_mfma_f32_16x16x32_bf16 v[100:103], a[112:115], v[36:39], v[100:103]
s_waitcnt lgkmcnt(1)
ds_read_b128 v[48:51], v2 offset:7280
v_mfma_f32_16x16x32_bf16 v[104:107], a[112:115], v[40:43], v[104:107]
s_waitcnt lgkmcnt(1)
ds_read_b128 v[52:55], v2 offset:15600
v_mfma_f32_16x16x32_bf16 v[108:111], a[112:115], v[44:47], v[108:111]
s_waitcnt vmcnt(2)
ds_read_b128 v[56:59], v2 offset:23920
v_mfma_f32_16x16x32_bf16 v[112:115], a[116:119], v[32:35], v[112:115]
v_mfma_f32_16x16x32_bf16 v[116:119], a[116:119], v[36:39], v[116:119]
ds_read_b128 v[60:63], v2 offset:32240
v_mfma_f32_16x16x32_bf16 v[120:123], a[116:119], v[40:43], v[120:123]
v_mfma_f32_16x16x32_bf16 v[124:127], a[116:119], v[44:47], v[124:127]
s_waitcnt vmcnt(1) lgkmcnt(3)
v_mfma_f32_16x16x32_bf16 v[96:99], a[120:123], v[48:51], v[96:99]
s_waitcnt lgkmcnt(2)
v_mfma_f32_16x16x32_bf16 v[100:103], a[120:123], v[52:55], v[100:103]
s_waitcnt lgkmcnt(1)
v_mfma_f32_16x16x32_bf16 v[104:107], a[120:123], v[56:59], v[104:107]
s_waitcnt lgkmcnt(0)
v_mfma_f32_16x16x32_bf16 v[108:111], a[120:123], v[60:63], v[108:111]
s_waitcnt vmcnt(0)
v_mfma_f32_16x16x32_bf16 v[112:115], a[124:127], v[48:51], v[112:115]
v_mfma_f32_16x16x32_bf16 v[116:119], a[124:127], v[52:55], v[116:119]
v_mfma_f32_16x16x32_bf16 v[120:123], a[124:127], v[56:59], v[120:123]
v_mfma_f32_16x16x32_bf16 v[124:127], a[124:127], v[60:63], v[124:127]
s_nop 7
s_nop 7
v_max3_f32 v28, v64, v65, v28
v_max3_f32 v28, v66, v67, v28
v_max3_f32 v29, v68, v69, v29
v_max3_f32 v29, v70, v71, v29
v_max3_f32 v30, v72, v73, v30
v_max3_f32 v30, v74, v75, v30
v_max3_f32 v31, v76, v77, v31
v_max3_f32 v31, v78, v79, v31
v_max3_f32 v28, v80, v81, v28
v_max3_f32 v28, v82, v83, v28
v_max3_f32 v29, v84, v85, v29
v_max3_f32 v29, v86, v87, v29
v_max3_f32 v30, v88, v89, v30
v_max3_f32 v30, v90, v91, v30
v_max3_f32 v31, v92, v93, v31
v_max3_f32 v31, v94, v95, v31
v_max3_f32 v28, v96, v97, v28
v_max3_f32 v28, v98, v99, v28
v_max3_f32 v29, v100, v101, v29
v_max3_f32 v29, v102, v103, v29
v_max3_f32 v30, v104, v105, v30
v_max3_f32 v30, v106, v107, v30
v_max3_f32 v31, v108, v109, v31
v_max3_f32 v31, v110, v111, v31
v_max3_f32 v28, v112, v113, v28
v_max3_f32 v28, v114, v115, v28
v_max3_f32 v29, v116, v117, v29
v_max3_f32 v29, v118, v119, v29
v_max3_f32 v30, v120, v121, v30
v_max3_f32 v30, v122, v123, v30
v_max3_f32 v31, v124, v125, v31
v_max3_f32 v31, v126, v127, v31
s_add_u32 s73, s73, 262144
s_add_u32 s74, s74, 1
s_cmp_lt_u32 s74, 8
s_cbranch_scc1 L_mx_loop
s_lshl_b32 s70, s64, 10
s_add_u32 s70, s70, 102912
v_lshrrev_b32 v12, 2, v1
v_add_u32 v12, s70, v12
ds_write_b32 v12, v28 offset:0
ds_write_b32 v12, v29 offset:256
ds_write_b32 v12, v30 offset:512
ds_write_b32 v12, v31 offset:768
s_waitcnt lgkmcnt(0)
s_barrier
v_lshrrev_b32 v13, 4, v1
v_and_b32 v14, 15, v13
v_lshlrev_b32 v12, 2, v14
v_add_u32 v12, 102912, v12
ds_read_b32 v64, v12 offset:0
ds_read_b32 v65, v12 offset:64
ds_read_b32 v66, v12 offset:128
ds_read_b32 v67, v12 offset:192
ds_read_b32 v68, v12 offset:1024
ds_read_b32 v69, v12 offset:1088
ds_read_b32 v70, v12 offset:1152
ds_read_b32 v71, v12 offset:1216
s_waitcnt lgkmcnt(0)
ds_read_b32 v72, v12 offset:2048
ds_read_b32 v73, v12 offset:2112
ds_read_b32 v74, v12 offset:2176
ds_read_b32 v75, v12 offset:2240
ds_read_b32 v76, v12 offset:3072
ds_read_b32 v77, v12 offset:3136
ds_read_b32 v78, v12 offset:3200
ds_read_b32 v79, v12 offset:3264
s_waitcnt lgkmcnt(0)
v_max3_f32 v28, v64, v65, v28
v_max3_f32 v28, v66, v67, v28
v_max3_f32 v28, v68, v69, v28
v_max3_f32 v28, v70, v71, v28
v_max3_f32 v28, v72, v73, v28
v_max3_f32 v28, v74, v75, v28
v_max3_f32 v28, v76, v77, v28
v_max3_f32 v28, v78, v79, v28
ds_read_b32 v64, v12 offset:256
ds_read_b32 v65, v12 offset:320
ds_read_b32 v66, v12 offset:384
ds_read_b32 v67, v12 offset:448
ds_read_b32 v68, v12 offset:1280
ds_read_b32 v69, v12 offset:1344
ds_read_b32 v70, v12 offset:1408
ds_read_b32 v71, v12 offset:1472
s_waitcnt lgkmcnt(0)
ds_read_b32 v72, v12 offset:2304
ds_read_b32 v73, v12 offset:2368
ds_read_b32 v74, v12 offset:2432
ds_read_b32 v75, v12 offset:2496
ds_read_b32 v76, v12 offset:3328
ds_read_b32 v77, v12 offset:3392
ds_read_b32 v78, v12 offset:3456
ds_read_b32 v79, v12 offset:3520
s_waitcnt lgkmcnt(0)
v_max3_f32 v29, v64, v65, v29
v_max3_f32 v29, v66, v67, v29
v_max3_f32 v29, v68, v69, v29
v_max3_f32 v29, v70, v71, v29
v_max3_f32 v29, v72, v73, v29
v_max3_f32 v29, v74, v75, v29
v_max3_f32 v29, v76, v77, v29
v_max3_f32 v29, v78, v79, v29
ds_read_b32 v64, v12 offset:512
ds_read_b32 v65, v12 offset:576
ds_read_b32 v66, v12 offset:640
ds_read_b32 v67, v12 offset:704
ds_read_b32 v68, v12 offset:1536
ds_read_b32 v69, v12 offset:1600
ds_read_b32 v70, v12 offset:1664
ds_read_b32 v71, v12 offset:1728
s_waitcnt lgkmcnt(0)
ds_read_b32 v72, v12 offset:2560
ds_read_b32 v73, v12 offset:2624
ds_read_b32 v74, v12 offset:2688
ds_read_b32 v75, v12 offset:2752
ds_read_b32 v76, v12 offset:3584
ds_read_b32 v77, v12 offset:3648
ds_read_b32 v78, v12 offset:3712
ds_read_b32 v79, v12 offset:3776
s_waitcnt lgkmcnt(0)
v_max3_f32 v30, v64, v65, v30
v_max3_f32 v30, v66, v67, v30
v_max3_f32 v30, v68, v69, v30
v_max3_f32 v30, v70, v71, v30
v_max3_f32 v30, v72, v73, v30
v_max3_f32 v30, v74, v75, v30
v_max3_f32 v30, v76, v77, v30
v_max3_f32 v30, v78, v79, v30
ds_read_b32 v64, v12 offset:768
ds_read_b32 v65, v12 offset:832
ds_read_b32 v66, v12 offset:896
ds_read_b32 v67, v12 offset:960
ds_read_b32 v68, v12 offset:1792
ds_read_b32 v69, v12 offset:1856
ds_read_b32 v70, v12 offset:1920
ds_read_b32 v71, v12 offset:1984
s_waitcnt lgkmcnt(0)
ds_read_b32 v72, v12 offset:2816
ds_read_b32 v73, v12 offset:2880
ds_read_b32 v74, v12 offset:2944
ds_read_b32 v75, v12 offset:3008
ds_read_b32 v76, v12 offset:3840
ds_read_b32 v77, v12 offset:3904
ds_read_b32 v78, v12 offset:3968
ds_read_b32 v79, v12 offset:4032
s_waitcnt lgkmcnt(0)
v_max3_f32 v31, v64, v65, v31
v_max3_f32 v31, v66, v67, v31
v_max3_f32 v31, v68, v69, v31
v_max3_f32 v31, v70, v71, v31
v_max3_f32 v31, v72, v73, v31
v_max3_f32 v31, v74, v75, v31
v_max3_f32 v31, v76, v77, v31
v_max3_f32 v31, v78, v79, v31
s_barrier
s_mov_b32 s93, 16
s_lshl_b32 s70, s65, 21
s_lshl_b32 s71, s64, 15
s_add_u32 s68, s70, s71
s_add_u32 s69, s68, 131072
buffer_load_dwordx4 a[64:67], v1, s[44:47], s68 offen offset:0 sc1
buffer_load_dwordx4 a[68:71], v1, s[44:47], s68 offen offset:1024 sc1
buffer_load_dwordx4 a[72:75], v1, s[44:47], s68 offen offset:2048 sc1
buffer_load_dwordx4 a[76:79], v1, s[44:47], s68 offen offset:3072 sc1
s_add_u32 s68, s68, 4096
buffer_load_dwordx4 a[80:83], v1, s[44:47], s68 offen offset:0 sc1
buffer_load_dwordx4 a[84:87], v1, s[44:47], s68 offen offset:1024 sc1
buffer_load_dwordx4 a[88:91], v1, s[44:47], s68 offen offset:2048 sc1
buffer_load_dwordx4 a[92:95], v1, s[44:47], s68 offen offset:3072 sc1
s_add_u32 s68, s68, 4096
buffer_load_dwordx4 a[96:99], v1, s[44:47], s68 offen offset:0 sc1
buffer_load_dwordx4 a[100:103], v1, s[44:47], s68 offen offset:1024 sc1
buffer_load_dwordx4 a[104:107], v1, s[44:47], s68 offen offset:2048 sc1
buffer_load_dwordx4 a[108:111], v1, s[44:47], s68 offen offset:3072 sc1
s_add_u32 s68, s68, 4096
buffer_load_dwordx4 a[112:115], v1, s[44:47], s68 offen offset:0 sc1
buffer_load_dwordx4 a[116:119], v1, s[44:47], s68 offen offset:1024 sc1
buffer_load_dwordx4 a[120:123], v1, s[44:47], s68 offen offset:2048 sc1
ds_read_b128 v[32:35], v2 offset:0
ds_read_b128 v[36:39], v2 offset:8320
ds_read_b128 v[40:43], v2 offset:16640
ds_read_b128 v[44:47], v2 offset:24960
v_mov_b32 v3, v1
s_lshl_b32 s70, s64, 13
v_add_u32 v4, s70, v1
v_mov_b32 v8, 0
v_mov_b32 v9, 0
v_mov_b32 v10, 0
v_mov_b32 v11, 0
s_waitcnt vmcnt(15)
v_accvgpr_write_b32 a0, 0
v_accvgpr_write_b32 a1, 0
v_accvgpr_write_b32 a2, 0
v_accvgpr_write_b32 a3, 0
v_accvgpr_write_b32 a4, 0
v_accvgpr_write_b32 a5, 0
v_accvgpr_write_b32 a6, 0
v_accvgpr_write_b32 a7, 0
v_accvgpr_write_b32 a8, 0
v_accvgpr_write_b32 a9, 0
v_accvgpr_write_b32 a10, 0
v_accvgpr_write_b32 a11, 0
v_accvgpr_write_b32 a12, 0
v_accvgpr_write_b32 a13, 0
v_accvgpr_write_b32 a14, 0
v_accvgpr_write_b32 a15, 0
v_accvgpr_write_b32 a16, 0
v_accvgpr_write_b32 a17, 0
v_accvgpr_write_b32 a18, 0
v_accvgpr_write_b32 a19, 0
v_accvgpr_write_b32 a20, 0
v_accvgpr_write_b32 a21, 0
v_accvgpr_write_b32 a22, 0
v_accvgpr_write_b32 a23, 0
v_accvgpr_write_b32 a24, 0
v_accvgpr_write_b32 a25, 0
v_accvgpr_write_b32 a26, 0
v_accvgpr_write_b32 a27, 0
v_accvgpr_write_b32 a28, 0
v_accvgpr_write_b32 a29, 0
v_accvgpr_write_b32 a30, 0
v_accvgpr_write_b32 a31, 0
v_accvgpr_write_b32 a32, 0
v_accvgpr_write_b32 a33, 0
v_accvgpr_write_b32 a34, 0
v_accvgpr_write_b32 a35, 0
v_accvgpr_write_b32 a36, 0
v_accvgpr_write_b32 a37, 0
v_accvgpr_write_b32 a38, 0
v_accvgpr_write_b32 a39, 0
v_accvgpr_write_b32 a40, 0
v_accvgpr_write_b32 a41, 0
v_accvgpr_write_b32 a42, 0
v_accvgpr_write_b32 a43, 0
v_accvgpr_write_b32 a44, 0
v_accvgpr_write_b32 a45, 0
v_accvgpr_write_b32 a46, 0
v_accvgpr_write_b32 a47, 0
v_accvgpr_write_b32 a48, 0
v_accvgpr_write_b32 a49, 0
v_accvgpr_write_b32 a50, 0
v_accvgpr_write_b32 a51, 0
v_accvgpr_write_b32 a52, 0
v_accvgpr_write_b32 a53, 0
v_accvgpr_write_b32 a54, 0
v_accvgpr_write_b32 a55, 0
v_accvgpr_write_b32 a56, 0
v_accvgpr_write_b32 a57, 0
v_accvgpr_write_b32 a58, 0
v_accvgpr_write_b32 a59, 0
v_accvgpr_write_b32 a60, 0
v_accvgpr_write_b32 a61, 0
v_accvgpr_write_b32 a62, 0
v_accvgpr_write_b32 a63, 0
s_waitcnt vmcnt(14) lgkmcnt(3)
v_mfma_f32_16x16x32_bf16 v[64:67], a[64:67], v[32:35], 0
s_waitcnt lgkmcnt(2)
buffer_load_dwordx4 a[124:127], v1, s[44:47], s68 offen offset:3072 sc1
v_mfma_f32_16x16x32_bf16 v[68:71], a[64:67], v[36:39], 0
s_waitcnt lgkmcnt(1)
ds_read_b128 v[48:51], v2 offset:1040
v_mfma_f32_16x16x32_bf16 v[72:75], a[64:67], v[40:43], 0
s_waitcnt lgkmcnt(1)
ds_read_b128 v[52:55], v2 offset:9360
v_mfma_f32_16x16x32_bf16 v[76:79], a[64:67], v[44:47], 0
s_waitcnt vmcnt(14)
ds_read_b128 v[56:59], v2 offset:17680
v_mfma_f32_16x16x32_bf16 v[80:83], a[68:71], v[32:35], 0
s_add_u32 s68, s68, 4096
buffer_load_dwordx4 a[64:67], v1, s[44:47], s68 offen offset:0 sc1
v_mfma_f32_16x16x32_bf16 v[84:87], a[68:71], v[36:39], 0
ds_read_b128 v[60:63], v2 offset:26000
v_mfma_f32_16x16x32_bf16 v[88:91], a[68:71], v[40:43], 0
v_mfma_f32_16x16x32_bf16 v[92:95], a[68:71], v[44:47], 0
s_waitcnt vmcnt(14) lgkmcnt(3)
v_mfma_f32_16x16x32_bf16 v[64:67], a[72:75], v[48:51], v[64:67]
s_waitcnt lgkmcnt(2)
buffer_load_dwordx4 a[68:71], v1, s[44:47], s68 offen offset:1024 sc1
v_mfma_f32_16x16x32_bf16 v[68:71], a[72:75], v[52:55], v[68:71]
s_waitcnt lgkmcnt(1)
ds_read_b128 v[32:35], v2 offset:2080
v_mfma_f32_16x16x32_bf16 v[72:75], a[72:75], v[56:59], v[72:75]
s_waitcnt lgkmcnt(1)
ds_read_b128 v[36:39], v2 offset:10400
v_mfma_f32_16x16x32_bf16 v[76:79], a[72:75], v[60:63], v[76:79]
s_waitcnt vmcnt(14)
ds_read_b128 v[40:43], v2 offset:18720
v_mfma_f32_16x16x32_bf16 v[80:83], a[76:79], v[48:51], v[80:83]
buffer_load_dwordx4 a[72:75], v1, s[44:47], s68 offen offset:2048 sc1
v_mfma_f32_16x16x32_bf16 v[84:87], a[76:79], v[52:55], v[84:87]
ds_read_b128 v[44:47], v2 offset:27040
v_mfma_f32_16x16x32_bf16 v[88:91], a[76:79], v[56:59], v[88:91]
v_mfma_f32_16x16x32_bf16 v[92:95], a[76:79], v[60:63], v[92:95]
s_waitcnt vmcnt(14) lgkmcnt(3)
v_mfma_f32_16x16x32_bf16 v[64:67], a[80:83], v[32:35], v[64:67]
s_waitcnt lgkmcnt(2)
buffer_load_dwordx4 a[76:79], v1, s[44:47], s68 offen offset:3072 sc1
v_mfma_f32_16x16x32_bf16 v[68:71], a[80:83], v[36:39], v[68:71]
s_waitcnt lgkmcnt(1)
ds_read_b128 v[48:51], v2 offset:3120
v_mfma_f32_16x16x32_bf16 v[72:75], a[80:83], v[40:43], v[72:75]
s_waitcnt lgkmcnt(1)
ds_read_b128 v[52:55], v2 offset:11440
v_mfma_f32_16x16x32_bf16 v[76:79], a[80:83], v[44:47], v[76:79]
s_waitcnt vmcnt(14)
ds_read_b128 v[56:59], v2 offset:19760
v_mfma_f32_16x16x32_bf16 v[80:83], a[84:87], v[32:35], v[80:83]
s_add_u32 s68, s68, 4096
buffer_load_dwordx4 a[80:83], v1, s[44:47], s68 offen offset:0 sc1
v_mfma_f32_16x16x32_bf16 v[84:87], a[84:87], v[36:39], v[84:87]
ds_read_b128 v[60:63], v2 offset:28080
v_mfma_f32_16x16x32_bf16 v[88:91], a[84:87], v[40:43], v[88:91]
v_mfma_f32_16x16x32_bf16 v[92:95], a[84:87], v[44:47], v[92:95]
s_waitcnt vmcnt(14) lgkmcnt(3)
v_mfma_f32_16x16x32_bf16 v[64:67], a[88:91], v[48:51], v[64:67]
s_waitcnt lgkmcnt(2)
buffer_load_dwordx4 a[84:87], v1, s[44:47], s68 offen offset:1024 sc1
v_mfma_f32_16x16x32_bf16 v[68:71], a[88:91], v[52:55], v[68:71]
s_waitcnt lgkmcnt(1)
ds_read_b128 v[32:35], v2 offset:4160
v_mfma_f32_16x16x32_bf16 v[72:75], a[88:91], v[56:59], v[72:75]
s_waitcnt lgkmcnt(1)
ds_read_b128 v[36:39], v2 offset:12480
v_mfma_f32_16x16x32_bf16 v[76:79], a[88:91], v[60:63], v[76:79]
s_waitcnt vmcnt(14)
ds_read_b128 v[40:43], v2 offset:20800
v_mfma_f32_16x16x32_bf16 v[80:83], a[92:95], v[48:51], v[80:83]
buffer_load_dwordx4 a[88:91], v1, s[44:47], s68 offen offset:2048 sc1
v_mfma_f32_16x16x32_bf16 v[84:87], a[92:95], v[52:55], v[84:87]
ds_read_b128 v[44:47], v2 offset:29120
v_mfma_f32_16x16x32_bf16 v[88:91], a[92:95], v[56:59], v[88:91]
v_mfma_f32_16x16x32_bf16 v[92:95], a[92:95], v[60:63], v[92:95]
s_waitcnt vmcnt(14) lgkmcnt(3)
v_mfma_f32_16x16x32_bf16 v[64:67], a[96:99], v[32:35], v[64:67]
s_waitcnt lgkmcnt(2)
buffer_load_dwordx4 a[92:95], v1, s[44:47], s68 offen offset:3072 sc1
v_mfma_f32_16x16x32_bf16 v[68:71], a[96:99], v[36:39], v[68:71]
s_waitcnt lgkmcnt(1)
ds_read_b128 v[48:51], v2 offset:5200
v_mfma_f32_16x16x32_bf16 v[72:75], a[96:99], v[40:43], v[72:75]
s_waitcnt lgkmcnt(1)
ds_read_b128 v[52:55], v2 offset:13520
v_mfma_f32_16x16x32_bf16 v[76:79], a[96:99], v[44:47], v[76:79]
s_waitcnt vmcnt(14)
ds_read_b128 v[56:59], v2 offset:21840
v_mfma_f32_16x16x32_bf16 v[80:83], a[100:103], v[32:35], v[80:83]
s_add_u32 s68, s68, 4096
buffer_load_dwordx4 a[96:99], v1, s[44:47], s68 offen offset:0 sc1
v_mfma_f32_16x16x32_bf16 v[84:87], a[100:103], v[36:39], v[84:87]
ds_read_b128 v[60:63], v2 offset:30160
v_mfma_f32_16x16x32_bf16 v[88:91], a[100:103], v[40:43], v[88:91]
v_mfma_f32_16x16x32_bf16 v[92:95], a[100:103], v[44:47], v[92:95]
s_waitcnt vmcnt(14) lgkmcnt(3)
v_mfma_f32_16x16x32_bf16 v[64:67], a[104:107], v[48:51], v[64:67]
s_waitcnt lgkmcnt(2)
buffer_load_dwordx4 a[100:103], v1, s[44:47], s68 offen offset:1024 sc1
v_mfma_f32_16x16x32_bf16 v[68:71], a[104:107], v[52:55], v[68:71]
s_waitcnt lgkmcnt(1)
ds_read_b128 v[32:35], v2 offset:6240
v_mfma_f32_16x16x32_bf16 v[72:75], a[104:107], v[56:59], v[72:75]
s_waitcnt lgkmcnt(1)
ds_read_b128 v[36:39], v2 offset:14560
v_mfma_f32_16x16x32_bf16 v[76:79], a[104:107], v[60:63], v[76:79]
s_waitcnt vmcnt(14)
ds_read_b128 v[40:43], v2 offset:22880
v_mfma_f32_16x16x32_bf16 v[80:83], a[108:111], v[48:51], v[80:83]
buffer_load_dwordx4 a[104:107], v1, s[44:47], s68 offen offset:2048 sc1
v_mfma_f32_16x16x32_bf16 v[84:87], a[108:111], v[52:55], v[84:87]
ds_read_b128 v[44:47], v2 offset:31200
v_mfma_f32_16x16x32_bf16 v[88:91], a[108:111], v[56:59], v[88:91]
v_mfma_f32_16x16x32_bf16 v[92:95], a[108:111], v[60:63], v[92:95]
s_waitcnt vmcnt(14) lgkmcnt(3)
v_mfma_f32_16x16x32_bf16 v[64:67], a[112:115], v[32:35], v[64:67]
s_waitcnt lgkmcnt(2)
buffer_load_dwordx4 a[108:111], v1, s[44:47], s68 offen offset:3072 sc1
v_mfma_f32_16x16x32_bf16 v[68:71], a[112:115], v[36:39], v[68:71]
s_waitcnt lgkmcnt(1)
ds_read_b128 v[48:51], v2 offset:7280
v_mfma_f32_16x16x32_bf16 v[72:75], a[112:115], v[40:43], v[72:75]
s_waitcnt lgkmcnt(1)
ds_read_b128 v[52:55], v2 offset:15600
v_mfma_f32_16x16x32_bf16 v[76:79], a[112:115], v[44:47], v[76:79]
s_waitcnt vmcnt(14)
ds_read_b128 v[56:59], v2 offset:23920
v_mfma_f32_16x16x32_bf16 v[80:83], a[116:119], v[32:35], v[80:83]
s_add_u32 s68, s68, 4096
buffer_load_dwordx4 a[112:115], v1, s[44:47], s68 offen offset:0 sc1
v_mfma_f32_16x16x32_bf16 v[84:87], a[116:119], v[36:39], v[84:87]
ds_read_b128 v[60:63], v2 offset:32240
v_mfma_f32_16x16x32_bf16 v[88:91], a[116:119], v[40:43], v[88:91]
v_mfma_f32_16x16x32_bf16 v[92:95], a[116:119], v[44:47], v[92:95]
s_waitcnt vmcnt(14) lgkmcnt(3)
v_mfma_f32_16x16x32_bf16 v[64:67], a[120:123], v[48:51], v[64:67]
s_waitcnt lgkmcnt(2)
buffer_load_dwordx4 a[116:119], v1, s[44:47], s68 offen offset:1024 sc1
v_mfma_f32_16x16x32_bf16 v[68:71], a[120:123], v[52:55], v[68:71]
s_waitcnt lgkmcnt(1)
ds_read_b128 v[32:35], v2 offset:0
v_mfma_f32_16x16x32_bf16 v[72:75], a[120:123], v[56:59], v[72:75]
s_waitcnt lgkmcnt(1)
ds_read_b128 v[36:39], v2 offset:8320
v_mfma_f32_16x16x32_bf16 v[76:79], a[120:123], v[60:63], v[76:79]
s_waitcnt vmcnt(14)
ds_read_b128 v[40:43], v2 offset:16640
v_mfma_f32_16x16x32_bf16 v[80:83], a[124:127], v[48:51], v[80:83]
buffer_load_dwordx4 a[120:123], v1, s[44:47], s68 offen offset:2048 sc1
v_mfma_f32_16x16x32_bf16 v[84:87], a[124:127], v[52:55], v[84:87]
ds_read_b128 v[44:47], v2 offset:24960
v_mfma_f32_16x16x32_bf16 v[88:91], a[124:127], v[56:59], v[88:91]
v_mfma_f32_16x16x32_bf16 v[92:95], a[124:127], v[60:63], v[92:95]
s_waitcnt vmcnt(14) lgkmcnt(3)
v_mfma_f32_16x16x32_bf16 v[96:99], a[64:67], v[32:35], 0
s_waitcnt lgkmcnt(2)
buffer_load_dwordx4 a[124:127], v1, s[44:47], s68 offen offset:3072 sc1
v_mfma_f32_16x16x32_bf16 v[100:103], a[64:67], v[36:39], 0
s_waitcnt lgkmcnt(1)
ds_read_b128 v[48:51], v2 offset:1040
v_mfma_f32_16x16x32_bf16 v[104:107], a[64:67], v[40:43], 0
s_waitcnt lgkmcnt(1)
ds_read_b128 v[52:55], v2 offset:9360
v_mfma_f32_16x16x32_bf16 v[108:111], a[64:67], v[44:47], 0
s_waitcnt vmcnt(14)
ds_read_b128 v[56:59], v2 offset:17680
v_sub_f32 v64, v64, v28
v_sub_f32 v65, v65, v28
v_mfma_f32_16x16x32_bf16 v[112:115], a[68:71], v[32:35], 0
s_add_u32 s68, s68, 233472
buffer_load_dwordx4 a[64:67], v1, s[44:47], s68 offen offset:0 sc1
v_exp_f32 v12, v64
v_mfma_f32_16x16x32_bf16 v[116:119], a[68:71], v[36:39], 0
ds_read_b128 v[60:63], v2 offset:26000
v_exp_f32 v13, v65
v_mfma_f32_16x16x32_bf16 v[120:123], a[68:71], v[40:43], 0
v_sub_f32 v66, v66, v28
v_sub_f32 v67, v67, v28
v_exp_f32 v14, v66
v_mfma_f32_16x16x32_bf16 v[124:127], a[68:71], v[44:47], 0
s_waitcnt vmcnt(14) lgkmcnt(3)
v_exp_f32 v15, v67
v_add_f32 v8, v8, v12
v_mfma_f32_16x16x32_bf16 v[96:99], a[72:75], v[48:51], v[96:99]
s_waitcnt lgkmcnt(2)
buffer_load_dwordx4 a[68:71], v1, s[44:47], s68 offen offset:1024 sc1
v_cvt_pk_bf16_f32 v20, v12, v13
v_mfma_f32_16x16x32_bf16 v[100:103], a[72:75], v[52:55], v[100:103]
s_waitcnt lgkmcnt(1)
ds_read_b128 v[32:35], v2 offset:2080
v_add_f32 v8, v8, v13
v_sub_f32 v80, v80, v28
v_mfma_f32_16x16x32_bf16 v[104:107], a[72:75], v[56:59], v[104:107]
s_waitcnt lgkmcnt(1)
ds_read_b128 v[36:39], v2 offset:10400
v_sub_f32 v81, v81, v28
v_exp_f32 v16, v80
v_mfma_f32_16x16x32_bf16 v[108:111], a[72:75], v[60:63], v[108:111]
s_waitcnt vmcnt(14)
ds_read_b128 v[40:43], v2 offset:18720
v_exp_f32 v17, v81
v_mfma_f32_16x16x32_bf16 v[112:115], a[76:79], v[48:51], v[112:115]
buffer_load_dwordx4 a[72:75], v1, s[44:47], s68 offen offset:2048 sc1
v_add_f32 v8, v8, v14
v_mfma_f32_16x16x32_bf16 v[116:119], a[76:79], v[52:55], v[116:119]
ds_read_b128 v[44:47], v2 offset:27040
v_cvt_pk_bf16_f32 v21, v14, v15
v_add_f32 v8, v8, v15
v_mfma_f32_16x16x32_bf16 v[120:123], a[76:79], v[56:59], v[120:123]
v_sub_f32 v82, v82, v28
v_sub_f32 v83, v83, v28
v_exp_f32 v18, v82
v_mfma_f32_16x16x32_bf16 v[124:127], a[76:79], v[60:63], v[124:127]
s_waitcnt vmcnt(14) lgkmcnt(3)
v_exp_f32 v19, v83
v_add_f32 v8, v8, v16
v_mfma_f32_16x16x32_bf16 v[96:99], a[80:83], v[32:35], v[96:99]
s_waitcnt lgkmcnt(2)
buffer_load_dwordx4 a[76:79], v1, s[44:47], s68 offen offset:3072 sc1
v_cvt_pk_bf16_f32 v22, v16, v17
v_mfma_f32_16x16x32_bf16 v[100:103], a[80:83], v[36:39], v[100:103]
s_waitcnt lgkmcnt(1)
ds_read_b128 v[48:51], v2 offset:3120
v_add_f32 v8, v8, v17
v_sub_f32 v68, v68, v29
v_mfma_f32_16x16x32_bf16 v[104:107], a[80:83], v[40:43], v[104:107]
s_waitcnt lgkmcnt(1)
ds_read_b128 v[52:55], v2 offset:11440
v_sub_f32 v69, v69, v29
v_exp_f32 v12, v68
v_mfma_f32_16x16x32_bf16 v[108:111], a[80:83], v[44:47], v[108:111]
s_waitcnt vmcnt(14)
ds_read_b128 v[56:59], v2 offset:19760
v_exp_f32 v13, v69
v_mfma_f32_16x16x32_bf16 v[112:115], a[84:87], v[32:35], v[112:115]
s_add_u32 s68, s68, 4096
buffer_load_dwordx4 a[80:83], v1, s[44:47], s68 offen offset:0 sc1
v_add_f32 v8, v8, v18
v_mfma_f32_16x16x32_bf16 v[116:119], a[84:87], v[36:39], v[116:119]
ds_read_b128 v[60:63], v2 offset:28080
v_cvt_pk_bf16_f32 v23, v18, v19
v_add_f32 v8, v8, v19
v_mfma_f32_16x16x32_bf16 v[120:123], a[84:87], v[40:43], v[120:123]
ds_write_b128 v4, v[20:23] offset:0
v_mfma_f32_16x16x32_bf16 v[124:127], a[84:87], v[44:47], v[124:127]
s_waitcnt vmcnt(14) lgkmcnt(4)
v_sub_f32 v70, v70, v29
v_sub_f32 v71, v71, v29
v_exp_f32 v14, v70
v_mfma_f32_16x16x32_bf16 v[96:99], a[88:91], v[48:51], v[96:99]
s_waitcnt lgkmcnt(3)
buffer_load_dwordx4 a[84:87], v1, s[44:47], s68 offen offset:1024 sc1
v_exp_f32 v15, v71
v_mfma_f32_16x16x32_bf16 v[100:103], a[88:91], v[52:55], v[100:103]
s_waitcnt lgkmcnt(2)
ds_read_b128 v[32:35], v2 offset:4160
v_mfma_f32_16x16x32_bf16 v[104:107], a[88:91], v[56:59], v[104:107]
s_waitcnt lgkmcnt(2)
ds_read_b128 v[36:39], v2 offset:12480
v_add_f32 v9, v9, v12
v_mfma_f32_16x16x32_bf16 v[108:111], a[88:91], v[60:63], v[108:111]
s_waitcnt vmcnt(14)
ds_read_b128 v[40:43], v2 offset:20800
v_mfma_f32_16x16x32_bf16 v[112:115], a[92:95], v[48:51], v[112:115]
buffer_load_dwordx4 a[88:91], v1, s[44:47], s68 offen offset:2048 sc1
v_mfma_f32_16x16x32_bf16 v[116:119], a[92:95], v[52:55], v[116:119]
ds_read_b128 v[44:47], v2 offset:29120
v_cvt_pk_bf16_f32 v24, v12, v13
v_mfma_f32_16x16x32_bf16 v[120:123], a[92:95], v[56:59], v[120:123]
v_add_f32 v9, v9, v13
v_sub_f32 v84, v84, v29
v_mfma_f32_16x16x32_bf16 v[124:127], a[92:95], v[60:63], v[124:127]
s_waitcnt vmcnt(14) lgkmcnt(3)
v_sub_f32 v85, v85, v29
v_exp_f32 v16, v84
v_mfma_f32_16x16x32_bf16 v[96:99], a[96:99], v[32:35], v[96:99]
s_waitcnt lgkmcnt(2)
buffer_load_dwordx4 a[92:95], v1, s[44:47], s68 offen offset:3072 sc1
v_mfma_f32_16x16x32_bf16 v[100:103], a[96:99], v[36:39], v[100:103]
s_waitcnt lgkmcnt(1)
ds_read_b128 v[48:51], v2 offset:5200
v_mfma_f32_16x16x32_bf16 v[104:107], a[96:99], v[40:43], v[104:107]
s_waitcnt lgkmcnt(1)
ds_read_b128 v[52:55], v2 offset:13520
v_exp_f32 v17, v85
v_mfma_f32_16x16x32_bf16 v[108:111], a[96:99], v[44:47], v[108:111]
s_waitcnt vmcnt(14)
ds_read_b128 v[56:59], v2 offset:21840
v_mfma_f32_16x16x32_bf16 v[112:115], a[100:103], v[32:35], v[112:115]
s_add_u32 s68, s68, 4096
buffer_load_dwordx4 a[96:99], v1, s[44:47], s68 offen offset:0 sc1
v_mfma_f32_16x16x32_bf16 v[116:119], a[100:103], v[36:39], v[116:119]
ds_read_b128 v[60:63], v2 offset:30160
v_add_f32 v9, v9, v14
v_mfma_f32_16x16x32_bf16 v[120:123], a[100:103], v[40:43], v[120:123]
v_cvt_pk_bf16_f32 v25, v14, v15
v_add_f32 v9, v9, v15
v_mfma_f32_16x16x32_bf16 v[124:127], a[100:103], v[44:47], v[124:127]
s_waitcnt vmcnt(14) lgkmcnt(3)
v_sub_f32 v86, v86, v29
v_sub_f32 v87, v87, v29
v_mfma_f32_16x16x32_bf16 v[96:99], a[104:107], v[48:51], v[96:99]
s_waitcnt lgkmcnt(2)
buffer_load_dwordx4 a[100:103], v1, s[44:47], s68 offen offset:1024 sc1
v_mfma_f32_16x16x32_bf16 v[100:103], a[104:107], v[52:55], v[100:103]
s_waitcnt lgkmcnt(1)
ds_read_b128 v[32:35], v2 offset:6240
v_mfma_f32_16x16x32_bf16 v[104:107], a[104:107], v[56:59], v[104:107]
s_waitcnt lgkmcnt(1)
ds_read_b128 v[36:39], v2 offset:14560
v_exp_f32 v18, v86
v_mfma_f32_16x16x32_bf16 v[108:111], a[104:107], v[60:63], v[108:111]
s_waitcnt vmcnt(14)
ds_read_b128 v[40:43], v2 offset:22880
v_mfma_f32_16x16x32_bf16 v[112:115], a[108:111], v[48:51], v[112:115]
buffer_load_dwordx4 a[104:107], v1, s[44:47], s68 offen offset:2048 sc1
v_mfma_f32_16x16x32_bf16 v[116:119], a[108:111], v[52:55], v[116:119]
ds_read_b128 v[44:47], v2 offset:31200
v_exp_f32 v19, v87
v_mfma_f32_16x16x32_bf16 v[120:123], a[108:111], v[56:59], v[120:123]
v_add_f32 v9, v9, v16
v_cvt_pk_bf16_f32 v26, v16, v17
v_mfma_f32_16x16x32_bf16 v[124:127], a[108:111], v[60:63], v[124:127]
s_waitcnt vmcnt(14) lgkmcnt(3)
v_add_f32 v9, v9, v17
v_sub_f32 v72, v72, v30
v_mfma_f32_16x16x32_bf16 v[96:99], a[112:115], v[32:35], v[96:99]
s_waitcnt lgkmcnt(2)
buffer_load_dwordx4 a[108:111], v1, s[44:47], s68 offen offset:3072 sc1
v_mfma_f32_16x16x32_bf16 v[100:103], a[112:115], v[36:39], v[100:103]
s_waitcnt lgkmcnt(1)
ds_read_b128 v[48:51], v2 offset:7280
v_mfma_f32_16x16x32_bf16 v[104:107], a[112:115], v[40:43], v[104:107]
s_waitcnt lgkmcnt(1)
ds_read_b128 v[52:55], v2 offset:15600
v_mfma_f32_16x16x32_bf16 v[108:111], a[112:115], v[44:47], v[108:111]
s_waitcnt vmcnt(14)
ds_read_b128 v[56:59], v2 offset:23920
v_sub_f32 v73, v73, v30
v_mfma_f32_16x16x32_bf16 v[112:115], a[116:119], v[32:35], v[112:115]
s_add_u32 s68, s68, 4096
buffer_load_dwordx4 a[112:115], v1, s[44:47], s68 offen offset:0 sc1
v_mfma_f32_16x16x32_bf16 v[116:119], a[116:119], v[36:39], v[116:119]
ds_read_b128 v[60:63], v2 offset:32240
v_exp_f32 v12, v72
v_mfma_f32_16x16x32_bf16 v[120:123], a[116:119], v[40:43], v[120:123]
v_exp_f32 v13, v73
v_mfma_f32_16x16x32_bf16 v[124:127], a[116:119], v[44:47], v[124:127]
s_waitcnt vmcnt(14) lgkmcnt(3)
v_add_f32 v9, v9, v18
v_cvt_pk_bf16_f32 v27, v18, v19
v_mfma_f32_16x16x32_bf16 v[96:99], a[120:123], v[48:51], v[96:99]
s_waitcnt lgkmcnt(2)
buffer_load_dwordx4 a[116:119], v1, s[44:47], s68 offen offset:1024 sc1
v_mfma_f32_16x16x32_bf16 v[100:103], a[120:123], v[52:55], v[100:103]
s_waitcnt lgkmcnt(1)
v_add_f32 v9, v9, v19
v_sub_f32 v74, v74, v30
v_mfma_f32_16x16x32_bf16 v[104:107], a[120:123], v[56:59], v[104:107]
s_waitcnt lgkmcnt(0)
ds_write_b128 v4, v[24:27] offset:1024
v_mfma_f32_16x16x32_bf16 v[108:111], a[120:123], v[60:63], v[108:111]
s_waitcnt vmcnt(14)
v_sub_f32 v75, v75, v30
v_exp_f32 v14, v74
v_mfma_f32_16x16x32_bf16 v[112:115], a[124:127], v[48:51], v[112:115]
buffer_load_dwordx4 a[120:123], v1, s[44:47], s68 offen offset:2048 sc1
v_mfma_f32_16x16x32_bf16 v[116:119], a[124:127], v[52:55], v[116:119]
v_exp_f32 v15, v75
v_mfma_f32_16x16x32_bf16 v[120:123], a[124:127], v[56:59], v[120:123]
v_add_f32 v10, v10, v12
v_cvt_pk_bf16_f32 v20, v12, v13
v_mfma_f32_16x16x32_bf16 v[124:127], a[124:127], v[60:63], v[124:127]
s_waitcnt vmcnt(14)
v_add_f32 v10, v10, v13
s_nop 7
s_nop 0
v_add_f32 v10, v10, v14
v_cvt_pk_bf16_f32 v21, v14, v15
v_add_f32 v10, v10, v15
v_sub_f32 v88, v88, v30
v_sub_f32 v89, v89, v30
v_sub_f32 v90, v90, v30
v_sub_f32 v91, v91, v30
v_exp_f32 v16, v88
v_exp_f32 v17, v89
v_exp_f32 v18, v90
v_exp_f32 v19, v91
s_nop 0
v_cvt_pk_bf16_f32 v22, v16, v17
v_cvt_pk_bf16_f32 v23, v18, v19
ds_write_b128 v4, v[20:23] offset:2048
v_add_f32 v10, v10, v16
v_add_f32 v10, v10, v17
v_add_f32 v10, v10, v18
v_add_f32 v10, v10, v19
v_sub_f32 v76, v76, v31
v_sub_f32 v77, v77, v31
v_sub_f32 v78, v78, v31
v_sub_f32 v79, v79, v31
v_sub_f32 v92, v92, v31
v_sub_f32 v93, v93, v31
v_sub_f32 v94, v94, v31
v_sub_f32 v95, v95, v31
v_exp_f32 v12, v76
v_exp_f32 v13, v77
v_exp_f32 v14, v78
v_exp_f32 v15, v79
v_exp_f32 v16, v92
v_exp_f32 v17, v93
v_exp_f32 v18, v94
v_exp_f32 v19, v95
s_nop 0
v_cvt_pk_bf16_f32 v24, v12, v13
v_cvt_pk_bf16_f32 v25, v14, v15
v_cvt_pk_bf16_f32 v26, v16, v17
v_cvt_pk_bf16_f32 v27, v18, v19
ds_write_b128 v4, v[24:27] offset:3072
v_add_f32 v11, v11, v12
v_add_f32 v11, v11, v13
v_add_f32 v11, v11, v14
v_add_f32 v11, v11, v15
v_add_f32 v11, v11, v16
v_add_f32 v11, v11, v17
v_add_f32 v11, v11, v18
v_add_f32 v11, v11, v19
v_sub_f32 v96, v96, v28
v_sub_f32 v97, v97, v28
v_sub_f32 v98, v98, v28
v_sub_f32 v99, v99, v28
v_sub_f32 v112, v112, v28
v_sub_f32 v113, v113, v28
v_sub_f32 v114, v114, v28
v_sub_f32 v115, v115, v28
v_exp_f32 v12, v96
v_exp_f32 v13, v97
v_exp_f32 v14, v98
v_exp_f32 v15, v99
v_exp_f32 v16, v112
v_exp_f32 v17, v113
v_exp_f32 v18, v114
v_exp_f32 v19, v115
s_nop 0
v_cvt_pk_bf16_f32 v20, v12, v13
v_cvt_pk_bf16_f32 v21, v14, v15
v_cvt_pk_bf16_f32 v22, v16, v17
v_cvt_pk_bf16_f32 v23, v18, v19
ds_write_b128 v4, v[20:23] offset:4096
v_add_f32 v8, v8, v12
v_add_f32 v8, v8, v13
v_add_f32 v8, v8, v14
v_add_f32 v8, v8, v15
v_add_f32 v8, v8, v16
v_add_f32 v8, v8, v17
v_add_f32 v8, v8, v18
v_add_f32 v8, v8, v19
v_sub_f32 v100, v100, v29
v_sub_f32 v101, v101, v29
v_sub_f32 v102, v102, v29
v_sub_f32 v103, v103, v29
v_sub_f32 v116, v116, v29
v_sub_f32 v117, v117, v29
v_sub_f32 v118, v118, v29
v_sub_f32 v119, v119, v29
v_exp_f32 v12, v100
v_exp_f32 v13, v101
v_exp_f32 v14, v102
v_exp_f32 v15, v103
v_exp_f32 v16, v116
v_exp_f32 v17, v117
v_exp_f32 v18, v118
v_exp_f32 v19, v119
s_nop 0
v_cvt_pk_bf16_f32 v24, v12, v13
v_cvt_pk_bf16_f32 v25, v14, v15
v_cvt_pk_bf16_f32 v26, v16, v17
v_cvt_pk_bf16_f32 v27, v18, v19
ds_write_b128 v4, v[24:27] offset:5120
v_add_f32 v9, v9, v12
v_add_f32 v9, v9, v13
v_add_f32 v9, v9, v14
v_add_f32 v9, v9, v15
v_add_f32 v9, v9, v16
v_add_f32 v9, v9, v17
v_add_f32 v9, v9, v18
v_add_f32 v9, v9, v19
v_sub_f32 v104, v104, v30
v_sub_f32 v105, v105, v30
v_sub_f32 v106, v106, v30
v_sub_f32 v107, v107, v30
v_sub_f32 v120, v120, v30
v_sub_f32 v121, v121, v30
v_sub_f32 v122, v122, v30
v_sub_f32 v123, v123, v30
v_exp_f32 v12, v104
v_exp_f32 v13, v105
v_exp_f32 v14, v106
v_exp_f32 v15, v107
v_exp_f32 v16, v120
v_exp_f32 v17, v121
v_exp_f32 v18, v122
v_exp_f32 v19, v123
s_nop 0
v_cvt_pk_bf16_f32 v20, v12, v13
v_cvt_pk_bf16_f32 v21, v14, v15
v_cvt_pk_bf16_f32 v22, v16, v17
v_cvt_pk_bf16_f32 v23, v18, v19
ds_write_b128 v4, v[20:23] offset:6144
v_add_f32 v10, v10, v12
v_add_f32 v10, v10, v13
v_add_f32 v10, v10, v14
v_add_f32 v10, v10, v15
v_add_f32 v10, v10, v16
v_add_f32 v10, v10, v17
v_add_f32 v10, v10, v18
v_add_f32 v10, v10, v19
v_sub_f32 v108, v108, v31
v_sub_f32 v109, v109, v31
v_sub_f32 v110, v110, v31
v_sub_f32 v111, v111, v31
v_sub_f32 v124, v124, v31
v_sub_f32 v125, v125, v31
v_sub_f32 v126, v126, v31
v_sub_f32 v127, v127, v31
v_exp_f32 v12, v108
v_exp_f32 v13, v109
v_exp_f32 v14, v110
v_exp_f32 v15, v111
v_exp_f32 v16, v124
v_exp_f32 v17, v125
v_exp_f32 v18, v126
v_exp_f32 v19, v127
s_nop 0
v_cvt_pk_bf16_f32 v24, v12, v13
v_cvt_pk_bf16_f32 v25, v14, v15
v_cvt_pk_bf16_f32 v26, v16, v17
v_cvt_pk_bf16_f32 v27, v18, v19
ds_write_b128 v4, v[24:27] offset:7168
v_add_f32 v11, v11, v12
v_add_f32 v11, v11, v13
v_add_f32 v11, v11, v14
v_add_f32 v11, v11, v15
v_add_f32 v11, v11, v16
v_add_f32 v11, v11, v17
v_add_f32 v11, v11, v18
v_add_f32 v11, v11, v19
s_add_u32 s67, s93, 1
v_mov_b32 v6, s67
ds_write_b32 v5, v6
v_xor_b32 v4, 0x8000, v4
ds_read_b128 v[32:35], v2 offset:0
ds_read_b128 v[36:39], v2 offset:8320
ds_read_b128 v[40:43], v2 offset:16640
ds_read_b128 v[44:47], v2 offset:24960
s_waitcnt lgkmcnt(3)
L_loop_s:
v_mfma_f32_16x16x32_bf16 v[64:67], a[64:67], v[32:35], 0
s_waitcnt lgkmcnt(2)
buffer_load_dwordx4 a[124:127], v1, s[44:47], s68 offen offset:3072 sc1
v_mfma_f32_16x16x32_bf16 v[68:71], a[64:67], v[36:39], 0
s_waitcnt lgkmcnt(1)
ds_read_b128 v[48:51], v2 offset:1040
v_mfma_f32_16x16x32_bf16 v[72:75], a[64:67], v[40:43], 0
s_waitcnt lgkmcnt(1)
ds_read_b128 v[52:55], v2 offset:9360
v_mfma_f32_16x16x32_bf16 v[76:79], a[64:67], v[44:47], 0
s_waitcnt vmcnt(14)
ds_read_b128 v[56:59], v2 offset:17680
v_mfma_f32_16x16x32_bf16 v[80:83], a[68:71], v[32:35], 0
s_add_u32 s68, s68, 4096
buffer_load_dwordx4 a[64:67], v1, s[44:47], s68 offen offset:0 sc1
v_mfma_f32_16x16x32_bf16 v[84:87], a[68:71], v[36:39], 0
ds_read_b128 v[60:63], v2 offset:26000
v_mfma_f32_16x16x32_bf16 v[88:91], a[68:71], v[40:43], 0
v_mfma_f32_16x16x32_bf16 v[92:95], a[68:71], v[44:47], 0
s_waitcnt vmcnt(14) lgkmcnt(3)
v_mfma_f32_16x16x32_bf16 v[64:67], a[72:75], v[48:51], v[64:67]
s_waitcnt lgkmcnt(2)
buffer_load_dwordx4 a[68:71], v1, s[44:47], s68 offen offset:1024 sc1
v_mfma_f32_16x16x32_bf16 v[68:71], a[72:75], v[52:55], v[68:71]
s_waitcnt lgkmcnt(1)
ds_read_b128 v[32:35], v2 offset:2080
v_mfma_f32_16x16x32_bf16 v[72:75], a[72:75], v[56:59], v[72:75]
s_waitcnt lgkmcnt(1)
ds_read_b128 v[36:39], v2 offset:10400
v_mfma_f32_16x16x32_bf16 v[76:79], a[72:75], v[60:63], v[76:79]
s_waitcnt vmcnt(14)
ds_read_b128 v[40:43], v2 offset:18720
v_mfma_f32_16x16x32_bf16 v[80:83], a[76:79], v[48:51], v[80:83]
buffer_load_dwordx4 a[72:75], v1, s[44:47], s68 offen offset:2048 sc1
v_mfma_f32_16x16x32_bf16 v[84:87], a[76:79], v[52:55], v[84:87]
ds_read_b128 v[44:47], v2 offset:27040
v_mfma_f32_16x16x32_bf16 v[88:91], a[76:79], v[56:59], v[88:91]
v_mfma_f32_16x16x32_bf16 v[92:95], a[76:79], v[60:63], v[92:95]
s_waitcnt vmcnt(14) lgkmcnt(3)
v_mfma_f32_16x16x32_bf16 v[64:67], a[80:83], v[32:35], v[64:67]
s_waitcnt lgkmcnt(2)
buffer_load_dwordx4 a[76:79], v1, s[44:47], s68 offen offset:3072 sc1
v_mfma_f32_16x16x32_bf16 v[68:71], a[80:83], v[36:39], v[68:71]
s_waitcnt lgkmcnt(1)
ds_read_b128 v[48:51], v2 offset:3120
v_mfma_f32_16x16x32_bf16 v[72:75], a[80:83], v[40:43], v[72:75]
s_waitcnt lgkmcnt(1)
ds_read_b128 v[52:55], v2 offset:11440
v_mfma_f32_16x16x32_bf16 v[76:79], a[80:83], v[44:47], v[76:79]
s_waitcnt vmcnt(14)
ds_read_b128 v[56:59], v2 offset:19760
v_mfma_f32_16x16x32_bf16 v[80:83], a[84:87], v[32:35], v[80:83]
s_add_u32 s68, s68, 4096
buffer_load_dwordx4 a[80:83], v1, s[44:47], s68 offen offset:0 sc1
v_mfma_f32_16x16x32_bf16 v[84:87], a[84:87], v[36:39], v[84:87]
ds_read_b128 v[60:63], v2 offset:28080
v_mfma_f32_16x16x32_bf16 v[88:91], a[84:87], v[40:43], v[88:91]
v_mfma_f32_16x16x32_bf16 v[92:95], a[84:87], v[44:47], v[92:95]
s_waitcnt vmcnt(14) lgkmcnt(3)
v_mfma_f32_16x16x32_bf16 v[64:67], a[88:91], v[48:51], v[64:67]
s_waitcnt lgkmcnt(2)
buffer_load_dwordx4 a[84:87], v1, s[44:47], s68 offen offset:1024 sc1
v_mfma_f32_16x16x32_bf16 v[68:71], a[88:91], v[52:55], v[68:71]
s_waitcnt lgkmcnt(1)
ds_read_b128 v[32:35], v2 offset:4160
v_mfma_f32_16x16x32_bf16 v[72:75], a[88:91], v[56:59], v[72:75]
s_waitcnt lgkmcnt(1)
ds_read_b128 v[36:39], v2 offset:12480
v_mfma_f32_16x16x32_bf16 v[76:79], a[88:91], v[60:63], v[76:79]
s_waitcnt vmcnt(14)
ds_read_b128 v[40:43], v2 offset:20800
v_mfma_f32_16x16x32_bf16 v[80:83], a[92:95], v[48:51], v[80:83]
buffer_load_dwordx4 a[88:91], v1, s[44:47], s68 offen offset:2048 sc1
v_mfma_f32_16x16x32_bf16 v[84:87], a[92:95], v[52:55], v[84:87]
ds_read_b128 v[44:47], v2 offset:29120
v_mfma_f32_16x16x32_bf16 v[88:91], a[92:95], v[56:59], v[88:91]
v_mfma_f32_16x16x32_bf16 v[92:95], a[92:95], v[60:63], v[92:95]
s_waitcnt vmcnt(14) lgkmcnt(3)
v_mfma_f32_16x16x32_bf16 v[64:67], a[96:99], v[32:35], v[64:67]
s_waitcnt lgkmcnt(2)
buffer_load_dwordx4 a[92:95], v1, s[44:47], s68 offen offset:3072 sc1
v_mfma_f32_16x16x32_bf16 v[68:71], a[96:99], v[36:39], v[68:71]
s_waitcnt lgkmcnt(1)
ds_read_b128 v[48:51], v2 offset:5200
v_mfma_f32_16x16x32_bf16 v[72:75], a[96:99], v[40:43], v[72:75]
s_waitcnt lgkmcnt(1)
ds_read_b128 v[52:55], v2 offset:13520
v_mfma_f32_16x16x32_bf16 v[76:79], a[96:99], v[44:47], v[76:79]
s_waitcnt vmcnt(14)
ds_read_b128 v[56:59], v2 offset:21840
v_mfma_f32_16x16x32_bf16 v[80:83], a[100:103], v[32:35], v[80:83]
s_add_u32 s68, s68, 4096
buffer_load_dwordx4 a[96:99], v1, s[44:47], s68 offen offset:0 sc1
v_mfma_f32_16x16x32_bf16 v[84:87], a[100:103], v[36:39], v[84:87]
ds_read_b128 v[60:63], v2 offset:30160
v_mfma_f32_16x16x32_bf16 v[88:91], a[100:103], v[40:43], v[88:91]
v_mfma_f32_16x16x32_bf16 v[92:95], a[100:103], v[44:47], v[92:95]
s_waitcnt vmcnt(14) lgkmcnt(3)
v_mfma_f32_16x16x32_bf16 v[64:67], a[104:107], v[48:51], v[64:67]
s_waitcnt lgkmcnt(2)
buffer_load_dwordx4 a[100:103], v1, s[44:47], s68 offen offset:1024 sc1
v_mfma_f32_16x16x32_bf16 v[68:71], a[104:107], v[52:55], v[68:71]
s_waitcnt lgkmcnt(1)
ds_read_b128 v[32:35], v2 offset:6240
v_mfma_f32_16x16x32_bf16 v[72:75], a[104:107], v[56:59], v[72:75]
s_waitcnt lgkmcnt(1)
ds_read_b128 v[36:39], v2 offset:14560
v_mfma_f32_16x16x32_bf16 v[76:79], a[104:107], v[60:63], v[76:79]
s_waitcnt vmcnt(14)
ds_read_b128 v[40:43], v2 offset:22880
ds_read_b32 v6, v0
v_mfma_f32_16x16x32_bf16 v[80:83], a[108:111], v[48:51], v[80:83]
buffer_load_dwordx4 a[104:107], v1, s[44:47], s68 offen offset:2048 sc1
v_mfma_f32_16x16x32_bf16 v[84:87], a[108:111], v[52:55], v[84:87]
ds_read_b128 v[44:47], v2 offset:31200
v_mfma_f32_16x16x32_bf16 v[88:91], a[108:111], v[56:59], v[88:91]
v_mfma_f32_16x16x32_bf16 v[92:95], a[108:111], v[60:63], v[92:95]
s_waitcnt vmcnt(14) lgkmcnt(4)
v_mfma_f32_16x16x32_bf16 v[64:67], a[112:115], v[32:35], v[64:67]
s_waitcnt lgkmcnt(3)
buffer_load_dwordx4 a[108:111], v1, s[44:47], s68 offen offset:3072 sc1
v_mfma_f32_16x16x32_bf16 v[68:71], a[112:115], v[36:39], v[68:71]
s_waitcnt lgkmcnt(2)
ds_read_b128 v[48:51], v2 offset:7280
v_mfma_f32_16x16x32_bf16 v[72:75], a[112:115], v[40:43], v[72:75]
s_waitcnt lgkmcnt(1)
ds_read_b128 v[52:55], v2 offset:15600
v_mfma_f32_16x16x32_bf16 v[76:79], a[112:115], v[44:47], v[76:79]
s_waitcnt vmcnt(14)
ds_read_b128 v[56:59], v2 offset:23920
v_mfma_f32_16x16x32_bf16 v[80:83], a[116:119], v[32:35], v[80:83]
s_add_u32 s68, s68, 4096
buffer_load_dwordx4 a[112:115], v1, s[44:47], s68 offen offset:0 sc1
v_mfma_f32_16x16x32_bf16 v[84:87], a[116:119], v[36:39], v[84:87]
ds_read_b128 v[60:63], v2 offset:32240
v_mfma_f32_16x16x32_bf16 v[88:91], a[116:119], v[40:43], v[88:91]
v_mfma_f32_16x16x32_bf16 v[92:95], a[116:119], v[44:47], v[92:95]
s_waitcnt vmcnt(14) lgkmcnt(3)
v_mfma_f32_16x16x32_bf16 v[64:67], a[120:123], v[48:51], v[64:67]
s_waitcnt lgkmcnt(2)
buffer_load_dwordx4 a[116:119], v1, s[44:47], s68 offen offset:1024 sc1
v_mfma_f32_16x16x32_bf16 v[68:71], a[120:123], v[52:55], v[68:71]
s_waitcnt lgkmcnt(1)
ds_read_b128 v[32:35], v2 offset:0
v_mfma_f32_16x16x32_bf16 v[72:75], a[120:123], v[56:59], v[72:75]
s_waitcnt lgkmcnt(1)
ds_read_b128 v[36:39], v2 offset:8320
v_mfma_f32_16x16x32_bf16 v[76:79], a[120:123], v[60:63], v[76:79]
s_waitcnt vmcnt(14)
ds_read_b128 v[40:43], v2 offset:16640
v_mfma_f32_16x16x32_bf16 v[80:83], a[124:127], v[48:51], v[80:83]
buffer_load_dwordx4 a[120:123], v1, s[44:47], s68 offen offset:2048 sc1
v_mfma_f32_16x16x32_bf16 v[84:87], a[124:127], v[52:55], v[84:87]
ds_read_b128 v[44:47], v2 offset:24960
v_mfma_f32_16x16x32_bf16 v[88:91], a[124:127], v[56:59], v[88:91]
v_mfma_f32_16x16x32_bf16 v[92:95], a[124:127], v[60:63], v[92:95]
s_waitcnt vmcnt(14) lgkmcnt(3)
v_mfma_f32_16x16x32_bf16 v[96:99], a[64:67], v[32:35], 0
s_waitcnt lgkmcnt(2)
buffer_load_dwordx4 a[124:127], v1, s[44:47], s68 offen offset:3072 sc1
v_mfma_f32_16x16x32_bf16 v[100:103], a[64:67], v[36:39], 0
s_waitcnt lgkmcnt(1)
ds_read_b128 v[48:51], v2 offset:1040
v_mfma_f32_16x16x32_bf16 v[104:107], a[64:67], v[40:43], 0
s_waitcnt lgkmcnt(1)
ds_read_b128 v[52:55], v2 offset:9360
v_mfma_f32_16x16x32_bf16 v[108:111], a[64:67], v[44:47], 0
s_waitcnt vmcnt(14)
ds_read_b128 v[56:59], v2 offset:17680
v_cmp_gt_u32 vcc, s67, v6
s_cbranch_vccnz L_spin_p_s
L_back_p_s:
v_mfma_f32_16x16x32_bf16 v[112:115], a[68:71], v[32:35], 0
buffer_load_dwordx4 a[64:67], v1, s[44:47], s69 offen offset:0 sc1
v_sub_f32 v64, v64, v28
v_mfma_f32_16x16x32_bf16 v[116:119], a[68:71], v[36:39], 0
ds_read_b128 v[60:63], v2 offset:26000
v_sub_f32 v65, v65, v28
v_exp_f32 v12, v64
v_mfma_f32_16x16x32_bf16 v[120:123], a[68:71], v[40:43], 0
v_exp_f32 v13, v65
v_sub_f32 v66, v66, v28
v_mfma_f32_16x16x32_bf16 v[124:127], a[68:71], v[44:47], 0
s_waitcnt vmcnt(14) lgkmcnt(3)
v_sub_f32 v67, v67, v28
v_exp_f32 v14, v66
v_mfma_f32_16x16x32_bf16 v[96:99], a[72:75], v[48:51], v[96:99]
s_waitcnt lgkmcnt(2)
buffer_load_dwordx4 a[68:71], v1, s[44:47], s69 offen offset:1024 sc1
v_exp_f32 v15, v67
v_mfma_f32_16x16x32_bf16 v[100:103], a[72:75], v[52:55], v[100:103]
s_waitcnt lgkmcnt(1)
ds_read_b128 v[32:35], v2 offset:2080
v_add_f32 v8, v8, v12
v_cvt_pk_bf16_f32 v20, v12, v13
v_mfma_f32_16x16x32_bf16 v[104:107], a[72:75], v[56:59], v[104:107]
s_waitcnt lgkmcnt(1)
ds_read_b128 v[36:39], v2 offset:10400
v_add_f32 v8, v8, v13
v_sub_f32 v80, v80, v28
v_mfma_f32_16x16x32_bf16 v[108:111], a[72:75], v[60:63], v[108:111]
s_waitcnt vmcnt(14)
ds_read_b128 v[40:43], v2 offset:18720
v_sub_f32 v81, v81, v28
v_exp_f32 v16, v80
v_mfma_f32_16x16x32_bf16 v[112:115], a[76:79], v[48:51], v[112:115]
buffer_load_dwordx4 a[72:75], v1, s[44:47], s69 offen offset:2048 sc1
v_exp_f32 v17, v81
v_mfma_f32_16x16x32_bf16 v[116:119], a[76:79], v[52:55], v[116:119]
ds_read_b128 v[44:47], v2 offset:27040
v_add_f32 v8, v8, v14
v_cvt_pk_bf16_f32 v21, v14, v15
v_mfma_f32_16x16x32_bf16 v[120:123], a[76:79], v[56:59], v[120:123]
v_add_f32 v8, v8, v15
v_sub_f32 v82, v82, v28
v_sub_f32 v83, v83, v28
v_mfma_f32_16x16x32_bf16 v[124:127], a[76:79], v[60:63], v[124:127]
s_waitcnt vmcnt(14) lgkmcnt(3)
v_exp_f32 v18, v82
v_exp_f32 v19, v83
v_mfma_f32_16x16x32_bf16 v[96:99], a[80:83], v[32:35], v[96:99]
s_waitcnt lgkmcnt(2)
buffer_load_dwordx4 a[76:79], v1, s[44:47], s69 offen offset:3072 sc1
v_add_f32 v8, v8, v16
v_mfma_f32_16x16x32_bf16 v[100:103], a[80:83], v[36:39], v[100:103]
s_waitcnt lgkmcnt(1)
ds_read_b128 v[48:51], v2 offset:3120
v_cvt_pk_bf16_f32 v22, v16, v17
v_add_f32 v8, v8, v17
v_mfma_f32_16x16x32_bf16 v[104:107], a[80:83], v[40:43], v[104:107]
s_waitcnt lgkmcnt(1)
ds_read_b128 v[52:55], v2 offset:11440
v_sub_f32 v68, v68, v29
v_sub_f32 v69, v69, v29
v_mfma_f32_16x16x32_bf16 v[108:111], a[80:83], v[44:47], v[108:111]
s_waitcnt vmcnt(14)
ds_read_b128 v[56:59], v2 offset:19760
v_exp_f32 v12, v68
v_mfma_f32_16x16x32_bf16 v[112:115], a[84:87], v[32:35], v[112:115]
s_add_u32 s69, s69, 4096
buffer_load_dwordx4 a[80:83], v1, s[44:47], s69 offen offset:0 sc1
v_exp_f32 v13, v69
v_mfma_f32_16x16x32_bf16 v[116:119], a[84:87], v[36:39], v[116:119]
ds_read_b128 v[60:63], v2 offset:28080
v_add_f32 v8, v8, v18
v_cvt_pk_bf16_f32 v23, v18, v19
v_mfma_f32_16x16x32_bf16 v[120:123], a[84:87], v[40:43], v[120:123]
v_add_f32 v8, v8, v19
v_sub_f32 v70, v70, v29
v_sub_f32 v71, v71, v29
v_mfma_f32_16x16x32_bf16 v[124:127], a[84:87], v[44:47], v[124:127]
s_waitcnt vmcnt(14) lgkmcnt(3)
ds_write_b128 v4, v[20:23] offset:0
v_mfma_f32_16x16x32_bf16 v[96:99], a[88:91], v[48:51], v[96:99]
s_waitcnt lgkmcnt(3)
buffer_load_dwordx4 a[84:87], v1, s[44:47], s69 offen offset:1024 sc1
v_exp_f32 v14, v70
v_mfma_f32_16x16x32_bf16 v[100:103], a[88:91], v[52:55], v[100:103]
s_waitcnt lgkmcnt(2)
ds_read_b128 v[32:35], v2 offset:4160
v_exp_f32 v15, v71
v_mfma_f32_16x16x32_bf16 v[104:107], a[88:91], v[56:59], v[104:107]
s_waitcnt lgkmcnt(2)
ds_read_b128 v[36:39], v2 offset:12480
v_add_f32 v9, v9, v12
v_cvt_pk_bf16_f32 v24, v12, v13
v_mfma_f32_16x16x32_bf16 v[108:111], a[88:91], v[60:63], v[108:111]
s_waitcnt vmcnt(14)
ds_read_b128 v[40:43], v2 offset:20800
v_add_f32 v9, v9, v13
v_sub_f32 v84, v84, v29
v_mfma_f32_16x16x32_bf16 v[112:115], a[92:95], v[48:51], v[112:115]
buffer_load_dwordx4 a[88:91], v1, s[44:47], s69 offen offset:2048 sc1
v_sub_f32 v85, v85, v29
v_mfma_f32_16x16x32_bf16 v[116:119], a[92:95], v[52:55], v[116:119]
ds_read_b128 v[44:47], v2 offset:29120
v_exp_f32 v16, v84
v_mfma_f32_16x16x32_bf16 v[120:123], a[92:95], v[56:59], v[120:123]
v_exp_f32 v17, v85
v_mfma_f32_16x16x32_bf16 v[124:127], a[92:95], v[60:63], v[124:127]
s_waitcnt vmcnt(14) lgkmcnt(3)
v_add_f32 v9, v9, v14
v_cvt_pk_bf16_f32 v25, v14, v15
v_mfma_f32_16x16x32_bf16 v[96:99], a[96:99], v[32:35], v[96:99]
s_waitcnt lgkmcnt(2)
buffer_load_dwordx4 a[92:95], v1, s[44:47], s69 offen offset:3072 sc1
v_mfma_f32_16x16x32_bf16 v[100:103], a[96:99], v[36:39], v[100:103]
s_waitcnt lgkmcnt(1)
ds_read_b128 v[48:51], v2 offset:5200
v_mfma_f32_16x16x32_bf16 v[104:107], a[96:99], v[40:43], v[104:107]
s_waitcnt lgkmcnt(1)
ds_read_b128 v[52:55], v2 offset:13520
v_add_f32 v9, v9, v15
v_mfma_f32_16x16x32_bf16 v[108:111], a[96:99], v[44:47], v[108:111]
s_waitcnt vmcnt(14)
ds_read_b128 v[56:59], v2 offset:21840
v_sub_f32 v86, v86, v29
v_mfma_f32_16x16x32_bf16 v[112:115], a[100:103], v[32:35], v[112:115]
s_add_u32 s69, s69, 4096
buffer_load_dwordx4 a[96:99], v1, s[44:47], s69 offen offset:0 sc1
v_mfma_f32_16x16x32_bf16 v[116:119], a[100:103], v[36:39], v[116:119]
ds_read_b128 v[60:63], v2 offset:30160
v_sub_f32 v87, v87, v29
v_mfma_f32_16x16x32_bf16 v[120:123], a[100:103], v[40:43], v[120:123]
v_exp_f32 v18, v86
v_mfma_f32_16x16x32_bf16 v[124:127], a[100:103], v[44:47], v[124:127]
s_waitcnt vmcnt(14) lgkmcnt(3)
v_exp_f32 v19, v87
v_mfma_f32_16x16x32_bf16 v[96:99], a[104:107], v[48:51], v[96:99]
s_waitcnt lgkmcnt(2)
buffer_load_dwordx4 a[100:103], v1, s[44:47], s69 offen offset:1024 sc1
v_mfma_f32_16x16x32_bf16 v[100:103], a[104:107], v[52:55], v[100:103]
s_waitcnt lgkmcnt(1)
ds_read_b128 v[32:35], v2 offset:6240
v_add_f32 v9, v9, v16
v_mfma_f32_16x16x32_bf16 v[104:107], a[104:107], v[56:59], v[104:107]
s_waitcnt lgkmcnt(1)
ds_read_b128 v[36:39], v2 offset:14560
v_mfma_f32_16x16x32_bf16 v[108:111], a[104:107], v[60:63], v[108:111]
s_waitcnt vmcnt(14)
ds_read_b128 v[40:43], v2 offset:22880
v_cvt_pk_bf16_f32 v26, v16, v17
v_mfma_f32_16x16x32_bf16 v[112:115], a[108:111], v[48:51], v[112:115]
buffer_load_dwordx4 a[104:107], v1, s[44:47], s69 offen offset:2048 sc1
v_mfma_f32_16x16x32_bf16 v[116:119], a[108:111], v[52:55], v[116:119]
ds_read_b128 v[44:47], v2 offset:31200
v_add_f32 v9, v9, v17
v_mfma_f32_16x16x32_bf16 v[120:123], a[108:111], v[56:59], v[120:123]
v_sub_f32 v72, v72, v30
v_sub_f32 v73, v73, v30
v_mfma_f32_16x16x32_bf16 v[124:127], a[108:111], v[60:63], v[124:127]
s_waitcnt vmcnt(14) lgkmcnt(3)
v_exp_f32 v12, v72
v_mfma_f32_16x16x32_bf16 v[96:99], a[112:115], v[32:35], v[96:99]
s_waitcnt lgkmcnt(2)
buffer_load_dwordx4 a[108:111], v1, s[44:47], s69 offen offset:3072 sc1
v_mfma_f32_16x16x32_bf16 v[100:103], a[112:115], v[36:39], v[100:103]
s_waitcnt lgkmcnt(1)
ds_read_b128 v[48:51], v2 offset:7280
v_exp_f32 v13, v73
v_mfma_f32_16x16x32_bf16 v[104:107], a[112:115], v[40:43], v[104:107]
s_waitcnt lgkmcnt(1)
ds_read_b128 v[52:55], v2 offset:15600
v_mfma_f32_16x16x32_bf16 v[108:111], a[112:115], v[44:47], v[108:111]
s_waitcnt vmcnt(14)
ds_read_b128 v[56:59], v2 offset:23920
v_add_f32 v9, v9, v18
v_mfma_f32_16x16x32_bf16 v[112:115], a[116:119], v[32:35], v[112:115]
s_add_u32 s69, s69, 4096
buffer_load_dwordx4 a[112:115], v1, s[44:47], s69 offen offset:0 sc1
v_mfma_f32_16x16x32_bf16 v[116:119], a[116:119], v[36:39], v[116:119]
ds_read_b128 v[60:63], v2 offset:32240
v_mfma_f32_16x16x32_bf16 v[120:123], a[116:119], v[40:43], v[120:123]
v_cvt_pk_bf16_f32 v27, v18, v19
v_add_f32 v9, v9, v19
v_mfma_f32_16x16x32_bf16 v[124:127], a[116:119], v[44:47], v[124:127]
s_waitcnt vmcnt(14) lgkmcnt(3)
ds_write_b128 v4, v[24:27] offset:1024
v_mfma_f32_16x16x32_bf16 v[96:99], a[120:123], v[48:51], v[96:99]
s_waitcnt lgkmcnt(3)
buffer_load_dwordx4 a[116:119], v1, s[44:47], s69 offen offset:1024 sc1
v_sub_f32 v74, v74, v30
v_mfma_f32_16x16x32_bf16 v[100:103], a[120:123], v[52:55], v[100:103]
s_waitcnt lgkmcnt(2)
ds_read_b128 v[32:35], v3 offset:0
v_sub_f32 v75, v75, v30
v_exp_f32 v14, v74
v_mfma_f32_16x16x32_bf16 v[104:107], a[120:123], v[56:59], v[104:107]
s_waitcnt lgkmcnt(2)
ds_read_b128 v[36:39], v3 offset:1024
v_mfma_f32_16x16x32_bf16 v[108:111], a[120:123], v[60:63], v[108:111]
s_waitcnt vmcnt(14)
ds_read_b128 v[40:43], v3 offset:2048
v_exp_f32 v15, v75
v_mfma_f32_16x16x32_bf16 v[112:115], a[124:127], v[48:51], v[112:115]
buffer_load_dwordx4 a[120:123], v1, s[44:47], s69 offen offset:2048 sc1
v_mfma_f32_16x16x32_bf16 v[116:119], a[124:127], v[52:55], v[116:119]
ds_read_b128 v[44:47], v3 offset:3072
v_mfma_f32_16x16x32_bf16 v[120:123], a[124:127], v[56:59], v[120:123]
v_add_f32 v10, v10, v12
v_cvt_pk_bf16_f32 v20, v12, v13
v_mfma_f32_16x16x32_bf16 v[124:127], a[124:127], v[60:63], v[124:127]
s_waitcnt vmcnt(14) lgkmcnt(3)
v_add_f32 v10, v10, v13
v_mfma_f32_16x16x32_bf16 a[0:3], a[64:67], v[32:35], a[0:3]
s_waitcnt lgkmcnt(2)
buffer_load_dwordx4 a[124:127], v1, s[44:47], s69 offen offset:3072 sc1
v_sub_f32 v88, v88, v30
v_mfma_f32_16x16x32_bf16 a[4:7], a[64:67], v[36:39], a[4:7]
s_waitcnt lgkmcnt(1)
ds_read_b128 v[48:51], v3 offset:4096
v_sub_f32 v89, v89, v30
v_exp_f32 v16, v88
v_mfma_f32_16x16x32_bf16 a[8:11], a[64:67], v[40:43], a[8:11]
s_waitcnt lgkmcnt(1)
ds_read_b128 v[52:55], v3 offset:5120
v_exp_f32 v17, v89
v_mfma_f32_16x16x32_bf16 a[12:15], a[64:67], v[44:47], a[12:15]
s_waitcnt vmcnt(14)
v_add_f32 v10, v10, v14
v_cvt_pk_bf16_f32 v21, v14, v15
v_add_f32 v10, v10, v15
v_mfma_f32_16x16x32_bf16 a[16:19], a[68:71], v[32:35], a[16:19]
s_add_u32 s69, s69, 4096
buffer_load_dwordx4 a[64:67], v1, s[44:47], s69 offen offset:0 sc1
v_sub_f32 v90, v90, v30
v_mfma_f32_16x16x32_bf16 a[20:23], a[68:71], v[36:39], a[20:23]
ds_read_b128 v[56:59], v3 offset:6144
v_sub_f32 v91, v91, v30
v_exp_f32 v18, v90
v_mfma_f32_16x16x32_bf16 a[24:27], a[68:71], v[40:43], a[24:27]
ds_read_b128 v[60:63], v3 offset:7168
v_exp_f32 v19, v91
v_mfma_f32_16x16x32_bf16 a[28:31], a[68:71], v[44:47], a[28:31]
s_waitcnt vmcnt(14)
v_add_f32 v10, v10, v16
v_cvt_pk_bf16_f32 v22, v16, v17
v_add_f32 v10, v10, v17
v_mfma_f32_16x16x32_bf16 a[32:35], a[72:75], v[32:35], a[32:35]
buffer_load_dwordx4 a[68:71], v1, s[44:47], s69 offen offset:1024 sc1
v_sub_f32 v76, v76, v31
v_mfma_f32_16x16x32_bf16 a[36:39], a[72:75], v[36:39], a[36:39]
v_sub_f32 v77, v77, v31
v_exp_f32 v12, v76
v_mfma_f32_16x16x32_bf16 a[40:43], a[72:75], v[40:43], a[40:43]
v_exp_f32 v13, v77
v_add_f32 v10, v10, v18
v_mfma_f32_16x16x32_bf16 a[44:47], a[72:75], v[44:47], a[44:47]
s_waitcnt vmcnt(14)
v_cvt_pk_bf16_f32 v23, v18, v19
v_add_f32 v10, v10, v19
v_sub_f32 v78, v78, v31
v_mfma_f32_16x16x32_bf16 a[48:51], a[76:79], v[32:35], a[48:51]
buffer_load_dwordx4 a[72:75], v1, s[44:47], s69 offen offset:2048 sc1
v_sub_f32 v79, v79, v31
v_mfma_f32_16x16x32_bf16 a[52:55], a[76:79], v[36:39], a[52:55]
ds_write_b128 v4, v[20:23] offset:2048
v_mfma_f32_16x16x32_bf16 a[56:59], a[76:79], v[40:43], a[56:59]
v_exp_f32 v14, v78
v_exp_f32 v15, v79
v_mfma_f32_16x16x32_bf16 a[60:63], a[76:79], v[44:47], a[60:63]
s_waitcnt vmcnt(14) lgkmcnt(4)
v_add_f32 v11, v11, v12
v_cvt_pk_bf16_f32 v24, v12, v13
v_add_f32 v11, v11, v13
v_mfma_f32_16x16x32_bf16 a[0:3], a[80:83], v[48:51], a[0:3]
s_waitcnt lgkmcnt(3)
buffer_load_dwordx4 a[76:79], v1, s[44:47], s69 offen offset:3072 sc1
v_sub_f32 v92, v92, v31
v_mfma_f32_16x16x32_bf16 a[4:7], a[80:83], v[52:55], a[4:7]
s_waitcnt lgkmcnt(2)
ds_read_b128 v[32:35], v3 offset:8192
v_sub_f32 v93, v93, v31
v_exp_f32 v16, v92
v_mfma_f32_16x16x32_bf16 a[8:11], a[80:83], v[56:59], a[8:11]
s_waitcnt lgkmcnt(2)
ds_read_b128 v[36:39], v3 offset:9216
v_exp_f32 v17, v93
v_mfma_f32_16x16x32_bf16 a[12:15], a[80:83], v[60:63], a[12:15]
s_waitcnt vmcnt(14)
v_add_f32 v11, v11, v14
v_cvt_pk_bf16_f32 v25, v14, v15
v_add_f32 v11, v11, v15
v_mfma_f32_16x16x32_bf16 a[16:19], a[84:87], v[48:51], a[16:19]
s_add_u32 s69, s69, 4096
buffer_load_dwordx4 a[80:83], v1, s[44:47], s69 offen offset:0 sc1
v_sub_f32 v94, v94, v31
v_mfma_f32_16x16x32_bf16 a[20:23], a[84:87], v[52:55], a[20:23]
ds_read_b128 v[40:43], v3 offset:10240
v_sub_f32 v95, v95, v31
v_exp_f32 v18, v94
v_mfma_f32_16x16x32_bf16 a[24:27], a[84:87], v[56:59], a[24:27]
ds_read_b128 v[44:47], v3 offset:11264
v_exp_f32 v19, v95
v_mfma_f32_16x16x32_bf16 a[28:31], a[84:87], v[60:63], a[28:31]
s_waitcnt vmcnt(14)
v_add_f32 v11, v11, v16
v_cvt_pk_bf16_f32 v26, v16, v17
v_add_f32 v11, v11, v17
v_mfma_f32_16x16x32_bf16 a[32:35], a[88:91], v[48:51], a[32:35]
buffer_load_dwordx4 a[84:87], v1, s[44:47], s69 offen offset:1024 sc1
v_sub_f32 v96, v96, v28
v_mfma_f32_16x16x32_bf16 a[36:39], a[88:91], v[52:55], a[36:39]
v_sub_f32 v97, v97, v28
v_exp_f32 v12, v96
v_mfma_f32_16x16x32_bf16 a[40:43], a[88:91], v[56:59], a[40:43]
v_exp_f32 v13, v97
v_add_f32 v11, v11, v18
v_mfma_f32_16x16x32_bf16 a[44:47], a[88:91], v[60:63], a[44:47]
s_waitcnt vmcnt(14)
v_cvt_pk_bf16_f32 v27, v18, v19
v_add_f32 v11, v11, v19
v_sub_f32 v98, v98, v28
v_mfma_f32_16x16x32_bf16 a[48:51], a[92:95], v[48:51], a[48:51]
buffer_load_dwordx4 a[88:91], v1, s[44:47], s69 offen offset:2048 sc1
v_sub_f32 v99, v99, v28
v_mfma_f32_16x16x32_bf16 a[52:55], a[92:95], v[52:55], a[52:55]
ds_write_b128 v4, v[24:27] offset:3072
v_mfma_f32_16x16x32_bf16 a[56:59], a[92:95], v[56:59], a[56:59]
v_exp_f32 v14, v98
v_exp_f32 v15, v99
v_mfma_f32_16x16x32_bf16 a[60:63], a[92:95], v[60:63], a[60:63]
s_waitcnt vmcnt(14) lgkmcnt(4)
v_add_f32 v8, v8, v12
v_cvt_pk_bf16_f32 v20, v12, v13
v_add_f32 v8, v8, v13
v_mfma_f32_16x16x32_bf16 a[0:3], a[96:99], v[32:35], a[0:3]
s_waitcnt lgkmcnt(3)
buffer_load_dwordx4 a[92:95], v1, s[44:47], s69 offen offset:3072 sc1
v_sub_f32 v112, v112, v28
v_mfma_f32_16x16x32_bf16 a[4:7], a[96:99], v[36:39], a[4:7]
s_waitcnt lgkmcnt(2)
ds_read_b128 v[48:51], v3 offset:12288
v_sub_f32 v113, v113, v28
v_exp_f32 v16, v112
v_mfma_f32_16x16x32_bf16 a[8:11], a[96:99], v[40:43], a[8:11]
s_waitcnt lgkmcnt(2)
ds_read_b128 v[52:55], v3 offset:13312
v_exp_f32 v17, v113
v_mfma_f32_16x16x32_bf16 a[12:15], a[96:99], v[44:47], a[12:15]
s_waitcnt vmcnt(14)
v_add_f32 v8, v8, v14
v_cvt_pk_bf16_f32 v21, v14, v15
v_add_f32 v8, v8, v15
v_mfma_f32_16x16x32_bf16 a[16:19], a[100:103], v[32:35], a[16:19]
s_add_u32 s69, s69, 4096
buffer_load_dwordx4 a[96:99], v1, s[44:47], s69 offen offset:0 sc1
v_sub_f32 v114, v114, v28
v_mfma_f32_16x16x32_bf16 a[20:23], a[100:103], v[36:39], a[20:23]
ds_read_b128 v[56:59], v3 offset:14336
v_sub_f32 v115, v115, v28
v_exp_f32 v18, v114
v_mfma_f32_16x16x32_bf16 a[24:27], a[100:103], v[40:43], a[24:27]
ds_read_b128 v[60:63], v3 offset:15360
v_exp_f32 v19, v115
v_mfma_f32_16x16x32_bf16 a[28:31], a[100:103], v[44:47], a[28:31]
s_waitcnt vmcnt(14)
v_add_f32 v8, v8, v16
v_cvt_pk_bf16_f32 v22, v16, v17
v_add_f32 v8, v8, v17
v_mfma_f32_16x16x32_bf16 a[32:35], a[104:107], v[32:35], a[32:35]
buffer_load_dwordx4 a[100:103], v1, s[44:47], s69 offen offset:1024 sc1
v_sub_f32 v100, v100, v29
v_mfma_f32_16x16x32_bf16 a[36:39], a[104:107], v[36:39], a[36:39]
v_sub_f32 v101, v101, v29
v_exp_f32 v12, v100
v_mfma_f32_16x16x32_bf16 a[40:43], a[104:107], v[40:43], a[40:43]
v_exp_f32 v13, v101
v_add_f32 v8, v8, v18
v_mfma_f32_16x16x32_bf16 a[44:47], a[104:107], v[44:47], a[44:47]
s_waitcnt vmcnt(14)
v_cvt_pk_bf16_f32 v23, v18, v19
v_add_f32 v8, v8, v19
v_sub_f32 v102, v102, v29
v_mfma_f32_16x16x32_bf16 a[48:51], a[108:111], v[32:35], a[48:51]
buffer_load_dwordx4 a[104:107], v1, s[44:47], s69 offen offset:2048 sc1
v_sub_f32 v103, v103, v29
v_mfma_f32_16x16x32_bf16 a[52:55], a[108:111], v[36:39], a[52:55]
ds_write_b128 v4, v[20:23] offset:4096
v_mfma_f32_16x16x32_bf16 a[56:59], a[108:111], v[40:43], a[56:59]
v_exp_f32 v14, v102
v_exp_f32 v15, v103
v_mfma_f32_16x16x32_bf16 a[60:63], a[108:111], v[44:47], a[60:63]
s_waitcnt vmcnt(14) lgkmcnt(4)
v_add_f32 v9, v9, v12
v_cvt_pk_bf16_f32 v24, v12, v13
v_mfma_f32_16x16x32_bf16 a[0:3], a[112:115], v[48:51], a[0:3]
s_waitcnt lgkmcnt(3)
buffer_load_dwordx4 a[108:111], v1, s[44:47], s69 offen offset:3072 sc1
v_mfma_f32_16x16x32_bf16 a[4:7], a[112:115], v[52:55], a[4:7]
s_waitcnt lgkmcnt(2)
ds_read_b128 v[32:35], v3 offset:16384
v_add_f32 v9, v9, v13
v_mfma_f32_16x16x32_bf16 a[8:11], a[112:115], v[56:59], a[8:11]
s_waitcnt lgkmcnt(2)
ds_read_b128 v[36:39], v3 offset:17408
v_sub_f32 v116, v116, v29
v_mfma_f32_16x16x32_bf16 a[12:15], a[112:115], v[60:63], a[12:15]
s_waitcnt vmcnt(14)
v_sub_f32 v117, v117, v29
v_exp_f32 v16, v116
v_mfma_f32_16x16x32_bf16 a[16:19], a[116:119], v[48:51], a[16:19]
s_add_u32 s69, s69, 4096
buffer_load_dwordx4 a[112:115], v1, s[44:47], s69 offen offset:0 sc1
v_mfma_f32_16x16x32_bf16 a[20:23], a[116:119], v[52:55], a[20:23]
ds_read_b128 v[40:43], v3 offset:18432
v_mfma_f32_16x16x32_bf16 a[24:27], a[116:119], v[56:59], a[24:27]
ds_read_b128 v[44:47], v3 offset:19456
v_exp_f32 v17, v117
v_mfma_f32_16x16x32_bf16 a[28:31], a[116:119], v[60:63], a[28:31]
s_waitcnt vmcnt(14)
v_add_f32 v9, v9, v14
v_cvt_pk_bf16_f32 v25, v14, v15
v_mfma_f32_16x16x32_bf16 a[32:35], a[120:123], v[48:51], a[32:35]
buffer_load_dwordx4 a[116:119], v1, s[44:47], s69 offen offset:1024 sc1
v_mfma_f32_16x16x32_bf16 a[36:39], a[120:123], v[52:55], a[36:39]
v_add_f32 v9, v9, v15
v_sub_f32 v118, v118, v29
v_mfma_f32_16x16x32_bf16 a[40:43], a[120:123], v[56:59], a[40:43]
v_sub_f32 v119, v119, v29
v_mfma_f32_16x16x32_bf16 a[44:47], a[120:123], v[60:63], a[44:47]
s_waitcnt vmcnt(14)
v_exp_f32 v18, v118
v_mfma_f32_16x16x32_bf16 a[48:51], a[124:127], v[48:51], a[48:51]
buffer_load_dwordx4 a[120:123], v1, s[44:47], s69 offen offset:2048 sc1
v_mfma_f32_16x16x32_bf16 a[52:55], a[124:127], v[52:55], a[52:55]
v_exp_f32 v19, v119
v_mfma_f32_16x16x32_bf16 a[56:59], a[124:127], v[56:59], a[56:59]
v_add_f32 v9, v9, v16
v_cvt_pk_bf16_f32 v26, v16, v17
v_mfma_f32_16x16x32_bf16 a[60:63], a[124:127], v[60:63], a[60:63]
s_waitcnt vmcnt(14) lgkmcnt(3)
v_add_f32 v9, v9, v17
v_sub_f32 v104, v104, v30
v_mfma_f32_16x16x32_bf16 a[0:3], a[64:67], v[32:35], a[0:3]
s_waitcnt lgkmcnt(2)
buffer_load_dwordx4 a[124:127], v1, s[44:47], s69 offen offset:3072 sc1
v_mfma_f32_16x16x32_bf16 a[4:7], a[64:67], v[36:39], a[4:7]
s_waitcnt lgkmcnt(1)
ds_read_b128 v[48:51], v3 offset:20480
v_mfma_f32_16x16x32_bf16 a[8:11], a[64:67], v[40:43], a[8:11]
s_waitcnt lgkmcnt(1)
ds_read_b128 v[52:55], v3 offset:21504
v_sub_f32 v105, v105, v30
v_mfma_f32_16x16x32_bf16 a[12:15], a[64:67], v[44:47], a[12:15]
s_waitcnt vmcnt(14)
v_exp_f32 v12, v104
v_mfma_f32_16x16x32_bf16 a[16:19], a[68:71], v[32:35], a[16:19]
s_sub_u32 s70, s67, s93
s_mov_b32 s71, 233472
s_cmp_lt_u32 s70, 7
s_cselect_b32 s70, s71, 102400
s_add_u32 s68, s68, s70
buffer_load_dwordx4 a[64:67], v1, s[44:47], s68 offen offset:0 sc1
v_mfma_f32_16x16x32_bf16 a[20:23], a[68:71], v[36:39], a[20:23]
ds_read_b128 v[56:59], v3 offset:22528
v_exp_f32 v13, v105
v_mfma_f32_16x16x32_bf16 a[24:27], a[68:71], v[40:43], a[24:27]
ds_read_b128 v[60:63], v3 offset:23552
v_mfma_f32_16x16x32_bf16 a[28:31], a[68:71], v[44:47], a[28:31]
s_waitcnt vmcnt(14)
v_add_f32 v9, v9, v18
v_cvt_pk_bf16_f32 v27, v18, v19
v_mfma_f32_16x16x32_bf16 a[32:35], a[72:75], v[32:35], a[32:35]
buffer_load_dwordx4 a[68:71], v1, s[44:47], s68 offen offset:1024 sc1
v_mfma_f32_16x16x32_bf16 a[36:39], a[72:75], v[36:39], a[36:39]
v_add_f32 v9, v9, v19
v_sub_f32 v106, v106, v30
v_mfma_f32_16x16x32_bf16 a[40:43], a[72:75], v[40:43], a[40:43]
ds_write_b128 v4, v[24:27] offset:5120
v_mfma_f32_16x16x32_bf16 a[44:47], a[72:75], v[44:47], a[44:47]
s_waitcnt vmcnt(14)
v_sub_f32 v107, v107, v30
v_exp_f32 v14, v106
v_mfma_f32_16x16x32_bf16 a[48:51], a[76:79], v[32:35], a[48:51]
buffer_load_dwordx4 a[72:75], v1, s[44:47], s68 offen offset:2048 sc1
v_mfma_f32_16x16x32_bf16 a[52:55], a[76:79], v[36:39], a[52:55]
v_exp_f32 v15, v107
v_mfma_f32_16x16x32_bf16 a[56:59], a[76:79], v[40:43], a[56:59]
v_add_f32 v10, v10, v12
v_cvt_pk_bf16_f32 v20, v12, v13
v_mfma_f32_16x16x32_bf16 a[60:63], a[76:79], v[44:47], a[60:63]
s_waitcnt vmcnt(14) lgkmcnt(4)
v_add_f32 v10, v10, v13
v_sub_f32 v120, v120, v30
v_mfma_f32_16x16x32_bf16 a[0:3], a[80:83], v[48:51], a[0:3]
s_waitcnt lgkmcnt(3)
buffer_load_dwordx4 a[76:79], v1, s[44:47], s68 offen offset:3072 sc1
v_mfma_f32_16x16x32_bf16 a[4:7], a[80:83], v[52:55], a[4:7]
s_waitcnt lgkmcnt(2)
ds_read_b128 v[32:35], v3 offset:24576
v_sub_f32 v121, v121, v30
v_mfma_f32_16x16x32_bf16 a[8:11], a[80:83], v[56:59], a[8:11]
s_waitcnt lgkmcnt(2)
ds_read_b128 v[36:39], v3 offset:25600
v_exp_f32 v16, v120
v_mfma_f32_16x16x32_bf16 a[12:15], a[80:83], v[60:63], a[12:15]
s_waitcnt vmcnt(14)
v_exp_f32 v17, v121
v_mfma_f32_16x16x32_bf16 a[16:19], a[84:87], v[48:51], a[16:19]
s_add_u32 s68, s68, 4096
buffer_load_dwordx4 a[80:83], v1, s[44:47], s68 offen offset:0 sc1
v_mfma_f32_16x16x32_bf16 a[20:23], a[84:87], v[52:55], a[20:23]
ds_read_b128 v[40:43], v3 offset:26624
v_mfma_f32_16x16x32_bf16 a[24:27], a[84:87], v[56:59], a[24:27]
ds_read_b128 v[44:47], v3 offset:27648
v_mfma_f32_16x16x32_bf16 a[28:31], a[84:87], v[60:63], a[28:31]
s_waitcnt vmcnt(14)
v_add_f32 v10, v10, v14
v_cvt_pk_bf16_f32 v21, v14, v15
v_mfma_f32_16x16x32_bf16 a[32:35], a[88:91], v[48:51], a[32:35]
buffer_load_dwordx4 a[84:87], v1, s[44:47], s68 offen offset:1024 sc1
v_mfma_f32_16x16x32_bf16 a[36:39], a[88:91], v[52:55], a[36:39]
v_add_f32 v10, v10, v15
v_sub_f32 v122, v122, v30
v_mfma_f32_16x16x32_bf16 a[40:43], a[88:91], v[56:59], a[40:43]
v_sub_f32 v123, v123, v30
v_exp_f32 v18, v122
v_mfma_f32_16x16x32_bf16 a[44:47], a[88:91], v[60:63], a[44:47]
s_waitcnt vmcnt(14)
v_exp_f32 v19, v123
v_mfma_f32_16x16x32_bf16 a[48:51], a[92:95], v[48:51], a[48:51]
buffer_load_dwordx4 a[88:91], v1, s[44:47], s68 offen offset:2048 sc1
v_mfma_f32_16x16x32_bf16 a[52:55], a[92:95], v[52:55], a[52:55]
v_add_f32 v10, v10, v16
v_cvt_pk_bf16_f32 v22, v16, v17
v_mfma_f32_16x16x32_bf16 a[56:59], a[92:95], v[56:59], a[56:59]
v_add_f32 v10, v10, v17
v_sub_f32 v108, v108, v31
v_mfma_f32_16x16x32_bf16 a[60:63], a[92:95], v[60:63], a[60:63]
s_waitcnt vmcnt(14) lgkmcnt(3)
v_sub_f32 v109, v109, v31
v_mfma_f32_16x16x32_bf16 a[0:3], a[96:99], v[32:35], a[0:3]
s_waitcnt lgkmcnt(2)
buffer_load_dwordx4 a[92:95], v1, s[44:47], s68 offen offset:3072 sc1
v_mfma_f32_16x16x32_bf16 a[4:7], a[96:99], v[36:39], a[4:7]
s_waitcnt lgkmcnt(1)
ds_read_b128 v[48:51], v3 offset:28672
v_exp_f32 v12, v108
v_mfma_f32_16x16x32_bf16 a[8:11], a[96:99], v[40:43], a[8:11]
s_waitcnt lgkmcnt(1)
ds_read_b128 v[52:55], v3 offset:29696
v_mfma_f32_16x16x32_bf16 a[12:15], a[96:99], v[44:47], a[12:15]
s_waitcnt vmcnt(14)
v_exp_f32 v13, v109
v_mfma_f32_16x16x32_bf16 a[16:19], a[100:103], v[32:35], a[16:19]
s_add_u32 s68, s68, 4096
buffer_load_dwordx4 a[96:99], v1, s[44:47], s68 offen offset:0 sc1
v_mfma_f32_16x16x32_bf16 a[20:23], a[100:103], v[36:39], a[20:23]
ds_read_b128 v[56:59], v3 offset:30720
v_mfma_f32_16x16x32_bf16 a[24:27], a[100:103], v[40:43], a[24:27]
ds_read_b128 v[60:63], v3 offset:31744
v_add_f32 v10, v10, v18
v_mfma_f32_16x16x32_bf16 a[28:31], a[100:103], v[44:47], a[28:31]
s_waitcnt vmcnt(14)
v_cvt_pk_bf16_f32 v23, v18, v19
v_add_f32 v10, v10, v19
v_mfma_f32_16x16x32_bf16 a[32:35], a[104:107], v[32:35], a[32:35]
buffer_load_dwordx4 a[100:103], v1, s[44:47], s68 offen offset:1024 sc1
v_mfma_f32_16x16x32_bf16 a[36:39], a[104:107], v[36:39], a[36:39]
ds_write_b128 v4, v[20:23] offset:6144
v_mfma_f32_16x16x32_bf16 a[40:43], a[104:107], v[40:43], a[40:43]
v_sub_f32 v110, v110, v31
v_sub_f32 v111, v111, v31
v_exp_f32 v14, v110
v_mfma_f32_16x16x32_bf16 a[44:47], a[104:107], v[44:47], a[44:47]
s_waitcnt vmcnt(14)
v_exp_f32 v15, v111
v_mfma_f32_16x16x32_bf16 a[48:51], a[108:111], v[32:35], a[48:51]
buffer_load_dwordx4 a[104:107], v1, s[44:47], s68 offen offset:2048 sc1
v_mfma_f32_16x16x32_bf16 a[52:55], a[108:111], v[36:39], a[52:55]
v_add_f32 v11, v11, v12
v_cvt_pk_bf16_f32 v24, v12, v13
v_mfma_f32_16x16x32_bf16 a[56:59], a[108:111], v[40:43], a[56:59]
v_add_f32 v11, v11, v13
v_sub_f32 v124, v124, v31
v_mfma_f32_16x16x32_bf16 a[60:63], a[108:111], v[44:47], a[60:63]
s_waitcnt vmcnt(14) lgkmcnt(4)
v_sub_f32 v125, v125, v31
v_exp_f32 v16, v124
v_mfma_f32_16x16x32_bf16 a[0:3], a[112:115], v[48:51], a[0:3]
s_waitcnt lgkmcnt(3)
buffer_load_dwordx4 a[108:111], v1, s[44:47], s68 offen offset:3072 sc1
v_mfma_f32_16x16x32_bf16 a[4:7], a[112:115], v[52:55], a[4:7]
s_waitcnt lgkmcnt(2)
ds_read_b128 v[32:35], v2 offset:0
v_mfma_f32_16x16x32_bf16 a[8:11], a[112:115], v[56:59], a[8:11]
s_waitcnt lgkmcnt(2)
ds_read_b128 v[36:39], v2 offset:8320
v_mfma_f32_16x16x32_bf16 a[12:15], a[112:115], v[60:63], a[12:15]
s_waitcnt vmcnt(14)
v_exp_f32 v17, v125
v_mfma_f32_16x16x32_bf16 a[16:19], a[116:119], v[48:51], a[16:19]
s_add_u32 s68, s68, 4096
buffer_load_dwordx4 a[112:115], v1, s[44:47], s68 offen offset:0 sc1
v_mfma_f32_16x16x32_bf16 a[20:23], a[116:119], v[52:55], a[20:23]
ds_read_b128 v[40:43], v2 offset:16640
v_add_f32 v11, v11, v14
v_mfma_f32_16x16x32_bf16 a[24:27], a[116:119], v[56:59], a[24:27]
ds_read_b128 v[44:47], v2 offset:24960
v_cvt_pk_bf16_f32 v25, v14, v15
v_mfma_f32_16x16x32_bf16 a[28:31], a[116:119], v[60:63], a[28:31]
s_waitcnt vmcnt(14)
v_add_f32 v11, v11, v15
v_sub_f32 v126, v126, v31
v_mfma_f32_16x16x32_bf16 a[32:35], a[120:123], v[48:51], a[32:35]
buffer_load_dwordx4 a[116:119], v1, s[44:47], s68 offen offset:1024 sc1
v_mfma_f32_16x16x32_bf16 a[36:39], a[120:123], v[52:55], a[36:39]
v_sub_f32 v127, v127, v31
v_exp_f32 v18, v126
v_mfma_f32_16x16x32_bf16 a[40:43], a[120:123], v[56:59], a[40:43]
v_exp_f32 v19, v127
v_mfma_f32_16x16x32_bf16 a[44:47], a[120:123], v[60:63], a[44:47]
s_waitcnt vmcnt(14)
v_add_f32 v11, v11, v16
v_cvt_pk_bf16_f32 v26, v16, v17
v_mfma_f32_16x16x32_bf16 a[48:51], a[124:127], v[48:51], a[48:51]
buffer_load_dwordx4 a[120:123], v1, s[44:47], s68 offen offset:2048 sc1
v_mfma_f32_16x16x32_bf16 a[52:55], a[124:127], v[52:55], a[52:55]
v_add_f32 v11, v11, v17
v_add_f32 v11, v11, v18
v_mfma_f32_16x16x32_bf16 a[56:59], a[124:127], v[56:59], a[56:59]
v_cvt_pk_bf16_f32 v27, v18, v19
v_add_f32 v11, v11, v19
v_mfma_f32_16x16x32_bf16 a[60:63], a[124:127], v[60:63], a[60:63]
s_waitcnt vmcnt(14) lgkmcnt(3)
ds_write_b128 v4, v[24:27] offset:7168
s_add_u32 s67, s67, 1
v_mov_b32 v6, s67
ds_write_b32 v5, v6
v_xor_b32 v4, 0x8000, v4
v_xor_b32 v3, 0x8000, v3
s_add_u32 s69, s69, 233472
s_sub_u32 s70, s67, s93
s_cmp_lt_u32 s70, 8
s_cbranch_scc1 L_loop_s
v_mov_b32 v12, v8
v_mov_b32 v13, v9
v_mov_b32 v14, v10
v_mov_b32 v15, v11
s_nop 0
v_permlane32_swap_b32 v8, v12
v_permlane32_swap_b32 v9, v13
v_permlane32_swap_b32 v10, v14
v_permlane32_swap_b32 v11, v15
v_add_f32 v8, v8, v12
v_add_f32 v9, v9, v13
v_add_f32 v10, v10, v14
v_add_f32 v11, v11, v15
v_mov_b32 v12, v8
v_mov_b32 v13, v9
v_mov_b32 v14, v10
v_mov_b32 v15, v11
s_nop 0
v_permlane16_swap_b32 v8, v12
v_permlane16_swap_b32 v9, v13
v_permlane16_swap_b32 v10, v14
v_permlane16_swap_b32 v11, v15
v_add_f32 v8, v8, v12
v_add_f32 v9, v9, v13
v_add_f32 v10, v10, v14
v_add_f32 v11, v11, v15
s_lshl_b32 s70, s64, 10
s_add_u32 s70, s70, 102912
v_lshrrev_b32 v12, 2, v1
v_add_u32 v12, s70, v12
ds_write_b32 v12, v8 offset:0
ds_write_b32 v12, v9 offset:256
ds_write_b32 v12, v10 offset:512
ds_write_b32 v12, v11 offset:768
s_add_u32 s67, s67, 1
v_mov_b32 v6, s67
ds_write_b32 v5, v6
s_waitcnt lgkmcnt(0)
ds_read_b32 v6, v0
v_lshrrev_b32 v13, 4, v1
v_and_b32 v14, 15, v13
v_lshrrev_b32 v13, 4, v13
v_lshlrev_b32 v12, 2, v14
v_add_u32 v12, 102912, v12
s_waitcnt lgkmcnt(0)
v_cmp_gt_u32 vcc, s67, v6
s_cbranch_vccnz L_spin_pt_s
L_back_pt_s:
ds_read_b128 v[32:35], v3 offset:0
ds_read_b128 v[36:39], v3 offset:1024
ds_read_b128 v[40:43], v3 offset:2048
ds_read_b128 v[44:47], v3 offset:3072
s_waitcnt lgkmcnt(3)
v_mfma_f32_16x16x32_bf16 a[0:3], a[64:67], v[32:35], a[0:3]
s_waitcnt lgkmcnt(2)
buffer_load_dwordx4 a[124:127], v1, s[44:47], s68 offen offset:3072 sc1
v_mfma_f32_16x16x32_bf16 a[4:7], a[64:67], v[36:39], a[4:7]
s_waitcnt lgkmcnt(1)
ds_read_b128 v[48:51], v3 offset:4096
v_mfma_f32_16x16x32_bf16 a[8:11], a[64:67], v[40:43], a[8:11]
s_waitcnt lgkmcnt(1)
ds_read_b128 v[52:55], v3 offset:5120
v_mfma_f32_16x16x32_bf16 a[12:15], a[64:67], v[44:47], a[12:15]
s_waitcnt vmcnt(14)
ds_read_b32 v64, v12 offset:0
v_mfma_f32_16x16x32_bf16 a[16:19], a[68:71], v[32:35], a[16:19]
s_add_u32 s68, s68, 4096
buffer_load_dwordx4 a[64:67], v1, s[44:47], s68 offen offset:0 sc1
v_mfma_f32_16x16x32_bf16 a[20:23], a[68:71], v[36:39], a[20:23]
ds_read_b128 v[56:59], v3 offset:6144
v_mfma_f32_16x16x32_bf16 a[24:27], a[68:71], v[40:43], a[24:27]
ds_read_b128 v[60:63], v3 offset:7168
v_mfma_f32_16x16x32_bf16 a[28:31], a[68:71], v[44:47], a[28:31]
s_waitcnt vmcnt(14)
ds_read_b32 v65, v12 offset:1024
v_mfma_f32_16x16x32_bf16 a[32:35], a[72:75], v[32:35], a[32:35]
buffer_load_dwordx4 a[68:71], v1, s[44:47], s68 offen offset:1024 sc1
v_mfma_f32_16x16x32_bf16 a[36:39], a[72:75], v[36:39], a[36:39]
v_mfma_f32_16x16x32_bf16 a[40:43], a[72:75], v[40:43], a[40:43]
v_mfma_f32_16x16x32_bf16 a[44:47], a[72:75], v[44:47], a[44:47]
s_waitcnt vmcnt(14)
ds_read_b32 v66, v12 offset:2048
v_mfma_f32_16x16x32_bf16 a[48:51], a[76:79], v[32:35], a[48:51]
buffer_load_dwordx4 a[72:75], v1, s[44:47], s68 offen offset:2048 sc1
v_mfma_f32_16x16x32_bf16 a[52:55], a[76:79], v[36:39], a[52:55]
v_mfma_f32_16x16x32_bf16 a[56:59], a[76:79], v[40:43], a[56:59]
v_mfma_f32_16x16x32_bf16 a[60:63], a[76:79], v[44:47], a[60:63]
s_waitcnt vmcnt(14) lgkmcnt(6)
ds_read_b32 v67, v12 offset:3072
v_mfma_f32_16x16x32_bf16 a[0:3], a[80:83], v[48:51], a[0:3]
s_waitcnt lgkmcnt(6)
buffer_load_dwordx4 a[76:79], v1, s[44:47], s68 offen offset:3072 sc1
v_mfma_f32_16x16x32_bf16 a[4:7], a[80:83], v[52:55], a[4:7]
s_waitcnt lgkmcnt(4)
ds_read_b128 v[32:35], v3 offset:8192
v_mfma_f32_16x16x32_bf16 a[8:11], a[80:83], v[56:59], a[8:11]
s_waitcnt lgkmcnt(4)
ds_read_b128 v[36:39], v3 offset:9216
v_mfma_f32_16x16x32_bf16 a[12:15], a[80:83], v[60:63], a[12:15]
s_waitcnt vmcnt(14)
ds_read_b32 v68, v12 offset:256
v_mfma_f32_16x16x32_bf16 a[16:19], a[84:87], v[48:51], a[16:19]
s_add_u32 s68, s68, 4096
buffer_load_dwordx4 a[80:83], v1, s[44:47], s68 offen offset:0 sc1
v_mfma_f32_16x16x32_bf16 a[20:23], a[84:87], v[52:55], a[20:23]
ds_read_b128 v[40:43], v3 offset:10240
v_mfma_f32_16x16x32_bf16 a[24:27], a[84:87], v[56:59], a[24:27]
ds_read_b128 v[44:47], v3 offset:11264
v_mfma_f32_16x16x32_bf16 a[28:31], a[84:87], v[60:63], a[28:31]
s_waitcnt vmcnt(14)
ds_read_b32 v69, v12 offset:1280
v_mfma_f32_16x16x32_bf16 a[32:35], a[88:91], v[48:51], a[32:35]
buffer_load_dwordx4 a[84:87], v1, s[44:47], s68 offen offset:1024 sc1
v_mfma_f32_16x16x32_bf16 a[36:39], a[88:91], v[52:55], a[36:39]
v_mfma_f32_16x16x32_bf16 a[40:43], a[88:91], v[56:59], a[40:43]
v_mfma_f32_16x16x32_bf16 a[44:47], a[88:91], v[60:63], a[44:47]
s_waitcnt vmcnt(14)
ds_read_b32 v70, v12 offset:2304
v_mfma_f32_16x16x32_bf16 a[48:51], a[92:95], v[48:51], a[48:51]
buffer_load_dwordx4 a[88:91], v1, s[44:47], s68 offen offset:2048 sc1
v_mfma_f32_16x16x32_bf16 a[52:55], a[92:95], v[52:55], a[52:55]
v_mfma_f32_16x16x32_bf16 a[56:59], a[92:95], v[56:59], a[56:59]
v_mfma_f32_16x16x32_bf16 a[60:63], a[92:95], v[60:63], a[60:63]
s_waitcnt vmcnt(14) lgkmcnt(6)
ds_read_b32 v71, v12 offset:3328
v_mfma_f32_16x16x32_bf16 a[0:3], a[96:99], v[32:35], a[0:3]
s_waitcnt lgkmcnt(6)
buffer_load_dwordx4 a[92:95], v1, s[44:47], s68 offen offset:3072 sc1
v_mfma_f32_16x16x32_bf16 a[4:7], a[96:99], v[36:39], a[4:7]
s_waitcnt lgkmcnt(4)
ds_read_b128 v[48:51], v3 offset:12288
v_mfma_f32_16x16x32_bf16 a[8:11], a[96:99], v[40:43], a[8:11]
s_waitcnt lgkmcnt(4)
ds_read_b128 v[52:55], v3 offset:13312
v_mfma_f32_16x16x32_bf16 a[12:15], a[96:99], v[44:47], a[12:15]
s_waitcnt vmcnt(14)
ds_read_b32 v72, v12 offset:512
v_mfma_f32_16x16x32_bf16 a[16:19], a[100:103], v[32:35], a[16:19]
s_add_u32 s68, s68, 4096
buffer_load_dwordx4 a[96:99], v1, s[44:47], s68 offen offset:0 sc1
v_mfma_f32_16x16x32_bf16 a[20:23], a[100:103], v[36:39], a[20:23]
ds_read_b128 v[56:59], v3 offset:14336
v_mfma_f32_16x16x32_bf16 a[24:27], a[100:103], v[40:43], a[24:27]
ds_read_b128 v[60:63], v3 offset:15360
v_mfma_f32_16x16x32_bf16 a[28:31], a[100:103], v[44:47], a[28:31]
s_waitcnt vmcnt(14)
ds_read_b32 v73, v12 offset:1536
v_mfma_f32_16x16x32_bf16 a[32:35], a[104:107], v[32:35], a[32:35]
buffer_load_dwordx4 a[100:103], v1, s[44:47], s68 offen offset:1024 sc1
v_mfma_f32_16x16x32_bf16 a[36:39], a[104:107], v[36:39], a[36:39]
v_mfma_f32_16x16x32_bf16 a[40:43], a[104:107], v[40:43], a[40:43]
v_mfma_f32_16x16x32_bf16 a[44:47], a[104:107], v[44:47], a[44:47]
s_waitcnt vmcnt(14)
ds_read_b32 v74, v12 offset:2560
v_mfma_f32_16x16x32_bf16 a[48:51], a[108:111], v[32:35], a[48:51]
buffer_load_dwordx4 a[104:107], v1, s[44:47], s68 offen offset:2048 sc1
v_mfma_f32_16x16x32_bf16 a[52:55], a[108:111], v[36:39], a[52:55]
v_mfma_f32_16x16x32_bf16 a[56:59], a[108:111], v[40:43], a[56:59]
v_mfma_f32_16x16x32_bf16 a[60:63], a[108:111], v[44:47], a[60:63]
s_waitcnt vmcnt(14) lgkmcnt(6)
ds_read_b32 v75, v12 offset:3584
v_mfma_f32_16x16x32_bf16 a[0:3], a[112:115], v[48:51], a[0:3]
s_waitcnt lgkmcnt(6)
buffer_load_dwordx4 a[108:111], v1, s[44:47], s68 offen offset:3072 sc1
v_mfma_f32_16x16x32_bf16 a[4:7], a[112:115], v[52:55], a[4:7]
s_waitcnt lgkmcnt(4)
ds_read_b128 v[32:35], v3 offset:16384
v_mfma_f32_16x16x32_bf16 a[8:11], a[112:115], v[56:59], a[8:11]
s_waitcnt lgkmcnt(4)
ds_read_b128 v[36:39], v3 offset:17408
v_mfma_f32_16x16x32_bf16 a[12:15], a[112:115], v[60:63], a[12:15]
s_waitcnt vmcnt(14)
ds_read_b32 v76, v12 offset:768
v_mfma_f32_16x16x32_bf16 a[16:19], a[116:119], v[48:51], a[16:19]
s_add_u32 s68, s68, 4096
buffer_load_dwordx4 a[112:115], v1, s[44:47], s68 offen offset:0 sc1
v_mfma_f32_16x16x32_bf16 a[20:23], a[116:119], v[52:55], a[20:23]
ds_read_b128 v[40:43], v3 offset:18432
v_mfma_f32_16x16x32_bf16 a[24:27], a[116:119], v[56:59], a[24:27]
ds_read_b128 v[44:47], v3 offset:19456
v_mfma_f32_16x16x32_bf16 a[28:31], a[116:119], v[60:63], a[28:31]
s_waitcnt vmcnt(14)
ds_read_b32 v77, v12 offset:1792
v_mfma_f32_16x16x32_bf16 a[32:35], a[120:123], v[48:51], a[32:35]
buffer_load_dwordx4 a[116:119], v1, s[44:47], s68 offen offset:1024 sc1
v_mfma_f32_16x16x32_bf16 a[36:39], a[120:123], v[52:55], a[36:39]
v_mfma_f32_16x16x32_bf16 a[40:43], a[120:123], v[56:59], a[40:43]
v_mfma_f32_16x16x32_bf16 a[44:47], a[120:123], v[60:63], a[44:47]
s_waitcnt vmcnt(14)
ds_read_b32 v78, v12 offset:2816
v_mfma_f32_16x16x32_bf16 a[48:51], a[124:127], v[48:51], a[48:51]
buffer_load_dwordx4 a[120:123], v1, s[44:47], s68 offen offset:2048 sc1
v_mfma_f32_16x16x32_bf16 a[52:55], a[124:127], v[52:55], a[52:55]
v_mfma_f32_16x16x32_bf16 a[56:59], a[124:127], v[56:59], a[56:59]
v_mfma_f32_16x16x32_bf16 a[60:63], a[124:127], v[60:63], a[60:63]
s_waitcnt vmcnt(14) lgkmcnt(6)
ds_read_b32 v79, v12 offset:3840
v_mfma_f32_16x16x32_bf16 a[0:3], a[64:67], v[32:35], a[0:3]
s_waitcnt lgkmcnt(6)
buffer_load_dwordx4 a[124:127], v1, s[44:47], s68 offen offset:3072 sc1
v_mfma_f32_16x16x32_bf16 a[4:7], a[64:67], v[36:39], a[4:7]
s_waitcnt lgkmcnt(4)
ds_read_b128 v[48:51], v3 offset:20480
v_mfma_f32_16x16x32_bf16 a[8:11], a[64:67], v[40:43], a[8:11]
s_waitcnt lgkmcnt(4)
ds_read_b128 v[52:55], v3 offset:21504
v_mfma_f32_16x16x32_bf16 a[12:15], a[64:67], v[44:47], a[12:15]
s_waitcnt vmcnt(14)
v_mfma_f32_16x16x32_bf16 a[16:19], a[68:71], v[32:35], a[16:19]
v_mfma_f32_16x16x32_bf16 a[20:23], a[68:71], v[36:39], a[20:23]
ds_read_b128 v[56:59], v3 offset:22528
v_mfma_f32_16x16x32_bf16 a[24:27], a[68:71], v[40:43], a[24:27]
ds_read_b128 v[60:63], v3 offset:23552
v_mfma_f32_16x16x32_bf16 a[28:31], a[68:71], v[44:47], a[28:31]
s_waitcnt vmcnt(13)
v_mfma_f32_16x16x32_bf16 a[32:35], a[72:75], v[32:35], a[32:35]
v_mfma_f32_16x16x32_bf16 a[36:39], a[72:75], v[36:39], a[36:39]
v_mfma_f32_16x16x32_bf16 a[40:43], a[72:75], v[40:43], a[40:43]
v_mfma_f32_16x16x32_bf16 a[44:47], a[72:75], v[44:47], a[44:47]
s_waitcnt vmcnt(12)
s_waitcnt lgkmcnt(4)
v_add_f32 v64, v64, v65
v_add_f32 v66, v66, v67
v_add_f32 v68, v68, v69
v_add_f32 v70, v70, v71
v_add_f32 v72, v72, v73
v_add_f32 v74, v74, v75
v_add_f32 v76, v76, v77
v_add_f32 v78, v78, v79
v_mfma_f32_16x16x32_bf16 a[48:51], a[76:79], v[32:35], a[48:51]
v_mfma_f32_16x16x32_bf16 a[52:55], a[76:79], v[36:39], a[52:55]
v_mfma_f32_16x16x32_bf16 a[56:59], a[76:79], v[40:43], a[56:59]
v_mfma_f32_16x16x32_bf16 a[60:63], a[76:79], v[44:47], a[60:63]
s_waitcnt vmcnt(11) lgkmcnt(3)
v_add_f32 v80, v64, v66
v_add_f32 v81, v68, v70
v_add_f32 v82, v72, v74
v_add_f32 v83, v76, v78
v_mfma_f32_16x16x32_bf16 a[0:3], a[80:83], v[48:51], a[0:3]
s_waitcnt lgkmcnt(2)
v_mfma_f32_16x16x32_bf16 a[4:7], a[80:83], v[52:55], a[4:7]
s_waitcnt lgkmcnt(1)
ds_read_b128 v[32:35], v3 offset:24576
v_mfma_f32_16x16x32_bf16 a[8:11], a[80:83], v[56:59], a[8:11]
s_waitcnt lgkmcnt(1)
ds_read_b128 v[36:39], v3 offset:25600
v_mfma_f32_16x16x32_bf16 a[12:15], a[80:83], v[60:63], a[12:15]
s_waitcnt vmcnt(10)
s_mov_b32 s70, 0x2f800000
s_mov_b32 s71, 0x4f800000
v_mfma_f32_16x16x32_bf16 a[16:19], a[84:87], v[48:51], a[16:19]
v_mfma_f32_16x16x32_bf16 a[20:23], a[84:87], v[52:55], a[20:23]
ds_read_b128 v[40:43], v3 offset:26624
v_mfma_f32_16x16x32_bf16 a[24:27], a[84:87], v[56:59], a[24:27]
ds_read_b128 v[44:47], v3 offset:27648
v_mfma_f32_16x16x32_bf16 a[28:31], a[84:87], v[60:63], a[28:31]
s_waitcnt vmcnt(9)
v_cmp_lt_f32 vcc, s70, v80
v_cmp_lt_f32_e64 s[76:77], s70, v81
v_cmp_lt_f32_e64 s[78:79], s70, v82
v_cmp_lt_f32_e64 s[74:75], s70, v83
v_mfma_f32_16x16x32_bf16 a[32:35], a[88:91], v[48:51], a[32:35]
v_mfma_f32_16x16x32_bf16 a[36:39], a[88:91], v[52:55], a[36:39]
v_mfma_f32_16x16x32_bf16 a[40:43], a[88:91], v[56:59], a[40:43]
v_mfma_f32_16x16x32_bf16 a[44:47], a[88:91], v[60:63], a[44:47]
s_waitcnt vmcnt(8)
s_and_b64 s[76:77], s[76:77], vcc
s_and_b64 s[74:75], s[74:75], s[78:79]
s_and_b64 s[74:75], s[74:75], s[76:77]
v_mfma_f32_16x16x32_bf16 a[48:51], a[92:95], v[48:51], a[48:51]
v_mfma_f32_16x16x32_bf16 a[52:55], a[92:95], v[52:55], a[52:55]
v_mfma_f32_16x16x32_bf16 a[56:59], a[92:95], v[56:59], a[56:59]
v_mfma_f32_16x16x32_bf16 a[60:63], a[92:95], v[60:63], a[60:63]
s_waitcnt vmcnt(7) lgkmcnt(3)
v_cmp_gt_f32 vcc, s71, v80
v_cmp_gt_f32_e64 s[76:77], s71, v81
v_cmp_gt_f32_e64 s[78:79], s71, v82
v_cmp_gt_f32_e64 s[72:73], s71, v83
v_mfma_f32_16x16x32_bf16 a[0:3], a[96:99], v[32:35], a[0:3]
s_waitcnt lgkmcnt(2)
v_mfma_f32_16x16x32_bf16 a[4:7], a[96:99], v[36:39], a[4:7]
s_waitcnt lgkmcnt(1)
ds_read_b128 v[48:51], v3 offset:28672
v_mfma_f32_16x16x32_bf16 a[8:11], a[96:99], v[40:43], a[8:11]
s_waitcnt lgkmcnt(1)
ds_read_b128 v[52:55], v3 offset:29696
v_mfma_f32_16x16x32_bf16 a[12:15], a[96:99], v[44:47], a[12:15]
s_waitcnt vmcnt(6)
s_and_b64 s[76:77], s[76:77], vcc
s_and_b64 s[78:79], s[78:79], s[72:73]
s_and_b64 s[74:75], s[74:75], s[76:77]
s_and_b64 s[74:75], s[74:75], s[78:79]
v_mfma_f32_16x16x32_bf16 a[16:19], a[100:103], v[32:35], a[16:19]
v_mfma_f32_16x16x32_bf16 a[20:23], a[100:103], v[36:39], a[20:23]
ds_read_b128 v[56:59], v3 offset:30720
v_mfma_f32_16x16x32_bf16 a[24:27], a[100:103], v[40:43], a[24:27]
ds_read_b128 v[60:63], v3 offset:31744
v_mfma_f32_16x16x32_bf16 a[28:31], a[100:103], v[44:47], a[28:31]
s_waitcnt vmcnt(5)
v_rcp_f32 v88, v80
v_rcp_f32 v90, v81
v_rcp_f32 v92, v82
v_rcp_f32 v94, v83
v_mfma_f32_16x16x32_bf16 a[32:35], a[104:107], v[32:35], a[32:35]
v_mfma_f32_16x16x32_bf16 a[36:39], a[104:107], v[36:39], a[36:39]
v_mfma_f32_16x16x32_bf16 a[40:43], a[104:107], v[40:43], a[40:43]
v_mfma_f32_16x16x32_bf16 a[44:47], a[104:107], v[44:47], a[44:47]
s_waitcnt vmcnt(4)
v_mov_b32 v89, v88
v_mov_b32 v91, v90
v_mov_b32 v93, v92
v_mov_b32 v95, v94
v_mfma_f32_16x16x32_bf16 a[48:51], a[108:111], v[32:35], a[48:51]
v_mfma_f32_16x16x32_bf16 a[52:55], a[108:111], v[36:39], a[52:55]
v_mfma_f32_16x16x32_bf16 a[56:59], a[108:111], v[40:43], a[56:59]
v_mfma_f32_16x16x32_bf16 a[60:63], a[108:111], v[44:47], a[60:63]
s_waitcnt vmcnt(3) lgkmcnt(3)
s_lshl_b32 s70, s65, 20
s_add_u32 s48, s38, s70
s_addc_u32 s49, s39, 0
s_and_b32 s49, s49, 0xffff
s_mov_b32 s50, 0x100000
s_mov_b32 s51, 0x20000
v_mfma_f32_16x16x32_bf16 a[0:3], a[112:115], v[48:51], a[0:3]
s_waitcnt lgkmcnt(2)
v_mfma_f32_16x16x32_bf16 a[4:7], a[112:115], v[52:55], a[4:7]
s_waitcnt lgkmcnt(1)
v_mfma_f32_16x16x32_bf16 a[8:11], a[112:115], v[56:59], a[8:11]
s_waitcnt lgkmcnt(0)
v_mfma_f32_16x16x32_bf16 a[12:15], a[112:115], v[60:63], a[12:15]
s_waitcnt vmcnt(2)
s_lshl_b32 s71, s66, 15
s_lshl_b32 s70, s64, 7
s_add_u32 s71, s71, s70
v_mfma_f32_16x16x32_bf16 a[16:19], a[116:119], v[48:51], a[16:19]
v_mfma_f32_16x16x32_bf16 a[20:23], a[116:119], v[52:55], a[20:23]
v_mfma_f32_16x16x32_bf16 a[24:27], a[116:119], v[56:59], a[24:27]
v_mfma_f32_16x16x32_bf16 a[28:31], a[116:119], v[60:63], a[28:31]
s_waitcnt vmcnt(1)
v_mfma_f32_16x16x32_bf16 a[32:35], a[120:123], v[48:51], a[32:35]
v_mfma_f32_16x16x32_bf16 a[36:39], a[120:123], v[52:55], a[36:39]
v_mfma_f32_16x16x32_bf16 a[40:43], a[120:123], v[56:59], a[40:43]
v_mfma_f32_16x16x32_bf16 a[44:47], a[120:123], v[60:63], a[44:47]
s_waitcnt vmcnt(0)
v_mfma_f32_16x16x32_bf16 a[48:51], a[124:127], v[48:51], a[48:51]
v_mfma_f32_16x16x32_bf16 a[52:55], a[124:127], v[52:55], a[52:55]
v_mfma_f32_16x16x32_bf16 a[56:59], a[124:127], v[56:59], a[56:59]
v_mfma_f32_16x16x32_bf16 a[60:63], a[124:127], v[60:63], a[60:63]
s_branch L_epilogue
L_spin_ta_f:
s_mov_b32 s90, 0x80000
L_spin2_ta_f:
ds_read_b32 v6, v0 offset:2048
s_waitcnt lgkmcnt(0)
v_cmp_gt_u32 vcc, s92, v6
s_cbranch_vccz L_back_ta_f
s_sleep 1
s_sub_u32 s90, s90, 1
s_cmp_lg_u32 s90, 0
s_cbranch_scc1 L_spin2_ta_f
s_branch L_back_ta_f
L_spin_p_f:
s_mov_b32 s90, 0x80000
L_spin2_p_f:
ds_read_b32 v6, v0 offset:0
s_waitcnt lgkmcnt(0)
v_cmp_gt_u32 vcc, s67, v6
s_cbranch_vccz L_back_p_f
s_sleep 1
s_sub_u32 s90, s90, 1
s_cmp_lg_u32 s90, 0
s_cbranch_scc1 L_spin2_p_f
s_branch L_back_p_f
L_spin_tb_f:
s_mov_b32 s90, 0x80000
L_spin2_tb_f:
ds_read_b32 v6, v0 offset:2048
s_waitcnt lgkmcnt(0)
v_cmp_gt_u32 vcc, s92, v6
s_cbranch_vccz L_back_tb_f
s_sleep 1
s_sub_u32 s90, s90, 1
s_cmp_lg_u32 s90, 0
s_cbranch_scc1 L_spin2_tb_f
s_branch L_back_tb_f
L_spin_pt_f:
s_mov_b32 s90, 0x80000
L_spin2_pt_f:
ds_read_b32 v6, v0 offset:0
s_waitcnt lgkmcnt(0)
v_cmp_gt_u32 vcc, s67, v6
s_cbranch_vccz L_back_pt_f
s_sleep 1
s_sub_u32 s90, s90, 1
s_cmp_lg_u32 s90, 0
s_cbranch_scc1 L_spin2_pt_f
s_branch L_back_pt_f
L_spin_p_s:
s_mov_b32 s90, 0x80000
L_spin2_p_s:
ds_read_b32 v6, v0 offset:0
s_waitcnt lgkmcnt(0)
v_cmp_gt_u32 vcc, s67, v6
s_cbranch_vccz L_back_p_s
s_sleep 1
s_sub_u32 s90, s90, 1
s_cmp_lg_u32 s90, 0
s_cbranch_scc1 L_spin2_p_s
s_branch L_back_p_s
L_spin_pt_s:
s_mov_b32 s90, 0x80000
L_spin2_pt_s:
ds_read_b32 v6, v0 offset:0
s_waitcnt lgkmcnt(0)
v_cmp_gt_u32 vcc, s67, v6
s_cbranch_vccz L_back_pt_s
s_sleep 1
s_sub_u32 s90, s90, 1
s_cmp_lg_u32 s90, 0
s_cbranch_scc1 L_spin2_pt_s
s_branch L_back_pt_s
.section .rodata,"a"
.p2align 6
.amdhsa_kernel standalone__kv_cache_quant_pre_rope_vs_post_rope__prompt_kernel
  .amdhsa_next_free_vgpr 256
  .amdhsa_next_free_sgpr 102
  .amdhsa_accum_offset 128
  .amdhsa_group_segment_fixed_size 0
  .amdhsa_kernarg_size 112
  .amdhsa_user_sgpr_count 2
  .amdhsa_user_sgpr_kernarg_segment_ptr 1
  .amdhsa_system_sgpr_workgroup_id_x 1
.end_amdhsa_kernel
```
